```python
import torch

def _softmax(x, axis=-1):
    return torch.softmax(x, dim=axis)
def _gelu(x):
    return torch.nn.functional.gelu(x, approximate="tanh")
def _silu(x):
    return torch.nn.functional.silu(x)
def _sigmoid(x):
    return torch.sigmoid(x)
def _layernorm(x, axis=-1, eps=1e-5):
    m = x.mean(dim=axis, keepdim=True)
    v = x.var(dim=axis, keepdim=True, unbiased=False)
    return (x - m) / torch.sqrt(v + eps)
def _scatter_add(tgt, idx, src, axis=0):
    return tgt.clone().index_add_(axis, idx, src)
def _segment_sum(src, seg, n):
    out = torch.zeros((n,) + src.shape[1:], dtype=src.dtype)
    return out.index_add_(0, seg, src)
def _pad(x, pw):
    flat = tuple(v for pair in reversed(pw) for v in pair)
    return torch.nn.functional.pad(x, flat)

kernel_name = 'sequential_preLN__linear_kernel_hedgehog__swiglu_ffn__prompt'

def setup_inputs():

    _w = (lambda a: (lambda t: t.to(torch.bfloat16) if t.is_floating_point() else t)(torch.as_tensor(a)))
    def _A_setup():
        B, S, D, H = 1, 2048, 576, 32
        Dh = D // H
        return {
            "x": _w((lambda *s: torch.randn(*s, dtype=torch.bfloat16) * 0.05)(B, S, D)),
            "wqkv": _w((lambda *s: torch.randn(*s, dtype=torch.bfloat16) * 0.2)(D, 3 * D)),
            "w_phi": _w((lambda *s: torch.randn(*s, dtype=torch.bfloat16) * 0.2)(H, Dh, Dh) * (Dh ** -0.5)),
            "wo": _w((lambda *s: torch.randn(*s, dtype=torch.bfloat16) * 0.05)(D, D)),
        }
    _A_in = _A_setup()

    def _B_setup():
        B, S, D, F = 1, 2048, 576, 4608
        return {
            "x": _w((lambda *s: torch.randn(*s, dtype=torch.bfloat16) * 0.05)(B, S, D)),
            "w_gate": _w((lambda *s: torch.randn(*s, dtype=torch.bfloat16) * 0.05)(D, F)),
            "w_up": _w((lambda *s: torch.randn(*s, dtype=torch.bfloat16) * 0.05)(D, F)),
            "w_down": _w((lambda *s: torch.randn(*s, dtype=torch.bfloat16) * 0.05)(F, D)),
        }
    _B_in = _B_setup()

    return {
        "A_x": _A_in["x"],
        "A_wqkv": _A_in["wqkv"],
        "A_w_phi": _A_in["w_phi"],
        "A_wo": _A_in["wo"],
        "B_x": _B_in["x"],
        "B_w_gate": _B_in["w_gate"],
        "B_w_up": _B_in["w_up"],
        "B_w_down": _B_in["w_down"],
    }

def reference(A_x, A_wqkv, A_w_phi, A_wo, B_x, B_w_gate, B_w_up, B_w_down):
    def _A_ref(x, wqkv, w_phi, wo):
        B, S, D = x.shape
        H = 32; Dh = D // H
        qkv = (lambda x, *d: x.permute(*d))((x @ wqkv).reshape(B, S, 3, H, Dh), 2, 0, 3, 1, 4)
        q, k, v = qkv[0], qkv[1], qkv[2]
        pq = torch.einsum("bhsd,hdf->bhsf", q, w_phi)
        pk = torch.einsum("bhsd,hdf->bhsf", k, w_phi)
        phi_q = torch.concatenate([_softmax(pq, axis=-1), _softmax(-pq, axis=-1)], axis=-1)
        phi_k = torch.concatenate([_softmax(pk, axis=-1), _softmax(-pk, axis=-1)], axis=-1)
        kv = torch.einsum("bhsf,bhsd->bhfd", phi_k, v)
        z  = torch.einsum("bhsf->bhf", phi_k)
        num = torch.einsum("bhqf,bhfd->bhqd", phi_q, kv)
        den = torch.einsum("bhqf,bhf->bhq", phi_q, z)[..., None] + 1e-6
        o = num / den
        return (lambda x, *d: x.permute(*d))(o, 0, 2, 1, 3).reshape(B, S, D) @ wo

    def _B_ref(x, w_gate, w_up, w_down):
        g = _silu(x @ w_gate)
        u = x @ w_up
        return (g * u) @ w_down

    x = A_x
    h = x + _A_ref(_layernorm(x, axis=-1), A_wqkv, A_w_phi, A_wo)
    h2 = h + _B_ref(_layernorm(h, axis=-1), B_w_gate, B_w_up, B_w_down)
    return h2
```

```asm
; @launch grid=(256,1,1) block=(256,1,1) lds=163840
.amdgcn_target "amdgcn-amd-amdhsa--gfx950"
.text
.globl sequential_preLN__linear_kernel_hedgehog__swiglu_ffn__prompt_kernel
.p2align 8
.type sequential_preLN__linear_kernel_hedgehog__swiglu_ffn__prompt_kernel,@function
sequential_preLN__linear_kernel_hedgehog__swiglu_ffn__prompt_kernel:
    s_cmp_ge_u32 s2, 256
    s_cbranch_scc1 L_sequential_preLN__linear_kernel_hedgehog__swiglu_ffn__prompt_kernel_end
    s_load_dwordx4 s[4:7], s[0:1], 0
    s_load_dwordx2 s[8:9], s[0:1], 16
    s_load_dwordx2 s[10:11], s[0:1], 80
    s_load_dwordx4 s[64:67], s[0:1], 40
    s_load_dwordx2 s[68:69], s[0:1], 56
    s_load_dwordx2 s[78:79], s[0:1], 24
    s_and_b32 s43, s2, 1
    s_lshl_b32 s40, s43, 3
    s_bfe_u32 s41, s2, 0x30003
    s_add_u32 s40, s40, s41
    s_bfe_u32 s41, s2, 0x20001
    s_lshl_b32 s41, s41, 2
    s_lshr_b32 s44, s2, 6
    s_add_u32 s41, s41, s44
    s_getpc_b64 s[12:13]
L_sequential_preLN__linear_kernel_hedgehog__swiglu_ffn__prompt_kernel_pc:
    s_mov_b32 s14, L_all_end-L_sequential_preLN__linear_kernel_hedgehog__swiglu_ffn__prompt_kernel_pc
    s_mov_b32 s15, 0x00020000
    s_lshr_b32 s16, s2, 3
    s_and_b32 s16, s16, 31
    v_lshlrev_b32 v253, 12, v0
    s_lshl_b32 s16, s16, 7
    buffer_load_dword v254, v253, s[12:15], s16 offen
    v_lshrrev_b32 v1, 6, v0
    v_and_b32 v2, 63, v0
    v_readfirstlane_b32 s42, v1
    v_mov_b32 v255, 0x40000000
    v_mul_u32_u24 v241, 36, v2
    s_mul_i32 s46, s40, 1296
    v_add_u32 v241, s46, v241
    v_cmp_gt_u32 vcc, 36, v2
    s_bfe_u32 s47, s2, 0x30003
    s_mul_i32 s47, s47, 48
    v_cndmask_b32 v241, v255, v241, vcc
    v_add_u32 v242, s47, v0
    v_mul_u32_u24 v243, 21846, v242
    v_lshrrev_b32 v243, 16, v243
    v_mul_u32_u24 v244, 3, v243
    v_sub_u32 v244, v242, v244
    v_mul_u32_u24 v243, 1152, v243
    v_lshl_add_u32 v243, v244, 7, v243
    v_cmp_gt_u32 vcc, 48, v0
    s_mul_i32 s36, s41, 147456
    s_lshr_b32 s48, s2, 3
    s_mul_i32 s48, s48, 90
    v_cndmask_b32 v246, v255, v243, vcc
    v_add_u32 v242, s48, v0
    v_mul_u32_u24 v243, 13108, v242
    v_lshrrev_b32 v243, 16, v243
    v_mul_u32_u24 v244, 5, v243
    v_sub_u32 v244, v242, v244
    v_mul_u32_u24 v243, 1152, v243
    v_lshl_add_u32 v243, v244, 7, v243
    v_cmp_gt_u32 vcc, 90, v0
    s_lshl_b32 s37, s43, 9
    s_nop 0
    v_cndmask_b32 v247, v255, v243, vcc
    s_waitcnt lgkmcnt(0)
    s_mov_b32 s12, s4
    s_mov_b32 s13, s5
    s_mov_b32 s14, 0x240000
    s_mov_b32 s15, 0x00020000
    s_mov_b32 s16, s6
    s_mov_b32 s17, s7
    s_mov_b32 s18, 0x1e6000
    s_mov_b32 s19, 0x00020000
    s_mov_b32 s20, s8
    s_mov_b32 s21, s9
    s_mov_b32 s22, 0x5100
    s_mov_b32 s23, 0x00020000
    buffer_load_dword v252, v246, s[12:15], s36 offen offset:0
    buffer_load_dword v253, v247, s[16:19], s37 offen
    s_add_u32 s37, s37, 663552
    buffer_load_dwordx4 a[72:75], v241, s[20:23], 0 offen
    buffer_load_dwordx4 a[76:79], v241, s[20:23], 0 offen offset:16
    buffer_load_dword a80, v241, s[20:23], 0 offen offset:32
    s_add_u32 s24, s10, 0xe00000
    s_addc_u32 s25, s11, 0
    s_mov_b32 s26, 0x40000
    s_mov_b32 s27, 0x00020000
    s_load_dword s100, s[24:25], 0x3F000
    s_add_u32 s28, s10, 0x600000
    s_addc_u32 s29, s11, 0
    s_mov_b32 s30, 0x1e0000
    s_mov_b32 s31, 0x00020000
    s_mov_b32 s60, 0x3fb8aa3b
    s_mov_b32 s61, 0xbfb8aa3b
    v_lshrrev_b32 v241, 3, v2
    v_lshl_add_u32 v241, v1, 5, v241
    s_lshl_b32 s45, s41, 7
    v_add_u32 v241, s45, v241
    v_mul_u32_u24 v241, 1152, v241
    v_and_b32 v242, 7, v2
    v_lshrrev_b32 v243, 4, v2
    v_xor_b32 v242, v242, v243
    v_lshl_add_u32 v3, v242, 4, v241
    v_xor_b32 v4, 64, v3
    v_add_u32 v4, 8192, v4
    v_add_u32 v5, 16384, v3
    v_add_u32 v6, 16384, v4
    v_lshrrev_b32 v241, 4, v2
    v_and_b32 v242, 15, v2
    v_lshlrev_b32 v243, 2, v241
    v_sub_u32 v242, v242, v243
    v_and_b32 v242, 15, v242
    v_mul_u32_u24 v243, 52, v242
    v_lshrrev_b32 v243, 8, v243
    v_mul_u32_u24 v244, 5, v243
    v_sub_u32 v244, v242, v244
    v_mul_u32_u24 v243, 1152, v243
    v_lshl_add_u32 v244, v244, 4, v243
    v_lshl_add_u32 v243, v1, 2, v241
    v_mul_u32_u24 v243, 3456, v243
    s_mul_i32 s44, s40, 72
    s_and_b32 s45, s44, 8
    s_and_b32 s44, s44, 0xfffffff0
    v_add3_u32 v244, v244, v243, s44
    v_cmp_eq_u32 vcc, 15, v242
    v_cmp_ne_u32 s[32:33], 15, v242
    s_lshl_b32 s47, s42, 10
    s_mov_b32 s48, 0
    v_cndmask_b32 v7, v244, v255, vcc
    v_mov_b32 v248, 0x3f803f80
    v_mov_b32 v249, 0x3f803f80
    v_mov_b32 v250, 0x3f803f80
    v_mov_b32 v251, 0x3f803f80
    v_and_b32 v241, 3, v0
    v_lshlrev_b32 v241, 6, v241
    v_add_u32 v241, 240, v241
    v_and_b32 v241, 255, v241
    v_lshl_add_u32 v241, v0, 8, v241
    v_add_u32 v242, 0x10000, v241
    ds_write_b64 v241, v[248:249]
    s_cmp_ge_u32 s42, 2
    s_cbranch_scc1 L_sequential_preLN__linear_kernel_hedgehog__swiglu_ffn__prompt_kernel_no3
    ds_write_b64 v242, v[248:249]
L_sequential_preLN__linear_kernel_hedgehog__swiglu_ffn__prompt_kernel_no3:
    v_bfe_u32 v13, v2, 2, 2
    v_lshrrev_b32 v14, 5, v2
    v_bfe_u32 v15, v2, 4, 1
    v_and_b32 v241, 3, v2
    v_lshl_add_u32 v15, v15, 2, v241
    s_lshl_b32 s49, s42, 14
    s_add_u32 s49, s49, 98304
    s_add_u32 s46, s49, 12288
    v_cmp_eq_u32 s[58:59], 0, v14
    v_mov_b32 v238, 0
    v_mov_b32 v239, 0
    s_mov_b32 s62, 0x3f803f80
    s_waitcnt lgkmcnt(0)
    buffer_load_dword v252, v246, s[12:15], s36 offen offset:384
    buffer_load_dword v253, v247, s[16:19], s37 offen
    s_add_u32 s37, s37, 663552
    s_add_u32 m0, s49, 0
    s_mov_b32 s63, 0
    buffer_load_dwordx4 v3, s[12:15], s63 offen offset:0 lds
    buffer_load_dwordx4 v4, s[12:15], s63 offen offset:1024 lds
    buffer_load_dwordx4 v5, s[12:15], s63 offen offset:2048 lds
    buffer_load_dwordx4 v6, s[12:15], s63 offen offset:3072 lds
    s_add_u32 m0, s47, 0
    s_mov_b64 exec, s[32:33]
    buffer_load_dwordx4 v7, s[16:19], s48 offen lds
    s_mov_b64 exec, -1
    s_add_u32 s48, s48, 55296
    s_add_u32 m0, s47, 4096
    s_mov_b64 exec, s[32:33]
    buffer_load_dwordx4 v7, s[16:19], s48 offen lds
    s_mov_b64 exec, -1
    s_add_u32 s48, s48, 55296
    s_add_u32 m0, s47, 8192
    s_mov_b64 exec, s[32:33]
    buffer_load_dwordx4 v7, s[16:19], s48 offen lds
    s_mov_b64 exec, -1
    s_add_u32 s48, s48, 55296
    s_add_u32 m0, s47, 12288
    s_mov_b64 exec, s[32:33]
    buffer_load_dwordx4 v7, s[16:19], s48 offen lds
    s_mov_b64 exec, -1
    s_add_u32 s48, s48, 55296
    s_add_u32 m0, s49, 4096
    s_mov_b32 s63, 128
    buffer_load_dwordx4 v3, s[12:15], s63 offen offset:0 lds
    buffer_load_dwordx4 v4, s[12:15], s63 offen offset:1024 lds
    buffer_load_dwordx4 v5, s[12:15], s63 offen offset:2048 lds
    buffer_load_dwordx4 v6, s[12:15], s63 offen offset:3072 lds
    s_add_u32 m0, s47, 16384
    s_mov_b64 exec, s[32:33]
    buffer_load_dwordx4 v7, s[16:19], s48 offen lds
    s_mov_b64 exec, -1
    s_add_u32 s48, s48, 55296
    s_add_u32 m0, s47, 20480
    s_mov_b64 exec, s[32:33]
    buffer_load_dwordx4 v7, s[16:19], s48 offen lds
    s_mov_b64 exec, -1
    s_add_u32 s48, s48, 55296
    s_add_u32 m0, s47, 24576
    s_mov_b64 exec, s[32:33]
    buffer_load_dwordx4 v7, s[16:19], s48 offen lds
    s_mov_b64 exec, -1
    s_add_u32 s48, s48, 55296
    s_add_u32 m0, s47, 28672
    s_mov_b64 exec, s[32:33]
    buffer_load_dwordx4 v7, s[16:19], s48 offen lds
    s_mov_b64 exec, -1
    s_add_u32 s48, s48, 55296
    buffer_load_dword v252, v246, s[12:15], s36 offen offset:768
    buffer_load_dword v253, v247, s[16:19], s37 offen
    s_add_u32 s37, s37, 663552
    v_lshl_add_u32 v241, v14, 3, v13
    v_lshlrev_b32 v241, 8, v241
    v_lshlrev_b32 v242, 6, v13
    v_add_u32 v242, s45, v242
    v_lshl_add_u32 v243, v15, 3, v242
    v_add_u32 v244, 0, v243
    v_and_b32 v244, 255, v244
    v_add_u32 v8, v241, v244
    v_add_u32 v244, 80, v243
    v_and_b32 v244, 255, v244
    v_add_u32 v9, v241, v244
    v_add_u32 v244, 160, v243
    v_and_b32 v244, 255, v244
    v_add_u32 v10, v241, v244
    v_min_u32 v244, 2, v15
    v_mul_u32_u24 v244, 80, v244
    v_add3_u32 v244, v244, v242, 64
    v_lshlrev_b32 v245, 6, v13
    v_add_u32 v245, 240, v245
    v_cmp_lt_u32 vcc, 2, v15
    s_nop 1
    v_cndmask_b32 v244, v244, v245, vcc
    v_and_b32 v244, 255, v244
    v_add_u32 v11, v241, v244
    v_mov_b32 v12, v8
    v_cmp_eq_u32 vcc, 1, v1
    s_nop 1
    v_cndmask_b32 v12, v12, v9, vcc
    v_cmp_eq_u32 vcc, 2, v1
    s_nop 1
    v_cndmask_b32 v12, v12, v10, vcc
    v_cmp_eq_u32 vcc, 3, v1
    s_nop 1
    v_cndmask_b32 v12, v12, v11, vcc
    v_and_b32 v242, 31, v2
    v_bfe_u32 v241, v2, 1, 3
    v_xor_b32 v241, v241, v14
    v_lshlrev_b32 v241, 4, v241
    v_lshlrev_b32 v242, 7, v242
    v_add3_u32 v234, v241, v242, s49
    v_xor_b32 v235, 32, v234
    v_xor_b32 v236, 64, v234
    v_xor_b32 v237, 0x60, v234
    v_mul_u32_u24 v241, 40, v2
    v_add_u32 v241, s46, v241
    v_lshl_add_u32 v242, v14, 2, v13
    v_mul_u32_u24 v243, 40, v242
    v_lshrrev_b32 v244, 1, v15
    v_lshlrev_b32 v245, 3, v244
    v_add3_u32 v243, v243, v245, s46
    v_mov_b32 v240, s46
    v_add_u32 v240, 1440, v240
    v_and_b32 v172, 1, v15
    v_cmp_le_u32 vcc, 2, v242
    s_nop 1
    v_cndmask_b32 v173, 0, 1, vcc
    v_cmp_eq_u32 s[50:51], 0, v172
    v_cmp_eq_u32 s[52:53], 1, v172
    v_cmp_eq_u32 s[54:55], v172, v173
    v_cmp_eq_u32 s[56:57], 0, v244
    v_mul_u32_u24 v174, 40, v13
    v_add3_u32 v174, v174, v245, s46
    v_add_u32 v174, 1280, v174
    s_mov_b64 s[62:63], s[50:51]
    v_cndmask_b32 v176, v240, v243, s[62:63]
    s_mov_b64 s[62:63], s[52:53]
    v_cndmask_b32 v177, v240, v243, s[62:63]
    s_mov_b64 s[62:63], s[54:55]
    v_cndmask_b32 v178, v240, v243, s[62:63]
    s_mov_b64 s[62:63], s[52:53]
    s_and_b64 s[62:63], s[62:63], s[58:59]
    v_cndmask_b32 v179, v240, v174, s[62:63]
    s_mov_b64 s[62:63], s[52:53]
    s_andn2_b64 s[62:63], s[62:63], s[58:59]
    v_cndmask_b32 v180, v240, v174, s[62:63]
    s_mov_b64 s[62:63], s[50:51]
    s_and_b64 s[62:63], s[62:63], s[56:57]
    v_cndmask_b32 v181, v240, v243, s[62:63]
    s_mov_b64 s[62:63], s[52:53]
    s_and_b64 s[62:63], s[62:63], s[56:57]
    v_cndmask_b32 v182, v240, v243, s[62:63]
    s_mov_b64 s[62:63], s[54:55]
    s_and_b64 s[62:63], s[62:63], s[56:57]
    v_cndmask_b32 v183, v240, v243, s[62:63]
    s_mov_b64 s[62:63], s[52:53]
    s_and_b64 s[62:63], s[62:63], s[58:59]
    s_and_b64 s[62:63], s[62:63], s[56:57]
    v_cndmask_b32 v184, v240, v174, s[62:63]
    s_mov_b64 s[62:63], s[52:53]
    s_andn2_b64 s[62:63], s[62:63], s[58:59]
    s_and_b64 s[62:63], s[62:63], s[56:57]
    v_cndmask_b32 v185, v240, v174, s[62:63]
    v_accvgpr_write_b32 a81, 0
    s_waitcnt vmcnt(20)
    ds_write_b64 v241, a[72:73] offset:0
    ds_write_b64 v241, a[74:75] offset:8
    ds_write_b64 v241, a[76:77] offset:16
    ds_write_b64 v241, a[78:79] offset:24
    ds_write_b64 v241, a[80:81] offset:32
    ds_read_b64_tr_b16 a[0:1], v176 offset:0
    ds_read_b64_tr_b16 a[2:3], v176 offset:320
    ds_read_b64_tr_b16 a[4:5], v178 offset:640
    ds_read_b64_tr_b16 a[6:7], v177 offset:960
    ds_read_b64_tr_b16 a[8:9], v179 offset:0
    v_accvgpr_write_b32 a10, 0
    v_accvgpr_write_b32 a11, 0
    ds_read_b64_tr_b16 a[12:13], v180 offset:0
    v_accvgpr_write_b32 a14, 0
    v_accvgpr_write_b32 a15, 0
    ds_read_b64_tr_b16 a[16:17], v181 offset:32
    ds_read_b64_tr_b16 a[18:19], v181 offset:352
    ds_read_b64_tr_b16 a[20:21], v183 offset:672
    ds_read_b64_tr_b16 a[22:23], v182 offset:992
    ds_read_b64_tr_b16 a[24:25], v184 offset:32
    v_accvgpr_write_b32 a26, 0
    v_accvgpr_write_b32 a27, 0
    ds_read_b64_tr_b16 a[28:29], v185 offset:32
    v_accvgpr_write_b32 a30, 0
    v_accvgpr_write_b32 a31, 0
    s_waitcnt vmcnt(10)
    ds_read_b128 v[16:19], v234 offset:0
    ds_read_b128 v[20:23], v235 offset:0
    ds_read_b128 v[24:27], v236 offset:0
    ds_read_b128 v[28:31], v237 offset:0
    s_waitcnt vmcnt(2)
    s_barrier
    ds_read_b64_tr_b16 a[32:33], v8 offset:0
    ds_read_b64_tr_b16 a[34:35], v8 offset:1024
    ds_read_b64_tr_b16 a[36:37], v9 offset:0
    ds_read_b64_tr_b16 a[38:39], v9 offset:1024
    ds_read_b64_tr_b16 a[40:41], v10 offset:0
    ds_read_b64_tr_b16 a[42:43], v10 offset:1024
    ds_read_b64_tr_b16 a[44:45], v11 offset:0
    ds_read_b64_tr_b16 a[46:47], v11 offset:1024
    ds_read_b64_tr_b16 v[224:225], v12 offset:0
    ds_read_b64_tr_b16 v[226:227], v12 offset:1024
    ds_read_b128 v[32:35], v234 offset:4096
    ds_read_b128 v[36:39], v235 offset:4096
    ds_read_b128 v[40:43], v236 offset:4096
    ds_read_b128 v[44:47], v237 offset:4096
    s_waitcnt lgkmcnt(12)
    v_mfma_f32_32x32x16_bf16 v[160:175], a[32:35], v[16:19], 0
    ds_read_b64_tr_b16 a[48:49], v8 offset:4096
    ds_read_b64_tr_b16 a[50:51], v8 offset:5120
    ds_read_b64_tr_b16 a[52:53], v9 offset:4096
    v_mfma_f32_4x4x4_16b_bf16 a[64:67], v[16:17], v[16:17], 0
    s_add_u32 m0, s49, 8192
    s_mov_b32 s63, 256
    buffer_load_dwordx4 v3, s[12:15], s63 offen offset:0 lds
    s_waitcnt lgkmcnt(13)
    v_mfma_f32_32x32x16_bf16 v[176:191], a[36:39], v[16:19], 0
    ds_read_b64_tr_b16 a[54:55], v9 offset:5120
    ds_read_b64_tr_b16 a[56:57], v10 offset:4096
    ds_read_b64_tr_b16 a[58:59], v10 offset:5120
    v_mfma_f32_4x4x4_16b_bf16 a[64:67], v[18:19], v[18:19], a[64:67]
    buffer_load_dwordx4 v4, s[12:15], s63 offen offset:1024 lds
    s_waitcnt lgkmcnt(14)
    v_mfma_f32_32x32x16_bf16 v[192:207], a[40:43], v[16:19], 0
    ds_read_b64_tr_b16 a[60:61], v11 offset:4096
    ds_read_b64_tr_b16 a[62:63], v11 offset:5120
    ds_read_b64_tr_b16 v[228:229], v12 offset:4096
    s_waitcnt lgkmcnt(13)
    v_mfma_f32_4x4x4_16b_bf16 a[68:71], v[224:225], v[248:249], 0
    buffer_load_dwordx4 v5, s[12:15], s63 offen offset:2048 lds
    s_waitcnt lgkmcnt(15)
    v_mfma_f32_32x32x16_bf16 v[208:223], a[44:47], v[16:19], 0
    ds_read_b64_tr_b16 v[230:231], v12 offset:5120
    v_mfma_f32_4x4x4_16b_bf16 a[68:71], v[226:227], v[248:249], a[68:71]
    buffer_load_dwordx4 v6, s[12:15], s63 offen offset:3072 lds
    s_waitcnt lgkmcnt(8)
    v_mfma_f32_32x32x16_bf16 v[160:175], a[48:51], v[20:23], v[160:175]
    ds_read_b64_tr_b16 a[32:33], v8 offset:8192
    ds_read_b64_tr_b16 a[34:35], v8 offset:9216
    ds_read_b64_tr_b16 a[36:37], v9 offset:8192
    v_mfma_f32_4x4x4_16b_bf16 a[64:67], v[20:21], v[20:21], a[64:67]
    s_add_u32 m0, s47, 32768
    s_mov_b64 exec, s[32:33]
    buffer_load_dwordx4 v7, s[16:19], s48 offen lds
    s_mov_b64 exec, -1
    s_add_u32 s48, s48, 55296
    s_waitcnt lgkmcnt(9)
    v_mfma_f32_32x32x16_bf16 v[176:191], a[52:55], v[20:23], v[176:191]
    ds_read_b64_tr_b16 a[38:39], v9 offset:9216
    ds_read_b64_tr_b16 a[40:41], v10 offset:8192
    ds_read_b64_tr_b16 a[42:43], v10 offset:9216
    v_mfma_f32_4x4x4_16b_bf16 a[64:67], v[22:23], v[22:23], a[64:67]
    s_add_u32 m0, s47, 36864
    s_mov_b64 exec, s[32:33]
    buffer_load_dwordx4 v7, s[16:19], s48 offen lds
    s_mov_b64 exec, -1
    s_add_u32 s48, s48, 55296
    s_waitcnt lgkmcnt(10)
    v_mfma_f32_32x32x16_bf16 v[192:207], a[56:59], v[20:23], v[192:207]
    ds_read_b64_tr_b16 a[44:45], v11 offset:8192
    ds_read_b64_tr_b16 a[46:47], v11 offset:9216
    ds_read_b64_tr_b16 v[224:225], v12 offset:8192
    s_waitcnt lgkmcnt(9)
    v_mfma_f32_4x4x4_16b_bf16 a[68:71], v[228:229], v[248:249], a[68:71]
    s_add_u32 m0, s47, 40960
    s_mov_b64 exec, s[32:33]
    buffer_load_dwordx4 v7, s[16:19], s48 offen lds
    s_mov_b64 exec, -1
    s_add_u32 s48, s48, 55296
    s_waitcnt lgkmcnt(11)
    v_mfma_f32_32x32x16_bf16 v[208:223], a[60:63], v[20:23], v[208:223]
    ds_read_b64_tr_b16 v[226:227], v12 offset:9216
    v_mfma_f32_4x4x4_16b_bf16 a[68:71], v[230:231], v[248:249], a[68:71]
    s_add_u32 m0, s47, 45056
    s_mov_b64 exec, s[32:33]
    buffer_load_dwordx4 v7, s[16:19], s48 offen lds
    s_mov_b64 exec, -1
    s_add_u32 s48, s48, 55296
    s_waitcnt lgkmcnt(8)
    v_mfma_f32_32x32x16_bf16 v[160:175], a[32:35], v[24:27], v[160:175]
    ds_read_b64_tr_b16 a[48:49], v8 offset:12288
    ds_read_b64_tr_b16 a[50:51], v8 offset:13312
    ds_read_b64_tr_b16 a[52:53], v9 offset:12288
    v_mfma_f32_4x4x4_16b_bf16 a[64:67], v[24:25], v[24:25], a[64:67]
    s_add_u32 m0, s49, 12288
    s_mov_b32 s63, 384
    buffer_load_dwordx4 v3, s[12:15], s63 offen offset:0 lds
    s_waitcnt lgkmcnt(9)
    v_mfma_f32_32x32x16_bf16 v[176:191], a[36:39], v[24:27], v[176:191]
    ds_read_b64_tr_b16 a[54:55], v9 offset:13312
    ds_read_b64_tr_b16 a[56:57], v10 offset:12288
    ds_read_b64_tr_b16 a[58:59], v10 offset:13312
    v_mfma_f32_4x4x4_16b_bf16 a[64:67], v[26:27], v[26:27], a[64:67]
    buffer_load_dwordx4 v4, s[12:15], s63 offen offset:1024 lds
    s_waitcnt lgkmcnt(10)
    v_mfma_f32_32x32x16_bf16 v[192:207], a[40:43], v[24:27], v[192:207]
    ds_read_b64_tr_b16 a[60:61], v11 offset:12288
    ds_read_b64_tr_b16 a[62:63], v11 offset:13312
    ds_read_b64_tr_b16 v[228:229], v12 offset:12288
    s_waitcnt lgkmcnt(9)
    v_mfma_f32_4x4x4_16b_bf16 a[68:71], v[224:225], v[248:249], a[68:71]
    buffer_load_dwordx4 v5, s[12:15], s63 offen offset:2048 lds
    s_waitcnt lgkmcnt(11)
    v_mfma_f32_32x32x16_bf16 v[208:223], a[44:47], v[24:27], v[208:223]
    ds_read_b64_tr_b16 v[230:231], v12 offset:13312
    v_mfma_f32_4x4x4_16b_bf16 a[68:71], v[226:227], v[248:249], a[68:71]
    buffer_load_dwordx4 v6, s[12:15], s63 offen offset:3072 lds
    s_waitcnt lgkmcnt(8)
    v_mfma_f32_32x32x16_bf16 v[160:175], a[48:51], v[28:31], v[160:175]
    ds_read_b64_tr_b16 a[32:33], v8 offset:16384
    ds_read_b64_tr_b16 a[34:35], v8 offset:17408
    ds_read_b64_tr_b16 a[36:37], v9 offset:16384
    v_mfma_f32_4x4x4_16b_bf16 a[64:67], v[28:29], v[28:29], a[64:67]
    s_add_u32 m0, s47, 49152
    s_mov_b64 exec, s[32:33]
    buffer_load_dwordx4 v7, s[16:19], s48 offen lds
    s_mov_b64 exec, -1
    s_add_u32 s48, s48, 55296
    s_waitcnt lgkmcnt(9)
    v_mfma_f32_32x32x16_bf16 v[176:191], a[52:55], v[28:31], v[176:191]
    ds_read_b64_tr_b16 a[38:39], v9 offset:17408
    ds_read_b64_tr_b16 a[40:41], v10 offset:16384
    ds_read_b64_tr_b16 a[42:43], v10 offset:17408
    v_mfma_f32_4x4x4_16b_bf16 a[64:67], v[30:31], v[30:31], a[64:67]
    s_add_u32 m0, s47, 53248
    s_mov_b64 exec, s[32:33]
    buffer_load_dwordx4 v7, s[16:19], s48 offen lds
    s_mov_b64 exec, -1
    s_add_u32 s48, s48, 55296
    s_waitcnt lgkmcnt(10)
    v_mfma_f32_32x32x16_bf16 v[192:207], a[56:59], v[28:31], v[192:207]
    ds_read_b64_tr_b16 a[44:45], v11 offset:16384
    ds_read_b64_tr_b16 a[46:47], v11 offset:17408
    ds_read_b64_tr_b16 v[224:225], v12 offset:16384
    s_waitcnt lgkmcnt(9)
    v_mfma_f32_4x4x4_16b_bf16 a[68:71], v[228:229], v[248:249], a[68:71]
    s_add_u32 m0, s47, 57344
    s_mov_b64 exec, s[32:33]
    buffer_load_dwordx4 v7, s[16:19], s48 offen lds
    s_mov_b64 exec, -1
    s_add_u32 s48, s48, 55296
    s_waitcnt lgkmcnt(11)
    v_mfma_f32_32x32x16_bf16 v[208:223], a[60:63], v[28:31], v[208:223]
    ds_read_b64_tr_b16 v[226:227], v12 offset:17408
    v_mfma_f32_4x4x4_16b_bf16 a[68:71], v[230:231], v[248:249], a[68:71]
    s_add_u32 m0, s47, 61440
    s_mov_b64 exec, s[32:33]
    buffer_load_dwordx4 v7, s[16:19], s48 offen lds
    s_mov_b64 exec, -1
    s_add_u32 s48, s48, 55296
    s_waitcnt vmcnt(8)
    s_barrier
    ds_read_b128 v[48:51], v234 offset:8192
    ds_read_b128 v[52:55], v235 offset:8192
    ds_read_b128 v[56:59], v236 offset:8192
    ds_read_b128 v[60:63], v237 offset:8192
    s_waitcnt lgkmcnt(12)
    v_mfma_f32_32x32x16_bf16 v[160:175], a[32:35], v[32:35], v[160:175]
    ds_read_b64_tr_b16 a[48:49], v8 offset:20480
    ds_read_b64_tr_b16 a[50:51], v8 offset:21504
    ds_read_b64_tr_b16 a[52:53], v9 offset:20480
    v_mfma_f32_4x4x4_16b_bf16 a[64:67], v[32:33], v[32:33], a[64:67]
    s_add_u32 m0, s49, 0
    s_mov_b32 s63, 512
    buffer_load_dwordx4 v3, s[12:15], s63 offen offset:0 lds
    s_waitcnt lgkmcnt(13)
    v_mfma_f32_32x32x16_bf16 v[176:191], a[36:39], v[32:35], v[176:191]
    ds_read_b64_tr_b16 a[54:55], v9 offset:21504
    ds_read_b64_tr_b16 a[56:57], v10 offset:20480
    ds_read_b64_tr_b16 a[58:59], v10 offset:21504
    v_mfma_f32_4x4x4_16b_bf16 a[64:67], v[34:35], v[34:35], a[64:67]
    s_waitcnt lgkmcnt(14)
    v_mfma_f32_32x32x16_bf16 v[192:207], a[40:43], v[32:35], v[192:207]
    ds_read_b64_tr_b16 a[60:61], v11 offset:20480
    ds_read_b64_tr_b16 a[62:63], v11 offset:21504
    ds_read_b64_tr_b16 v[228:229], v12 offset:20480
    s_waitcnt lgkmcnt(13)
    v_mfma_f32_4x4x4_16b_bf16 a[68:71], v[224:225], v[248:249], a[68:71]
    buffer_load_dwordx4 v4, s[12:15], s63 offen offset:1024 lds
    s_waitcnt lgkmcnt(15)
    v_mfma_f32_32x32x16_bf16 v[208:223], a[44:47], v[32:35], v[208:223]
    ds_read_b64_tr_b16 v[230:231], v12 offset:21504
    v_mfma_f32_4x4x4_16b_bf16 a[68:71], v[226:227], v[248:249], a[68:71]
    s_waitcnt lgkmcnt(8)
    v_mfma_f32_32x32x16_bf16 v[160:175], a[48:51], v[36:39], v[160:175]
    ds_read_b64_tr_b16 a[32:33], v8 offset:24576
    ds_read_b64_tr_b16 a[34:35], v8 offset:25600
    ds_read_b64_tr_b16 a[36:37], v9 offset:24576
    v_mfma_f32_4x4x4_16b_bf16 a[64:67], v[36:37], v[36:37], a[64:67]
    buffer_load_dwordx4 v5, s[12:15], s63 offen offset:2048 lds
    s_waitcnt lgkmcnt(9)
    v_mfma_f32_32x32x16_bf16 v[176:191], a[52:55], v[36:39], v[176:191]
    ds_read_b64_tr_b16 a[38:39], v9 offset:25600
    ds_read_b64_tr_b16 a[40:41], v10 offset:24576
    ds_read_b64_tr_b16 a[42:43], v10 offset:25600
    v_mfma_f32_4x4x4_16b_bf16 a[64:67], v[38:39], v[38:39], a[64:67]
    s_waitcnt lgkmcnt(10)
    v_mfma_f32_32x32x16_bf16 v[192:207], a[56:59], v[36:39], v[192:207]
    ds_read_b64_tr_b16 a[44:45], v11 offset:24576
    ds_read_b64_tr_b16 a[46:47], v11 offset:25600
    ds_read_b64_tr_b16 v[224:225], v12 offset:24576
    s_waitcnt lgkmcnt(9)
    v_mfma_f32_4x4x4_16b_bf16 a[68:71], v[228:229], v[248:249], a[68:71]
    buffer_load_dwordx4 v6, s[12:15], s63 offen offset:3072 lds
    s_waitcnt lgkmcnt(11)
    v_mfma_f32_32x32x16_bf16 v[208:223], a[60:63], v[36:39], v[208:223]
    ds_read_b64_tr_b16 v[226:227], v12 offset:25600
    v_mfma_f32_4x4x4_16b_bf16 a[68:71], v[230:231], v[248:249], a[68:71]
    s_waitcnt lgkmcnt(8)
    v_mfma_f32_32x32x16_bf16 v[160:175], a[32:35], v[40:43], v[160:175]
    ds_read_b64_tr_b16 a[48:49], v8 offset:28672
    ds_read_b64_tr_b16 a[50:51], v8 offset:29696
    ds_read_b64_tr_b16 a[52:53], v9 offset:28672
    v_mfma_f32_4x4x4_16b_bf16 a[64:67], v[40:41], v[40:41], a[64:67]
    s_add_u32 m0, s47, 65536
    s_mov_b64 exec, s[32:33]
    buffer_load_dwordx4 v7, s[16:19], s48 offen lds
    s_mov_b64 exec, -1
    s_add_u32 s48, s48, 55296
    s_waitcnt lgkmcnt(9)
    v_mfma_f32_32x32x16_bf16 v[176:191], a[36:39], v[40:43], v[176:191]
    ds_read_b64_tr_b16 a[54:55], v9 offset:29696
    ds_read_b64_tr_b16 a[56:57], v10 offset:28672
    ds_read_b64_tr_b16 a[58:59], v10 offset:29696
    v_mfma_f32_4x4x4_16b_bf16 a[64:67], v[42:43], v[42:43], a[64:67]
    s_waitcnt lgkmcnt(10)
    v_mfma_f32_32x32x16_bf16 v[192:207], a[40:43], v[40:43], v[192:207]
    ds_read_b64_tr_b16 a[60:61], v11 offset:28672
    ds_read_b64_tr_b16 a[62:63], v11 offset:29696
    ds_read_b64_tr_b16 v[228:229], v12 offset:28672
    s_waitcnt lgkmcnt(9)
    v_mfma_f32_4x4x4_16b_bf16 a[68:71], v[224:225], v[248:249], a[68:71]
    s_add_u32 m0, s47, 69632
    s_mov_b64 exec, s[32:33]
    buffer_load_dwordx4 v7, s[16:19], s48 offen lds
    s_mov_b64 exec, -1
    s_add_u32 s48, s48, 55296
    s_waitcnt lgkmcnt(11)
    v_mfma_f32_32x32x16_bf16 v[208:223], a[44:47], v[40:43], v[208:223]
    ds_read_b64_tr_b16 v[230:231], v12 offset:29696
    v_mfma_f32_4x4x4_16b_bf16 a[68:71], v[226:227], v[248:249], a[68:71]
    s_waitcnt lgkmcnt(8)
    v_mfma_f32_32x32x16_bf16 v[160:175], a[48:51], v[44:47], v[160:175]
    ds_read_b64_tr_b16 a[32:33], v8 offset:32768
    ds_read_b64_tr_b16 a[34:35], v8 offset:33792
    ds_read_b64_tr_b16 a[36:37], v9 offset:32768
    v_mfma_f32_4x4x4_16b_bf16 a[64:67], v[44:45], v[44:45], a[64:67]
    s_add_u32 m0, s47, 73728
    s_mov_b64 exec, s[32:33]
    buffer_load_dwordx4 v7, s[16:19], s48 offen lds
    s_mov_b64 exec, -1
    s_add_u32 s48, s48, 55296
    s_waitcnt lgkmcnt(9)
    v_mfma_f32_32x32x16_bf16 v[176:191], a[52:55], v[44:47], v[176:191]
    ds_read_b64_tr_b16 a[38:39], v9 offset:33792
    ds_read_b64_tr_b16 a[40:41], v10 offset:32768
    ds_read_b64_tr_b16 a[42:43], v10 offset:33792
    v_mfma_f32_4x4x4_16b_bf16 a[64:67], v[46:47], v[46:47], a[64:67]
    s_waitcnt lgkmcnt(10)
    v_mfma_f32_32x32x16_bf16 v[192:207], a[56:59], v[44:47], v[192:207]
    ds_read_b64_tr_b16 a[44:45], v11 offset:32768
    ds_read_b64_tr_b16 a[46:47], v11 offset:33792
    ds_read_b64_tr_b16 v[224:225], v12 offset:32768
    s_waitcnt lgkmcnt(9)
    v_mfma_f32_4x4x4_16b_bf16 a[68:71], v[228:229], v[248:249], a[68:71]
    s_add_u32 m0, s47, 77824
    s_mov_b64 exec, s[32:33]
    buffer_load_dwordx4 v7, s[16:19], s48 offen lds
    s_mov_b64 exec, -1
    s_add_u32 s48, s48, 55296
    s_waitcnt lgkmcnt(11)
    v_mfma_f32_32x32x16_bf16 v[208:223], a[60:63], v[44:47], v[208:223]
    ds_read_b64_tr_b16 v[226:227], v12 offset:33792
    v_mfma_f32_4x4x4_16b_bf16 a[68:71], v[230:231], v[248:249], a[68:71]
    s_waitcnt vmcnt(8)
    s_barrier
    ds_read_b128 v[64:67], v234 offset:12288
    ds_read_b128 v[68:71], v235 offset:12288
    ds_read_b128 v[72:75], v236 offset:12288
    ds_read_b128 v[76:79], v237 offset:12288
    s_waitcnt lgkmcnt(12)
    v_mfma_f32_32x32x16_bf16 v[160:175], a[32:35], v[48:51], v[160:175]
    ds_read_b64_tr_b16 a[48:49], v8 offset:36864
    ds_read_b64_tr_b16 a[50:51], v8 offset:37888
    ds_read_b64_tr_b16 a[52:53], v9 offset:36864
    v_mfma_f32_4x4x4_16b_bf16 a[64:67], v[48:49], v[48:49], a[64:67]
    s_add_u32 m0, s49, 4096
    s_mov_b32 s63, 640
    buffer_load_dwordx4 v3, s[12:15], s63 offen offset:0 lds
    s_waitcnt lgkmcnt(13)
    v_mfma_f32_32x32x16_bf16 v[176:191], a[36:39], v[48:51], v[176:191]
    ds_read_b64_tr_b16 a[54:55], v9 offset:37888
    ds_read_b64_tr_b16 a[56:57], v10 offset:36864
    ds_read_b64_tr_b16 a[58:59], v10 offset:37888
    v_mfma_f32_4x4x4_16b_bf16 a[64:67], v[50:51], v[50:51], a[64:67]
    s_waitcnt lgkmcnt(14)
    v_mfma_f32_32x32x16_bf16 v[192:207], a[40:43], v[48:51], v[192:207]
    ds_read_b64_tr_b16 a[60:61], v11 offset:36864
    ds_read_b64_tr_b16 a[62:63], v11 offset:37888
    ds_read_b64_tr_b16 v[228:229], v12 offset:36864
    s_waitcnt lgkmcnt(13)
    v_mfma_f32_4x4x4_16b_bf16 a[68:71], v[224:225], v[248:249], a[68:71]
    buffer_load_dwordx4 v4, s[12:15], s63 offen offset:1024 lds
    s_waitcnt lgkmcnt(15)
    v_mfma_f32_32x32x16_bf16 v[208:223], a[44:47], v[48:51], v[208:223]
    ds_read_b64_tr_b16 v[230:231], v12 offset:37888
    v_mfma_f32_4x4x4_16b_bf16 a[68:71], v[226:227], v[248:249], a[68:71]
    s_waitcnt lgkmcnt(8)
    v_mfma_f32_32x32x16_bf16 v[160:175], a[48:51], v[52:55], v[160:175]
    ds_read_b64_tr_b16 a[32:33], v8 offset:40960
    ds_read_b64_tr_b16 a[34:35], v8 offset:41984
    ds_read_b64_tr_b16 a[36:37], v9 offset:40960
    v_mfma_f32_4x4x4_16b_bf16 a[64:67], v[52:53], v[52:53], a[64:67]
    buffer_load_dwordx4 v5, s[12:15], s63 offen offset:2048 lds
    s_waitcnt lgkmcnt(9)
    v_mfma_f32_32x32x16_bf16 v[176:191], a[52:55], v[52:55], v[176:191]
    ds_read_b64_tr_b16 a[38:39], v9 offset:41984
    ds_read_b64_tr_b16 a[40:41], v10 offset:40960
    ds_read_b64_tr_b16 a[42:43], v10 offset:41984
    v_mfma_f32_4x4x4_16b_bf16 a[64:67], v[54:55], v[54:55], a[64:67]
    s_waitcnt lgkmcnt(10)
    v_mfma_f32_32x32x16_bf16 v[192:207], a[56:59], v[52:55], v[192:207]
    ds_read_b64_tr_b16 a[44:45], v11 offset:40960
    ds_read_b64_tr_b16 a[46:47], v11 offset:41984
    ds_read_b64_tr_b16 v[224:225], v12 offset:40960
    s_waitcnt lgkmcnt(9)
    v_mfma_f32_4x4x4_16b_bf16 a[68:71], v[228:229], v[248:249], a[68:71]
    buffer_load_dwordx4 v6, s[12:15], s63 offen offset:3072 lds
    s_waitcnt lgkmcnt(11)
    v_mfma_f32_32x32x16_bf16 v[208:223], a[60:63], v[52:55], v[208:223]
    ds_read_b64_tr_b16 v[226:227], v12 offset:41984
    v_mfma_f32_4x4x4_16b_bf16 a[68:71], v[230:231], v[248:249], a[68:71]
    s_waitcnt lgkmcnt(8)
    v_mfma_f32_32x32x16_bf16 v[160:175], a[32:35], v[56:59], v[160:175]
    ds_read_b64_tr_b16 a[48:49], v8 offset:45056
    ds_read_b64_tr_b16 a[50:51], v8 offset:46080
    ds_read_b64_tr_b16 a[52:53], v9 offset:45056
    v_mfma_f32_4x4x4_16b_bf16 a[64:67], v[56:57], v[56:57], a[64:67]
    s_add_u32 m0, s47, 81920
    s_mov_b64 exec, s[32:33]
    buffer_load_dwordx4 v7, s[16:19], s48 offen lds
    s_mov_b64 exec, -1
    s_add_u32 s48, s48, 55296
    s_waitcnt lgkmcnt(9)
    v_mfma_f32_32x32x16_bf16 v[176:191], a[36:39], v[56:59], v[176:191]
    ds_read_b64_tr_b16 a[54:55], v9 offset:46080
    ds_read_b64_tr_b16 a[56:57], v10 offset:45056
    ds_read_b64_tr_b16 a[58:59], v10 offset:46080
    v_mfma_f32_4x4x4_16b_bf16 a[64:67], v[58:59], v[58:59], a[64:67]
    s_waitcnt lgkmcnt(10)
    v_mfma_f32_32x32x16_bf16 v[192:207], a[40:43], v[56:59], v[192:207]
    ds_read_b64_tr_b16 a[60:61], v11 offset:45056
    ds_read_b64_tr_b16 a[62:63], v11 offset:46080
    ds_read_b64_tr_b16 v[228:229], v12 offset:45056
    s_waitcnt lgkmcnt(9)
    v_mfma_f32_4x4x4_16b_bf16 a[68:71], v[224:225], v[248:249], a[68:71]
    s_add_u32 m0, s47, 86016
    s_mov_b64 exec, s[32:33]
    buffer_load_dwordx4 v7, s[16:19], s48 offen lds
    s_mov_b64 exec, -1
    s_add_u32 s48, s48, 55296
    s_waitcnt lgkmcnt(11)
    v_mfma_f32_32x32x16_bf16 v[208:223], a[44:47], v[56:59], v[208:223]
    ds_read_b64_tr_b16 v[230:231], v12 offset:46080
    v_mfma_f32_4x4x4_16b_bf16 a[68:71], v[226:227], v[248:249], a[68:71]
    s_waitcnt lgkmcnt(8)
    v_mfma_f32_32x32x16_bf16 v[160:175], a[48:51], v[60:63], v[160:175]
    v_add_u32 v8, 49152, v8
    v_add_u32 v9, 49152, v9
    v_add_u32 v10, 49152, v10
    v_add_u32 v11, 49152, v11
    v_add_u32 v12, 49152, v12
    ds_read_b64_tr_b16 a[32:33], v8 offset:0
    ds_read_b64_tr_b16 a[34:35], v8 offset:1024
    v_mfma_f32_4x4x4_16b_bf16 a[64:67], v[60:61], v[60:61], a[64:67]
    s_add_u32 m0, s47, 90112
    s_mov_b64 exec, s[32:33]
    buffer_load_dwordx4 v7, s[16:19], s48 offen lds
    s_mov_b64 exec, -1
    s_add_u32 s48, s48, 55296
    s_waitcnt lgkmcnt(8)
    v_mfma_f32_32x32x16_bf16 v[176:191], a[52:55], v[60:63], v[176:191]
    ds_read_b64_tr_b16 a[36:37], v9 offset:0
    ds_read_b64_tr_b16 a[38:39], v9 offset:1024
    ds_read_b64_tr_b16 a[40:41], v10 offset:0
    v_mfma_f32_4x4x4_16b_bf16 a[64:67], v[62:63], v[62:63], a[64:67]
    s_waitcnt lgkmcnt(9)
    v_mfma_f32_32x32x16_bf16 v[192:207], a[56:59], v[60:63], v[192:207]
    ds_read_b64_tr_b16 a[42:43], v10 offset:1024
    ds_read_b64_tr_b16 a[44:45], v11 offset:0
    ds_read_b64_tr_b16 a[46:47], v11 offset:1024
    s_waitcnt lgkmcnt(8)
    v_mfma_f32_4x4x4_16b_bf16 a[68:71], v[228:229], v[248:249], a[68:71]
    s_add_u32 m0, s47, 94208
    s_mov_b64 exec, s[32:33]
    buffer_load_dwordx4 v7, s[16:19], s48 offen lds
    s_mov_b64 exec, -1
    s_add_u32 s48, s48, 55296
    s_waitcnt lgkmcnt(10)
    v_mfma_f32_32x32x16_bf16 v[208:223], a[60:63], v[60:63], v[208:223]
    ds_read_b64_tr_b16 v[224:225], v12 offset:0
    ds_read_b64_tr_b16 v[226:227], v12 offset:1024
    v_mfma_f32_4x4x4_16b_bf16 a[68:71], v[230:231], v[248:249], a[68:71]
    s_waitcnt vmcnt(8)
    s_barrier
    ds_read_b128 v[80:83], v234 offset:0
    ds_read_b128 v[84:87], v235 offset:0
    ds_read_b128 v[88:91], v236 offset:0
    ds_read_b128 v[92:95], v237 offset:0
    s_waitcnt lgkmcnt(12)
    v_mfma_f32_32x32x16_bf16 v[160:175], a[32:35], v[64:67], v[160:175]
    ds_read_b64_tr_b16 a[48:49], v8 offset:4096
    ds_read_b64_tr_b16 a[50:51], v8 offset:5120
    ds_read_b64_tr_b16 a[52:53], v9 offset:4096
    v_mfma_f32_4x4x4_16b_bf16 a[64:67], v[64:65], v[64:65], a[64:67]
    s_add_u32 m0, s49, 8192
    s_mov_b32 s63, 768
    buffer_load_dwordx4 v3, s[12:15], s63 offen offset:0 lds
    s_waitcnt lgkmcnt(13)
    v_mfma_f32_32x32x16_bf16 v[176:191], a[36:39], v[64:67], v[176:191]
    ds_read_b64_tr_b16 a[54:55], v9 offset:5120
    ds_read_b64_tr_b16 a[56:57], v10 offset:4096
    ds_read_b64_tr_b16 a[58:59], v10 offset:5120
    v_mfma_f32_4x4x4_16b_bf16 a[64:67], v[66:67], v[66:67], a[64:67]
    s_waitcnt lgkmcnt(14)
    v_mfma_f32_32x32x16_bf16 v[192:207], a[40:43], v[64:67], v[192:207]
    ds_read_b64_tr_b16 a[60:61], v11 offset:4096
    ds_read_b64_tr_b16 a[62:63], v11 offset:5120
    ds_read_b64_tr_b16 v[228:229], v12 offset:4096
    s_waitcnt lgkmcnt(13)
    v_mfma_f32_4x4x4_16b_bf16 a[68:71], v[224:225], v[248:249], a[68:71]
    buffer_load_dwordx4 v4, s[12:15], s63 offen offset:1024 lds
    s_waitcnt lgkmcnt(15)
    v_mfma_f32_32x32x16_bf16 v[208:223], a[44:47], v[64:67], v[208:223]
    ds_read_b64_tr_b16 v[230:231], v12 offset:5120
    v_mfma_f32_4x4x4_16b_bf16 a[68:71], v[226:227], v[248:249], a[68:71]
    s_waitcnt lgkmcnt(8)
    v_mfma_f32_32x32x16_bf16 v[160:175], a[48:51], v[68:71], v[160:175]
    ds_read_b64_tr_b16 a[32:33], v8 offset:8192
    ds_read_b64_tr_b16 a[34:35], v8 offset:9216
    ds_read_b64_tr_b16 a[36:37], v9 offset:8192
    v_mfma_f32_4x4x4_16b_bf16 a[64:67], v[68:69], v[68:69], a[64:67]
    buffer_load_dwordx4 v5, s[12:15], s63 offen offset:2048 lds
    s_waitcnt lgkmcnt(9)
    v_mfma_f32_32x32x16_bf16 v[176:191], a[52:55], v[68:71], v[176:191]
    ds_read_b64_tr_b16 a[38:39], v9 offset:9216
    ds_read_b64_tr_b16 a[40:41], v10 offset:8192
    ds_read_b64_tr_b16 a[42:43], v10 offset:9216
    v_mfma_f32_4x4x4_16b_bf16 a[64:67], v[70:71], v[70:71], a[64:67]
    s_waitcnt lgkmcnt(10)
    v_mfma_f32_32x32x16_bf16 v[192:207], a[56:59], v[68:71], v[192:207]
    ds_read_b64_tr_b16 a[44:45], v11 offset:8192
    ds_read_b64_tr_b16 a[46:47], v11 offset:9216
    ds_read_b64_tr_b16 v[224:225], v12 offset:8192
    s_waitcnt lgkmcnt(9)
    v_mfma_f32_4x4x4_16b_bf16 a[68:71], v[228:229], v[248:249], a[68:71]
    buffer_load_dwordx4 v6, s[12:15], s63 offen offset:3072 lds
    s_waitcnt lgkmcnt(11)
    v_mfma_f32_32x32x16_bf16 v[208:223], a[60:63], v[68:71], v[208:223]
    ds_read_b64_tr_b16 v[226:227], v12 offset:9216
    v_mfma_f32_4x4x4_16b_bf16 a[68:71], v[230:231], v[248:249], a[68:71]
    s_waitcnt lgkmcnt(8)
    v_mfma_f32_32x32x16_bf16 v[160:175], a[32:35], v[72:75], v[160:175]
    ds_read_b64_tr_b16 a[48:49], v8 offset:12288
    ds_read_b64_tr_b16 a[50:51], v8 offset:13312
    ds_read_b64_tr_b16 a[52:53], v9 offset:12288
    v_mfma_f32_4x4x4_16b_bf16 a[64:67], v[72:73], v[72:73], a[64:67]
    s_add_u32 m0, s47, 0
    s_mov_b64 exec, s[32:33]
    buffer_load_dwordx4 v7, s[16:19], s48 offen lds
    s_mov_b64 exec, -1
    s_add_u32 s48, s48, 55296
    s_waitcnt lgkmcnt(9)
    v_mfma_f32_32x32x16_bf16 v[176:191], a[36:39], v[72:75], v[176:191]
    ds_read_b64_tr_b16 a[54:55], v9 offset:13312
    ds_read_b64_tr_b16 a[56:57], v10 offset:12288
    ds_read_b64_tr_b16 a[58:59], v10 offset:13312
    v_mfma_f32_4x4x4_16b_bf16 a[64:67], v[74:75], v[74:75], a[64:67]
    s_waitcnt lgkmcnt(10)
    v_mfma_f32_32x32x16_bf16 v[192:207], a[40:43], v[72:75], v[192:207]
    ds_read_b64_tr_b16 a[60:61], v11 offset:12288
    ds_read_b64_tr_b16 a[62:63], v11 offset:13312
    ds_read_b64_tr_b16 v[228:229], v12 offset:12288
    s_waitcnt lgkmcnt(9)
    v_mfma_f32_4x4x4_16b_bf16 a[68:71], v[224:225], v[248:249], a[68:71]
    s_add_u32 m0, s47, 4096
    s_mov_b64 exec, s[32:33]
    buffer_load_dwordx4 v7, s[16:19], s48 offen lds
    s_mov_b64 exec, -1
    s_add_u32 s48, s48, 55296
    s_waitcnt lgkmcnt(11)
    v_mfma_f32_32x32x16_bf16 v[208:223], a[44:47], v[72:75], v[208:223]
    ds_read_b64_tr_b16 v[230:231], v12 offset:13312
    v_mfma_f32_4x4x4_16b_bf16 a[68:71], v[226:227], v[248:249], a[68:71]
    s_waitcnt lgkmcnt(8)
    v_mfma_f32_32x32x16_bf16 v[160:175], a[48:51], v[76:79], v[160:175]
    ds_read_b64_tr_b16 a[32:33], v8 offset:16384
    ds_read_b64_tr_b16 a[34:35], v8 offset:17408
    ds_read_b64_tr_b16 a[36:37], v9 offset:16384
    v_mfma_f32_4x4x4_16b_bf16 a[64:67], v[76:77], v[76:77], a[64:67]
    s_add_u32 m0, s47, 8192
    s_mov_b64 exec, s[32:33]
    buffer_load_dwordx4 v7, s[16:19], s48 offen lds
    s_mov_b64 exec, -1
    s_add_u32 s48, s48, 55296
    s_waitcnt lgkmcnt(9)
    v_mfma_f32_32x32x16_bf16 v[176:191], a[52:55], v[76:79], v[176:191]
    ds_read_b64_tr_b16 a[38:39], v9 offset:17408
    ds_read_b64_tr_b16 a[40:41], v10 offset:16384
    ds_read_b64_tr_b16 a[42:43], v10 offset:17408
    v_mfma_f32_4x4x4_16b_bf16 a[64:67], v[78:79], v[78:79], a[64:67]
    s_waitcnt lgkmcnt(10)
    v_mfma_f32_32x32x16_bf16 v[192:207], a[56:59], v[76:79], v[192:207]
    ds_read_b64_tr_b16 a[44:45], v11 offset:16384
    ds_read_b64_tr_b16 a[46:47], v11 offset:17408
    ds_read_b64_tr_b16 v[224:225], v12 offset:16384
    s_waitcnt lgkmcnt(9)
    v_mfma_f32_4x4x4_16b_bf16 a[68:71], v[228:229], v[248:249], a[68:71]
    s_add_u32 m0, s47, 12288
    s_mov_b64 exec, s[32:33]
    buffer_load_dwordx4 v7, s[16:19], s48 offen lds
    s_mov_b64 exec, -1
    s_add_u32 s48, s48, 55296
    s_waitcnt lgkmcnt(11)
    v_mfma_f32_32x32x16_bf16 v[208:223], a[60:63], v[76:79], v[208:223]
    ds_read_b64_tr_b16 v[226:227], v12 offset:17408
    v_mfma_f32_4x4x4_16b_bf16 a[68:71], v[230:231], v[248:249], a[68:71]
    s_waitcnt vmcnt(8)
    s_barrier
    ds_read_b128 v[96:99], v234 offset:4096
    ds_read_b128 v[100:103], v235 offset:4096
    ds_read_b128 v[104:107], v236 offset:4096
    ds_read_b128 v[108:111], v237 offset:4096
    s_waitcnt lgkmcnt(12)
    v_mfma_f32_32x32x16_bf16 v[160:175], a[32:35], v[80:83], v[160:175]
    ds_read_b64_tr_b16 a[48:49], v8 offset:20480
    ds_read_b64_tr_b16 a[50:51], v8 offset:21504
    ds_read_b64_tr_b16 a[52:53], v9 offset:20480
    v_mfma_f32_4x4x4_16b_bf16 a[64:67], v[80:81], v[80:81], a[64:67]
    s_add_u32 m0, s49, 12288
    s_mov_b32 s63, 896
    buffer_load_dwordx4 v3, s[12:15], s63 offen offset:0 lds
    s_waitcnt lgkmcnt(13)
    v_mfma_f32_32x32x16_bf16 v[176:191], a[36:39], v[80:83], v[176:191]
    ds_read_b64_tr_b16 a[54:55], v9 offset:21504
    ds_read_b64_tr_b16 a[56:57], v10 offset:20480
    ds_read_b64_tr_b16 a[58:59], v10 offset:21504
    v_mfma_f32_4x4x4_16b_bf16 a[64:67], v[82:83], v[82:83], a[64:67]
    s_waitcnt lgkmcnt(14)
    v_mfma_f32_32x32x16_bf16 v[192:207], a[40:43], v[80:83], v[192:207]
    ds_read_b64_tr_b16 a[60:61], v11 offset:20480
    ds_read_b64_tr_b16 a[62:63], v11 offset:21504
    ds_read_b64_tr_b16 v[228:229], v12 offset:20480
    s_waitcnt lgkmcnt(13)
    v_mfma_f32_4x4x4_16b_bf16 a[68:71], v[224:225], v[248:249], a[68:71]
    buffer_load_dwordx4 v4, s[12:15], s63 offen offset:1024 lds
    s_waitcnt lgkmcnt(15)
    v_mfma_f32_32x32x16_bf16 v[208:223], a[44:47], v[80:83], v[208:223]
    ds_read_b64_tr_b16 v[230:231], v12 offset:21504
    v_mfma_f32_4x4x4_16b_bf16 a[68:71], v[226:227], v[248:249], a[68:71]
    s_waitcnt lgkmcnt(8)
    v_mfma_f32_32x32x16_bf16 v[160:175], a[48:51], v[84:87], v[160:175]
    ds_read_b64_tr_b16 a[32:33], v8 offset:24576
    ds_read_b64_tr_b16 a[34:35], v8 offset:25600
    ds_read_b64_tr_b16 a[36:37], v9 offset:24576
    v_mfma_f32_4x4x4_16b_bf16 a[64:67], v[84:85], v[84:85], a[64:67]
    buffer_load_dwordx4 v5, s[12:15], s63 offen offset:2048 lds
    s_waitcnt lgkmcnt(9)
    v_mfma_f32_32x32x16_bf16 v[176:191], a[52:55], v[84:87], v[176:191]
    ds_read_b64_tr_b16 a[38:39], v9 offset:25600
    ds_read_b64_tr_b16 a[40:41], v10 offset:24576
    ds_read_b64_tr_b16 a[42:43], v10 offset:25600
    v_mfma_f32_4x4x4_16b_bf16 a[64:67], v[86:87], v[86:87], a[64:67]
    s_waitcnt lgkmcnt(10)
    v_mfma_f32_32x32x16_bf16 v[192:207], a[56:59], v[84:87], v[192:207]
    ds_read_b64_tr_b16 a[44:45], v11 offset:24576
    ds_read_b64_tr_b16 a[46:47], v11 offset:25600
    ds_read_b64_tr_b16 v[224:225], v12 offset:24576
    s_waitcnt lgkmcnt(9)
    v_mfma_f32_4x4x4_16b_bf16 a[68:71], v[228:229], v[248:249], a[68:71]
    buffer_load_dwordx4 v6, s[12:15], s63 offen offset:3072 lds
    s_waitcnt lgkmcnt(11)
    v_mfma_f32_32x32x16_bf16 v[208:223], a[60:63], v[84:87], v[208:223]
    ds_read_b64_tr_b16 v[226:227], v12 offset:25600
    v_mfma_f32_4x4x4_16b_bf16 a[68:71], v[230:231], v[248:249], a[68:71]
    s_waitcnt lgkmcnt(8)
    v_mfma_f32_32x32x16_bf16 v[160:175], a[32:35], v[88:91], v[160:175]
    ds_read_b64_tr_b16 a[48:49], v8 offset:28672
    ds_read_b64_tr_b16 a[50:51], v8 offset:29696
    ds_read_b64_tr_b16 a[52:53], v9 offset:28672
    v_mfma_f32_4x4x4_16b_bf16 a[64:67], v[88:89], v[88:89], a[64:67]
    s_add_u32 m0, s47, 16384
    s_mov_b64 exec, s[32:33]
    buffer_load_dwordx4 v7, s[16:19], s48 offen lds
    s_mov_b64 exec, -1
    s_add_u32 s48, s48, 55296
    s_waitcnt lgkmcnt(9)
    v_mfma_f32_32x32x16_bf16 v[176:191], a[36:39], v[88:91], v[176:191]
    ds_read_b64_tr_b16 a[54:55], v9 offset:29696
    ds_read_b64_tr_b16 a[56:57], v10 offset:28672
    ds_read_b64_tr_b16 a[58:59], v10 offset:29696
    v_mfma_f32_4x4x4_16b_bf16 a[64:67], v[90:91], v[90:91], a[64:67]
    s_waitcnt lgkmcnt(10)
    v_mfma_f32_32x32x16_bf16 v[192:207], a[40:43], v[88:91], v[192:207]
    ds_read_b64_tr_b16 a[60:61], v11 offset:28672
    ds_read_b64_tr_b16 a[62:63], v11 offset:29696
    ds_read_b64_tr_b16 v[228:229], v12 offset:28672
    s_waitcnt lgkmcnt(9)
    v_mfma_f32_4x4x4_16b_bf16 a[68:71], v[224:225], v[248:249], a[68:71]
    s_add_u32 m0, s47, 20480
    s_mov_b64 exec, s[32:33]
    buffer_load_dwordx4 v7, s[16:19], s48 offen lds
    s_mov_b64 exec, -1
    s_add_u32 s48, s48, 55296
    s_waitcnt lgkmcnt(11)
    v_mfma_f32_32x32x16_bf16 v[208:223], a[44:47], v[88:91], v[208:223]
    ds_read_b64_tr_b16 v[230:231], v12 offset:29696
    v_mfma_f32_4x4x4_16b_bf16 a[68:71], v[226:227], v[248:249], a[68:71]
    s_waitcnt lgkmcnt(8)
    v_mfma_f32_32x32x16_bf16 v[160:175], a[48:51], v[92:95], v[160:175]
    ds_read_b64_tr_b16 a[32:33], v8 offset:32768
    ds_read_b64_tr_b16 a[34:35], v8 offset:33792
    ds_read_b64_tr_b16 a[36:37], v9 offset:32768
    v_mfma_f32_4x4x4_16b_bf16 a[64:67], v[92:93], v[92:93], a[64:67]
    s_add_u32 m0, s47, 24576
    s_mov_b64 exec, s[32:33]
    buffer_load_dwordx4 v7, s[16:19], s48 offen lds
    s_mov_b64 exec, -1
    s_add_u32 s48, s48, 55296
    s_waitcnt lgkmcnt(9)
    v_mfma_f32_32x32x16_bf16 v[176:191], a[52:55], v[92:95], v[176:191]
    ds_read_b64_tr_b16 a[38:39], v9 offset:33792
    ds_read_b64_tr_b16 a[40:41], v10 offset:32768
    ds_read_b64_tr_b16 a[42:43], v10 offset:33792
    v_mfma_f32_4x4x4_16b_bf16 a[64:67], v[94:95], v[94:95], a[64:67]
    s_waitcnt lgkmcnt(10)
    v_mfma_f32_32x32x16_bf16 v[192:207], a[56:59], v[92:95], v[192:207]
    ds_read_b64_tr_b16 a[44:45], v11 offset:32768
    ds_read_b64_tr_b16 a[46:47], v11 offset:33792
    ds_read_b64_tr_b16 v[224:225], v12 offset:32768
    s_waitcnt lgkmcnt(9)
    v_mfma_f32_4x4x4_16b_bf16 a[68:71], v[228:229], v[248:249], a[68:71]
    s_add_u32 m0, s47, 28672
    s_mov_b64 exec, s[32:33]
    buffer_load_dwordx4 v7, s[16:19], s48 offen lds
    s_mov_b64 exec, -1
    s_add_u32 s48, s48, 55296
    s_waitcnt lgkmcnt(11)
    v_mfma_f32_32x32x16_bf16 v[208:223], a[60:63], v[92:95], v[208:223]
    ds_read_b64_tr_b16 v[226:227], v12 offset:33792
    v_mfma_f32_4x4x4_16b_bf16 a[68:71], v[230:231], v[248:249], a[68:71]
    s_waitcnt vmcnt(8)
    s_barrier
    ds_read_b128 v[112:115], v234 offset:8192
    ds_read_b128 v[116:119], v235 offset:8192
    ds_read_b128 v[120:123], v236 offset:8192
    ds_read_b128 v[124:127], v237 offset:8192
    s_waitcnt lgkmcnt(12)
    v_mfma_f32_32x32x16_bf16 v[160:175], a[32:35], v[96:99], v[160:175]
    ds_read_b64_tr_b16 a[48:49], v8 offset:36864
    ds_read_b64_tr_b16 a[50:51], v8 offset:37888
    ds_read_b64_tr_b16 a[52:53], v9 offset:36864
    v_mfma_f32_4x4x4_16b_bf16 a[64:67], v[96:97], v[96:97], a[64:67]
    s_add_u32 m0, s49, 0
    s_mov_b32 s63, 1024
    buffer_load_dwordx4 v3, s[12:15], s63 offen offset:0 lds
    s_waitcnt lgkmcnt(13)
    v_mfma_f32_32x32x16_bf16 v[176:191], a[36:39], v[96:99], v[176:191]
    ds_read_b64_tr_b16 a[54:55], v9 offset:37888
    ds_read_b64_tr_b16 a[56:57], v10 offset:36864
    ds_read_b64_tr_b16 a[58:59], v10 offset:37888
    v_mfma_f32_4x4x4_16b_bf16 a[64:67], v[98:99], v[98:99], a[64:67]
    s_waitcnt lgkmcnt(14)
    v_mfma_f32_32x32x16_bf16 v[192:207], a[40:43], v[96:99], v[192:207]
    ds_read_b64_tr_b16 a[60:61], v11 offset:36864
    ds_read_b64_tr_b16 a[62:63], v11 offset:37888
    ds_read_b64_tr_b16 v[228:229], v12 offset:36864
    s_waitcnt lgkmcnt(13)
    v_mfma_f32_4x4x4_16b_bf16 a[68:71], v[224:225], v[248:249], a[68:71]
    buffer_load_dwordx4 v4, s[12:15], s63 offen offset:1024 lds
    s_waitcnt lgkmcnt(15)
    v_mfma_f32_32x32x16_bf16 v[208:223], a[44:47], v[96:99], v[208:223]
    ds_read_b64_tr_b16 v[230:231], v12 offset:37888
    v_mfma_f32_4x4x4_16b_bf16 a[68:71], v[226:227], v[248:249], a[68:71]
    s_waitcnt lgkmcnt(8)
    v_mfma_f32_32x32x16_bf16 v[160:175], a[48:51], v[100:103], v[160:175]
    ds_read_b64_tr_b16 a[32:33], v8 offset:40960
    ds_read_b64_tr_b16 a[34:35], v8 offset:41984
    ds_read_b64_tr_b16 a[36:37], v9 offset:40960
    v_mfma_f32_4x4x4_16b_bf16 a[64:67], v[100:101], v[100:101], a[64:67]
    buffer_load_dwordx4 v5, s[12:15], s63 offen offset:2048 lds
    s_waitcnt lgkmcnt(9)
    v_mfma_f32_32x32x16_bf16 v[176:191], a[52:55], v[100:103], v[176:191]
    ds_read_b64_tr_b16 a[38:39], v9 offset:41984
    ds_read_b64_tr_b16 a[40:41], v10 offset:40960
    ds_read_b64_tr_b16 a[42:43], v10 offset:41984
    v_mfma_f32_4x4x4_16b_bf16 a[64:67], v[102:103], v[102:103], a[64:67]
    s_waitcnt lgkmcnt(10)
    v_mfma_f32_32x32x16_bf16 v[192:207], a[56:59], v[100:103], v[192:207]
    ds_read_b64_tr_b16 a[44:45], v11 offset:40960
    ds_read_b64_tr_b16 a[46:47], v11 offset:41984
    ds_read_b64_tr_b16 v[224:225], v12 offset:40960
    s_waitcnt lgkmcnt(9)
    v_mfma_f32_4x4x4_16b_bf16 a[68:71], v[228:229], v[248:249], a[68:71]
    buffer_load_dwordx4 v6, s[12:15], s63 offen offset:3072 lds
    s_waitcnt lgkmcnt(11)
    v_mfma_f32_32x32x16_bf16 v[208:223], a[60:63], v[100:103], v[208:223]
    ds_read_b64_tr_b16 v[226:227], v12 offset:41984
    v_mfma_f32_4x4x4_16b_bf16 a[68:71], v[230:231], v[248:249], a[68:71]
    s_waitcnt lgkmcnt(8)
    v_mfma_f32_32x32x16_bf16 v[160:175], a[32:35], v[104:107], v[160:175]
    ds_read_b64_tr_b16 a[48:49], v8 offset:45056
    ds_read_b64_tr_b16 a[50:51], v8 offset:46080
    ds_read_b64_tr_b16 a[52:53], v9 offset:45056
    v_mfma_f32_4x4x4_16b_bf16 a[64:67], v[104:105], v[104:105], a[64:67]
    s_add_u32 m0, s47, 32768
    s_mov_b64 exec, s[32:33]
    buffer_load_dwordx4 v7, s[16:19], s48 offen lds
    s_mov_b64 exec, -1
    s_add_u32 s48, s48, 55296
    s_waitcnt lgkmcnt(9)
    v_mfma_f32_32x32x16_bf16 v[176:191], a[36:39], v[104:107], v[176:191]
    ds_read_b64_tr_b16 a[54:55], v9 offset:46080
    ds_read_b64_tr_b16 a[56:57], v10 offset:45056
    ds_read_b64_tr_b16 a[58:59], v10 offset:46080
    v_mfma_f32_4x4x4_16b_bf16 a[64:67], v[106:107], v[106:107], a[64:67]
    s_waitcnt lgkmcnt(10)
    v_mfma_f32_32x32x16_bf16 v[192:207], a[40:43], v[104:107], v[192:207]
    ds_read_b64_tr_b16 a[60:61], v11 offset:45056
    ds_read_b64_tr_b16 a[62:63], v11 offset:46080
    ds_read_b64_tr_b16 v[228:229], v12 offset:45056
    s_waitcnt lgkmcnt(9)
    v_mfma_f32_4x4x4_16b_bf16 a[68:71], v[224:225], v[248:249], a[68:71]
    s_add_u32 m0, s47, 36864
    s_mov_b64 exec, s[32:33]
    buffer_load_dwordx4 v7, s[16:19], s48 offen lds
    s_mov_b64 exec, -1
    s_add_u32 s48, s48, 55296
    s_waitcnt lgkmcnt(11)
    v_mfma_f32_32x32x16_bf16 v[208:223], a[44:47], v[104:107], v[208:223]
    ds_read_b64_tr_b16 v[230:231], v12 offset:46080
    v_mfma_f32_4x4x4_16b_bf16 a[68:71], v[226:227], v[248:249], a[68:71]
    s_waitcnt lgkmcnt(8)
    v_mfma_f32_32x32x16_bf16 v[160:175], a[48:51], v[108:111], v[160:175]
    v_subrev_u32 v8, 49152, v8
    v_subrev_u32 v9, 49152, v9
    v_subrev_u32 v10, 49152, v10
    v_subrev_u32 v11, 49152, v11
    v_subrev_u32 v12, 49152, v12
    ds_read_b64_tr_b16 a[32:33], v8 offset:0
    ds_read_b64_tr_b16 a[34:35], v8 offset:1024
    v_mfma_f32_4x4x4_16b_bf16 a[64:67], v[108:109], v[108:109], a[64:67]
    s_add_u32 m0, s47, 40960
    s_mov_b64 exec, s[32:33]
    buffer_load_dwordx4 v7, s[16:19], s48 offen lds
    s_mov_b64 exec, -1
    s_add_u32 s48, s48, 55296
    s_waitcnt lgkmcnt(8)
    v_mfma_f32_32x32x16_bf16 v[176:191], a[52:55], v[108:111], v[176:191]
    ds_read_b64_tr_b16 a[36:37], v9 offset:0
    ds_read_b64_tr_b16 a[38:39], v9 offset:1024
    ds_read_b64_tr_b16 a[40:41], v10 offset:0
    v_mfma_f32_4x4x4_16b_bf16 a[64:67], v[110:111], v[110:111], a[64:67]
    s_waitcnt lgkmcnt(9)
    v_mfma_f32_32x32x16_bf16 v[192:207], a[56:59], v[108:111], v[192:207]
    ds_read_b64_tr_b16 a[42:43], v10 offset:1024
    ds_read_b64_tr_b16 a[44:45], v11 offset:0
    ds_read_b64_tr_b16 a[46:47], v11 offset:1024
    s_waitcnt lgkmcnt(8)
    v_mfma_f32_4x4x4_16b_bf16 a[68:71], v[228:229], v[248:249], a[68:71]
    s_add_u32 m0, s47, 45056
    s_mov_b64 exec, s[32:33]
    buffer_load_dwordx4 v7, s[16:19], s48 offen lds
    s_mov_b64 exec, -1
    s_add_u32 s48, s48, 55296
    s_waitcnt lgkmcnt(10)
    v_mfma_f32_32x32x16_bf16 v[208:223], a[60:63], v[108:111], v[208:223]
    ds_read_b64_tr_b16 v[224:225], v12 offset:0
    ds_read_b64_tr_b16 v[226:227], v12 offset:1024
    v_mfma_f32_4x4x4_16b_bf16 a[68:71], v[230:231], v[248:249], a[68:71]
    s_waitcnt vmcnt(8)
    s_barrier
    ds_read_b128 v[128:131], v234 offset:12288
    ds_read_b128 v[132:135], v235 offset:12288
    ds_read_b128 v[136:139], v236 offset:12288
    ds_read_b128 v[140:143], v237 offset:12288
    s_waitcnt lgkmcnt(12)
    v_mfma_f32_32x32x16_bf16 v[160:175], a[32:35], v[112:115], v[160:175]
    ds_read_b64_tr_b16 a[48:49], v8 offset:4096
    ds_read_b64_tr_b16 a[50:51], v8 offset:5120
    ds_read_b64_tr_b16 a[52:53], v9 offset:4096
    v_mfma_f32_4x4x4_16b_bf16 a[64:67], v[112:113], v[112:113], a[64:67]
    s_waitcnt lgkmcnt(13)
    v_mfma_f32_32x32x16_bf16 v[176:191], a[36:39], v[112:115], v[176:191]
    ds_read_b64_tr_b16 a[54:55], v9 offset:5120
    ds_read_b64_tr_b16 a[56:57], v10 offset:4096
    ds_read_b64_tr_b16 a[58:59], v10 offset:5120
    v_mfma_f32_4x4x4_16b_bf16 a[64:67], v[114:115], v[114:115], a[64:67]
    s_waitcnt lgkmcnt(14)
    v_mfma_f32_32x32x16_bf16 v[192:207], a[40:43], v[112:115], v[192:207]
    ds_read_b64_tr_b16 a[60:61], v11 offset:4096
    ds_read_b64_tr_b16 a[62:63], v11 offset:5120
    ds_read_b64_tr_b16 v[228:229], v12 offset:4096
    s_waitcnt lgkmcnt(13)
    v_mfma_f32_4x4x4_16b_bf16 a[68:71], v[224:225], v[248:249], a[68:71]
    s_waitcnt lgkmcnt(15)
    v_mfma_f32_32x32x16_bf16 v[208:223], a[44:47], v[112:115], v[208:223]
    ds_read_b64_tr_b16 v[230:231], v12 offset:5120
    v_mfma_f32_4x4x4_16b_bf16 a[68:71], v[226:227], v[248:249], a[68:71]
    s_waitcnt lgkmcnt(8)
    v_mfma_f32_32x32x16_bf16 v[160:175], a[48:51], v[116:119], v[160:175]
    ds_read_b64_tr_b16 a[32:33], v8 offset:8192
    ds_read_b64_tr_b16 a[34:35], v8 offset:9216
    ds_read_b64_tr_b16 a[36:37], v9 offset:8192
    v_mfma_f32_4x4x4_16b_bf16 a[64:67], v[116:117], v[116:117], a[64:67]
    s_waitcnt lgkmcnt(9)
    v_mfma_f32_32x32x16_bf16 v[176:191], a[52:55], v[116:119], v[176:191]
    ds_read_b64_tr_b16 a[38:39], v9 offset:9216
    ds_read_b64_tr_b16 a[40:41], v10 offset:8192
    ds_read_b64_tr_b16 a[42:43], v10 offset:9216
    v_mfma_f32_4x4x4_16b_bf16 a[64:67], v[118:119], v[118:119], a[64:67]
    s_waitcnt lgkmcnt(10)
    v_mfma_f32_32x32x16_bf16 v[192:207], a[56:59], v[116:119], v[192:207]
    ds_read_b64_tr_b16 a[44:45], v11 offset:8192
    ds_read_b64_tr_b16 a[46:47], v11 offset:9216
    ds_read_b64_tr_b16 v[224:225], v12 offset:8192
    s_waitcnt lgkmcnt(9)
    v_mfma_f32_4x4x4_16b_bf16 a[68:71], v[228:229], v[248:249], a[68:71]
    s_waitcnt lgkmcnt(11)
    v_mfma_f32_32x32x16_bf16 v[208:223], a[60:63], v[116:119], v[208:223]
    ds_read_b64_tr_b16 v[226:227], v12 offset:9216
    v_mfma_f32_4x4x4_16b_bf16 a[68:71], v[230:231], v[248:249], a[68:71]
    s_waitcnt lgkmcnt(8)
    v_mfma_f32_32x32x16_bf16 v[160:175], a[32:35], v[120:123], v[160:175]
    ds_read_b64_tr_b16 a[48:49], v8 offset:12288
    ds_read_b64_tr_b16 a[50:51], v8 offset:13312
    ds_read_b64_tr_b16 a[52:53], v9 offset:12288
    v_mfma_f32_4x4x4_16b_bf16 a[64:67], v[120:121], v[120:121], a[64:67]
    s_waitcnt lgkmcnt(9)
    v_mfma_f32_32x32x16_bf16 v[176:191], a[36:39], v[120:123], v[176:191]
    ds_read_b64_tr_b16 a[54:55], v9 offset:13312
    ds_read_b64_tr_b16 a[56:57], v10 offset:12288
    ds_read_b64_tr_b16 a[58:59], v10 offset:13312
    v_mfma_f32_4x4x4_16b_bf16 a[64:67], v[122:123], v[122:123], a[64:67]
    s_waitcnt lgkmcnt(10)
    v_mfma_f32_32x32x16_bf16 v[192:207], a[40:43], v[120:123], v[192:207]
    ds_read_b64_tr_b16 a[60:61], v11 offset:12288
    ds_read_b64_tr_b16 a[62:63], v11 offset:13312
    ds_read_b64_tr_b16 v[228:229], v12 offset:12288
    s_waitcnt lgkmcnt(9)
    v_mfma_f32_4x4x4_16b_bf16 a[68:71], v[224:225], v[248:249], a[68:71]
    s_waitcnt lgkmcnt(11)
    v_mfma_f32_32x32x16_bf16 v[208:223], a[44:47], v[120:123], v[208:223]
    ds_read_b64_tr_b16 v[230:231], v12 offset:13312
    v_mfma_f32_4x4x4_16b_bf16 a[68:71], v[226:227], v[248:249], a[68:71]
    s_waitcnt lgkmcnt(8)
    v_mfma_f32_32x32x16_bf16 v[160:175], a[48:51], v[124:127], v[160:175]
    ds_read_b64_tr_b16 a[32:33], v8 offset:16384
    ds_read_b64_tr_b16 a[34:35], v8 offset:17408
    ds_read_b64_tr_b16 a[36:37], v9 offset:16384
    v_mfma_f32_4x4x4_16b_bf16 a[64:67], v[124:125], v[124:125], a[64:67]
    s_waitcnt lgkmcnt(9)
    v_mfma_f32_32x32x16_bf16 v[176:191], a[52:55], v[124:127], v[176:191]
    ds_read_b64_tr_b16 a[38:39], v9 offset:17408
    ds_read_b64_tr_b16 a[40:41], v10 offset:16384
    ds_read_b64_tr_b16 a[42:43], v10 offset:17408
    v_mfma_f32_4x4x4_16b_bf16 a[64:67], v[126:127], v[126:127], a[64:67]
    s_waitcnt lgkmcnt(10)
    v_mfma_f32_32x32x16_bf16 v[192:207], a[56:59], v[124:127], v[192:207]
    ds_read_b64_tr_b16 a[44:45], v11 offset:16384
    ds_read_b64_tr_b16 a[46:47], v11 offset:17408
    ds_read_b64_tr_b16 v[224:225], v12 offset:16384
    s_waitcnt lgkmcnt(9)
    v_mfma_f32_4x4x4_16b_bf16 a[68:71], v[228:229], v[248:249], a[68:71]
    s_waitcnt lgkmcnt(11)
    v_mfma_f32_32x32x16_bf16 v[208:223], a[60:63], v[124:127], v[208:223]
    ds_read_b64_tr_b16 v[226:227], v12 offset:17408
    v_mfma_f32_4x4x4_16b_bf16 a[68:71], v[230:231], v[248:249], a[68:71]
    s_waitcnt vmcnt(0)
    s_barrier
    v_lshlrev_b32 v246, 7, v0
    v_cmp_gt_u32 vcc, 162, v0
    s_mul_i32 s36, s2, 20736
    s_mul_i32 s37, s2, 2688
    v_cndmask_b32 v247, v255, v246, vcc
    v_cmp_gt_u32 vcc, 21, v0
    s_mov_b32 s12, s64
    s_mov_b32 s13, s65
    s_mov_b32 s14, 0x510000
    s_mov_b32 s15, 0x00020000
    buffer_load_dword v252, v247, s[12:15], s36 offen
    v_cndmask_b32 v246, v255, v246, vcc
    s_mov_b32 s16, s78
    s_mov_b32 s17, s79
    s_mov_b32 s18, 0xa2000
    s_mov_b32 s19, 0x00020000
    buffer_load_dword v253, v246, s[16:19], s37 offen
    ds_read_b128 v[144:147], v234 offset:0
    ds_read_b128 v[148:151], v235 offset:0
    ds_read_b128 v[152:155], v236 offset:0
    ds_read_b128 v[156:159], v237 offset:0
    s_waitcnt lgkmcnt(12)
    v_mfma_f32_32x32x16_bf16 v[160:175], a[32:35], v[128:131], v[160:175]
    ds_read_b64_tr_b16 a[48:49], v8 offset:20480
    ds_read_b64_tr_b16 a[50:51], v8 offset:21504
    ds_read_b64_tr_b16 a[52:53], v9 offset:20480
    v_mfma_f32_4x4x4_16b_bf16 a[64:67], v[128:129], v[128:129], a[64:67]
    s_waitcnt lgkmcnt(13)
    v_mfma_f32_32x32x16_bf16 v[176:191], a[36:39], v[128:131], v[176:191]
    ds_read_b64_tr_b16 a[54:55], v9 offset:21504
    ds_read_b64_tr_b16 a[56:57], v10 offset:20480
    ds_read_b64_tr_b16 a[58:59], v10 offset:21504
    v_mfma_f32_4x4x4_16b_bf16 a[64:67], v[130:131], v[130:131], a[64:67]
    s_waitcnt lgkmcnt(14)
    v_mfma_f32_32x32x16_bf16 v[192:207], a[40:43], v[128:131], v[192:207]
    ds_read_b64_tr_b16 a[60:61], v11 offset:20480
    ds_read_b64_tr_b16 a[62:63], v11 offset:21504
    ds_read_b64_tr_b16 v[228:229], v12 offset:20480
    s_waitcnt lgkmcnt(13)
    v_mfma_f32_4x4x4_16b_bf16 a[68:71], v[224:225], v[248:249], a[68:71]
    s_waitcnt lgkmcnt(15)
    v_mfma_f32_32x32x16_bf16 v[208:223], a[44:47], v[128:131], v[208:223]
    ds_read_b64_tr_b16 v[230:231], v12 offset:21504
    v_mfma_f32_4x4x4_16b_bf16 a[68:71], v[226:227], v[248:249], a[68:71]
    s_waitcnt lgkmcnt(8)
    v_mfma_f32_32x32x16_bf16 v[160:175], a[48:51], v[132:135], v[160:175]
    ds_read_b64_tr_b16 a[32:33], v8 offset:24576
    ds_read_b64_tr_b16 a[34:35], v8 offset:25600
    ds_read_b64_tr_b16 a[36:37], v9 offset:24576
    v_mfma_f32_4x4x4_16b_bf16 a[64:67], v[132:133], v[132:133], a[64:67]
    s_waitcnt lgkmcnt(9)
    v_mfma_f32_32x32x16_bf16 v[176:191], a[52:55], v[132:135], v[176:191]
    ds_read_b64_tr_b16 a[38:39], v9 offset:25600
    ds_read_b64_tr_b16 a[40:41], v10 offset:24576
    ds_read_b64_tr_b16 a[42:43], v10 offset:25600
    v_mfma_f32_4x4x4_16b_bf16 a[64:67], v[134:135], v[134:135], a[64:67]
    s_waitcnt lgkmcnt(10)
    v_mfma_f32_32x32x16_bf16 v[192:207], a[56:59], v[132:135], v[192:207]
    ds_read_b64_tr_b16 a[44:45], v11 offset:24576
    ds_read_b64_tr_b16 a[46:47], v11 offset:25600
    ds_read_b64_tr_b16 v[224:225], v12 offset:24576
    s_waitcnt lgkmcnt(9)
    v_mfma_f32_4x4x4_16b_bf16 a[68:71], v[228:229], v[248:249], a[68:71]
    s_waitcnt lgkmcnt(11)
    v_mfma_f32_32x32x16_bf16 v[208:223], a[60:63], v[132:135], v[208:223]
    ds_read_b64_tr_b16 v[226:227], v12 offset:25600
    v_mfma_f32_4x4x4_16b_bf16 a[68:71], v[230:231], v[248:249], a[68:71]
    s_waitcnt lgkmcnt(8)
    v_mfma_f32_32x32x16_bf16 v[160:175], a[32:35], v[136:139], v[160:175]
    ds_read_b64_tr_b16 a[48:49], v8 offset:28672
    ds_read_b64_tr_b16 a[50:51], v8 offset:29696
    ds_read_b64_tr_b16 a[52:53], v9 offset:28672
    v_mfma_f32_4x4x4_16b_bf16 a[64:67], v[136:137], v[136:137], a[64:67]
    s_waitcnt lgkmcnt(9)
    v_mfma_f32_32x32x16_bf16 v[176:191], a[36:39], v[136:139], v[176:191]
    ds_read_b64_tr_b16 a[54:55], v9 offset:29696
    ds_read_b64_tr_b16 a[56:57], v10 offset:28672
    ds_read_b64_tr_b16 a[58:59], v10 offset:29696
    v_mfma_f32_4x4x4_16b_bf16 a[64:67], v[138:139], v[138:139], a[64:67]
    s_waitcnt lgkmcnt(10)
    v_mfma_f32_32x32x16_bf16 v[192:207], a[40:43], v[136:139], v[192:207]
    ds_read_b64_tr_b16 a[60:61], v11 offset:28672
    ds_read_b64_tr_b16 a[62:63], v11 offset:29696
    ds_read_b64_tr_b16 v[228:229], v12 offset:28672
    s_waitcnt lgkmcnt(9)
    v_mfma_f32_4x4x4_16b_bf16 a[68:71], v[224:225], v[248:249], a[68:71]
    s_waitcnt lgkmcnt(11)
    v_mfma_f32_32x32x16_bf16 v[208:223], a[44:47], v[136:139], v[208:223]
    ds_read_b64_tr_b16 v[230:231], v12 offset:29696
    v_mfma_f32_4x4x4_16b_bf16 a[68:71], v[226:227], v[248:249], a[68:71]
    s_waitcnt lgkmcnt(8)
    v_mfma_f32_32x32x16_bf16 v[160:175], a[48:51], v[140:143], v[160:175]
    ds_read_b64_tr_b16 a[32:33], v8 offset:32768
    ds_read_b64_tr_b16 a[34:35], v8 offset:33792
    ds_read_b64_tr_b16 a[36:37], v9 offset:32768
    v_mfma_f32_4x4x4_16b_bf16 a[64:67], v[140:141], v[140:141], a[64:67]
    s_waitcnt lgkmcnt(9)
    v_mfma_f32_32x32x16_bf16 v[176:191], a[52:55], v[140:143], v[176:191]
    ds_read_b64_tr_b16 a[38:39], v9 offset:33792
    ds_read_b64_tr_b16 a[40:41], v10 offset:32768
    ds_read_b64_tr_b16 a[42:43], v10 offset:33792
    v_mfma_f32_4x4x4_16b_bf16 a[64:67], v[142:143], v[142:143], a[64:67]
    s_waitcnt lgkmcnt(10)
    v_mfma_f32_32x32x16_bf16 v[192:207], a[56:59], v[140:143], v[192:207]
    ds_read_b64_tr_b16 a[44:45], v11 offset:32768
    ds_read_b64_tr_b16 a[46:47], v11 offset:33792
    ds_read_b64_tr_b16 v[224:225], v12 offset:32768
    s_waitcnt lgkmcnt(9)
    v_mfma_f32_4x4x4_16b_bf16 a[68:71], v[228:229], v[248:249], a[68:71]
    s_waitcnt lgkmcnt(11)
    v_mfma_f32_32x32x16_bf16 v[208:223], a[60:63], v[140:143], v[208:223]
    ds_read_b64_tr_b16 v[226:227], v12 offset:33792
    v_mfma_f32_4x4x4_16b_bf16 a[68:71], v[230:231], v[248:249], a[68:71]
    s_waitcnt lgkmcnt(8)
    v_mfma_f32_32x32x16_bf16 v[160:175], a[32:35], v[144:147], v[160:175]
    ds_read_b64_tr_b16 a[48:49], v8 offset:36864
    ds_read_b64_tr_b16 a[50:51], v8 offset:37888
    ds_read_b64_tr_b16 a[52:53], v9 offset:36864
    v_mfma_f32_4x4x4_16b_bf16 a[64:67], v[144:145], v[144:145], a[64:67]
    s_waitcnt lgkmcnt(9)
    v_mfma_f32_32x32x16_bf16 v[176:191], a[36:39], v[144:147], v[176:191]
    ds_read_b64_tr_b16 a[54:55], v9 offset:37888
    ds_read_b64_tr_b16 a[56:57], v10 offset:36864
    ds_read_b64_tr_b16 a[58:59], v10 offset:37888
    v_mfma_f32_4x4x4_16b_bf16 a[64:67], v[146:147], v[146:147], a[64:67]
    s_waitcnt lgkmcnt(10)
    v_mfma_f32_32x32x16_bf16 v[192:207], a[40:43], v[144:147], v[192:207]
    ds_read_b64_tr_b16 a[60:61], v11 offset:36864
    ds_read_b64_tr_b16 a[62:63], v11 offset:37888
    ds_read_b64_tr_b16 v[228:229], v12 offset:36864
    s_waitcnt lgkmcnt(9)
    v_mfma_f32_4x4x4_16b_bf16 a[68:71], v[224:225], v[248:249], a[68:71]
    s_waitcnt lgkmcnt(11)
    v_mfma_f32_32x32x16_bf16 v[208:223], a[44:47], v[144:147], v[208:223]
    ds_read_b64_tr_b16 v[230:231], v12 offset:37888
    v_mfma_f32_4x4x4_16b_bf16 a[68:71], v[226:227], v[248:249], a[68:71]
    s_waitcnt lgkmcnt(8)
    v_mfma_f32_32x32x16_bf16 v[160:175], a[48:51], v[148:151], v[160:175]
    ds_read_b64_tr_b16 a[32:33], v8 offset:40960
    ds_read_b64_tr_b16 a[34:35], v8 offset:41984
    ds_read_b64_tr_b16 a[36:37], v9 offset:40960
    v_mfma_f32_4x4x4_16b_bf16 a[64:67], v[148:149], v[148:149], a[64:67]
    s_waitcnt lgkmcnt(9)
    v_mfma_f32_32x32x16_bf16 v[176:191], a[52:55], v[148:151], v[176:191]
    ds_read_b64_tr_b16 a[38:39], v9 offset:41984
    ds_read_b64_tr_b16 a[40:41], v10 offset:40960
    ds_read_b64_tr_b16 a[42:43], v10 offset:41984
    v_mfma_f32_4x4x4_16b_bf16 a[64:67], v[150:151], v[150:151], a[64:67]
    s_waitcnt lgkmcnt(10)
    v_mfma_f32_32x32x16_bf16 v[192:207], a[56:59], v[148:151], v[192:207]
    ds_read_b64_tr_b16 a[44:45], v11 offset:40960
    ds_read_b64_tr_b16 a[46:47], v11 offset:41984
    ds_read_b64_tr_b16 v[224:225], v12 offset:40960
    s_waitcnt lgkmcnt(9)
    v_mfma_f32_4x4x4_16b_bf16 a[68:71], v[228:229], v[248:249], a[68:71]
    s_waitcnt lgkmcnt(11)
    v_mfma_f32_32x32x16_bf16 v[208:223], a[60:63], v[148:151], v[208:223]
    ds_read_b64_tr_b16 v[226:227], v12 offset:41984
    v_mfma_f32_4x4x4_16b_bf16 a[68:71], v[230:231], v[248:249], a[68:71]
    s_waitcnt lgkmcnt(8)
    v_mfma_f32_32x32x16_bf16 v[160:175], a[32:35], v[152:155], v[160:175]
    ds_read_b64_tr_b16 a[48:49], v8 offset:45056
    ds_read_b64_tr_b16 a[50:51], v8 offset:46080
    ds_read_b64_tr_b16 a[52:53], v9 offset:45056
    v_mfma_f32_4x4x4_16b_bf16 a[64:67], v[152:153], v[152:153], a[64:67]
    s_waitcnt lgkmcnt(9)
    v_mfma_f32_32x32x16_bf16 v[176:191], a[36:39], v[152:155], v[176:191]
    ds_read_b64_tr_b16 a[54:55], v9 offset:46080
    ds_read_b64_tr_b16 a[56:57], v10 offset:45056
    ds_read_b64_tr_b16 a[58:59], v10 offset:46080
    v_mfma_f32_4x4x4_16b_bf16 a[64:67], v[154:155], v[154:155], a[64:67]
    s_waitcnt lgkmcnt(10)
    v_mfma_f32_32x32x16_bf16 v[192:207], a[40:43], v[152:155], v[192:207]
    ds_read_b64_tr_b16 a[60:61], v11 offset:45056
    ds_read_b64_tr_b16 a[62:63], v11 offset:46080
    ds_read_b64_tr_b16 v[228:229], v12 offset:45056
    s_waitcnt lgkmcnt(9)
    v_mfma_f32_4x4x4_16b_bf16 a[68:71], v[224:225], v[248:249], a[68:71]
    s_waitcnt lgkmcnt(11)
    v_mfma_f32_32x32x16_bf16 v[208:223], a[44:47], v[152:155], v[208:223]
    ds_read_b64_tr_b16 v[230:231], v12 offset:46080
    v_mfma_f32_4x4x4_16b_bf16 a[68:71], v[226:227], v[248:249], a[68:71]
    s_waitcnt lgkmcnt(8)
    v_mfma_f32_32x32x16_bf16 v[160:175], a[48:51], v[156:159], v[160:175]
    v_mfma_f32_4x4x4_16b_bf16 a[64:67], v[156:157], v[156:157], a[64:67]
    s_waitcnt lgkmcnt(6)
    v_mfma_f32_32x32x16_bf16 v[176:191], a[52:55], v[156:159], v[176:191]
    v_mfma_f32_4x4x4_16b_bf16 a[64:67], v[158:159], v[158:159], a[64:67]
    s_waitcnt lgkmcnt(4)
    v_mfma_f32_32x32x16_bf16 v[192:207], a[56:59], v[156:159], v[192:207]
    s_waitcnt lgkmcnt(0)
    v_mfma_f32_4x4x4_16b_bf16 a[68:71], v[228:229], v[248:249], a[68:71]
    s_waitcnt lgkmcnt(2)
    v_mfma_f32_32x32x16_bf16 v[208:223], a[60:63], v[156:159], v[208:223]
    v_mfma_f32_4x4x4_16b_bf16 a[68:71], v[230:231], v[248:249], a[68:71]
    v_and_b32 v241, 3, v2
    v_cmp_eq_u32 s[34:35], 1, v241
    v_cmp_eq_u32 s[36:37], 2, v241
    v_cmp_eq_u32 s[38:39], 3, v241
    v_and_b32 v244, 31, v2
    v_lshlrev_b32 v244, 2, v244
    v_add_u32 v244, s49, v244
    s_nop 1
    v_accvgpr_read_b32 v224, a64
    v_accvgpr_read_b32 v225, a65
    v_accvgpr_read_b32 v226, a66
    v_accvgpr_read_b32 v227, a67
    v_accvgpr_read_b32 v228, a68
    v_accvgpr_read_b32 v229, a69
    v_accvgpr_read_b32 v230, a70
    v_accvgpr_read_b32 v231, a71
    v_cndmask_b32 v224, v224, v225, s[34:35]
    v_cndmask_b32 v228, v228, v229, s[34:35]
    v_cndmask_b32 v224, v224, v226, s[36:37]
    v_cndmask_b32 v228, v228, v230, s[36:37]
    v_cndmask_b32 v224, v224, v227, s[38:39]
    v_cndmask_b32 v228, v228, v231, s[38:39]
    v_mov_b32 v225, v224
    v_mov_b32 v229, v228
    v_cndmask_b32 v238, v212, v216, s[58:59]
    s_nop 0
    v_permlane32_swap_b32 v224, v225
    v_permlane32_swap_b32 v228, v229
    s_nop 0
    v_add_f32 v239, v224, v225
    v_add_f32 v228, v228, v229
    ds_write_b32 v244, v228
    v_mul_f32 v238, 0x3ae38e39, v238
    v_mul_f32 v239, 0x3ae38e39, v239
    v_fma_f32 v239, -v238, v238, v239
    v_max_f32 v239, 0, v239
    v_add_f32 v239, 0x3727c5ac, v239
    v_rsq_f32 v242, v239
    v_lshlrev_b32 v240, 4, v14
    v_mul_f32 v244, v238, v242
    v_sub_f32 v244, 0, v244
    v_add_u32 v240, 98304, v240
    s_waitcnt lgkmcnt(0)
    s_barrier
    ds_read_b128 v[80:83], v240 offset:0
    ds_read_b128 v[84:87], v240 offset:32
    ds_read_b128 v[88:91], v240 offset:64
    ds_read_b128 v[92:95], v240 offset:96
    ds_read_b128 v[96:99], v240 offset:16384
    ds_read_b128 v[100:103], v240 offset:16416
    ds_read_b128 v[104:107], v240 offset:16448
    ds_read_b128 v[108:111], v240 offset:16480
    ds_read_b128 v[112:115], v240 offset:32768
    ds_read_b128 v[116:119], v240 offset:32800
    ds_read_b128 v[120:123], v240 offset:32832
    ds_read_b128 v[124:127], v240 offset:32864
    ds_read_b128 v[128:131], v240 offset:49152
    ds_read_b128 v[132:135], v240 offset:49184
    s_waitcnt lgkmcnt(10)
    v_pk_mul_f32 v[80:81], v[80:81], v[244:245] op_sel_hi:[1,0]
    v_pk_fma_f32 v[80:81], v[160:161], v[242:243], v[80:81] op_sel_hi:[1,0,1]
    v_cvt_pk_bf16_f32 v16, v80, v81
    v_pk_mul_f32 v[82:83], v[82:83], v[244:245] op_sel_hi:[1,0]
    v_pk_fma_f32 v[82:83], v[162:163], v[242:243], v[82:83] op_sel_hi:[1,0,1]
    v_cvt_pk_bf16_f32 v17, v82, v83
    v_pk_mul_f32 v[84:85], v[84:85], v[244:245] op_sel_hi:[1,0]
    v_pk_fma_f32 v[84:85], v[164:165], v[242:243], v[84:85] op_sel_hi:[1,0,1]
    v_cvt_pk_bf16_f32 v18, v84, v85
    v_pk_mul_f32 v[86:87], v[86:87], v[244:245] op_sel_hi:[1,0]
    v_pk_fma_f32 v[86:87], v[166:167], v[242:243], v[86:87] op_sel_hi:[1,0,1]
    v_cvt_pk_bf16_f32 v19, v86, v87
    v_pk_mul_f32 v[88:89], v[88:89], v[244:245] op_sel_hi:[1,0]
    v_pk_fma_f32 v[88:89], v[168:169], v[242:243], v[88:89] op_sel_hi:[1,0,1]
    v_cvt_pk_bf16_f32 v20, v88, v89
    v_pk_mul_f32 v[90:91], v[90:91], v[244:245] op_sel_hi:[1,0]
    v_pk_fma_f32 v[90:91], v[170:171], v[242:243], v[90:91] op_sel_hi:[1,0,1]
    v_cvt_pk_bf16_f32 v21, v90, v91
    v_pk_mul_f32 v[92:93], v[92:93], v[244:245] op_sel_hi:[1,0]
    v_pk_fma_f32 v[92:93], v[172:173], v[242:243], v[92:93] op_sel_hi:[1,0,1]
    v_cvt_pk_bf16_f32 v22, v92, v93
    v_pk_mul_f32 v[94:95], v[94:95], v[244:245] op_sel_hi:[1,0]
    v_pk_fma_f32 v[94:95], v[174:175], v[242:243], v[94:95] op_sel_hi:[1,0,1]
    v_cvt_pk_bf16_f32 v23, v94, v95
    s_waitcnt lgkmcnt(6)
    v_pk_mul_f32 v[96:97], v[96:97], v[244:245] op_sel_hi:[1,0]
    v_pk_fma_f32 v[96:97], v[176:177], v[242:243], v[96:97] op_sel_hi:[1,0,1]
    v_cvt_pk_bf16_f32 v24, v96, v97
    v_pk_mul_f32 v[98:99], v[98:99], v[244:245] op_sel_hi:[1,0]
    v_pk_fma_f32 v[98:99], v[178:179], v[242:243], v[98:99] op_sel_hi:[1,0,1]
    v_cvt_pk_bf16_f32 v25, v98, v99
    v_pk_mul_f32 v[100:101], v[100:101], v[244:245] op_sel_hi:[1,0]
    v_pk_fma_f32 v[100:101], v[180:181], v[242:243], v[100:101] op_sel_hi:[1,0,1]
    v_cvt_pk_bf16_f32 v26, v100, v101
    v_pk_mul_f32 v[102:103], v[102:103], v[244:245] op_sel_hi:[1,0]
    v_pk_fma_f32 v[102:103], v[182:183], v[242:243], v[102:103] op_sel_hi:[1,0,1]
    v_cvt_pk_bf16_f32 v27, v102, v103
    v_pk_mul_f32 v[104:105], v[104:105], v[244:245] op_sel_hi:[1,0]
    v_pk_fma_f32 v[104:105], v[184:185], v[242:243], v[104:105] op_sel_hi:[1,0,1]
    v_cvt_pk_bf16_f32 v28, v104, v105
    v_pk_mul_f32 v[106:107], v[106:107], v[244:245] op_sel_hi:[1,0]
    v_pk_fma_f32 v[106:107], v[186:187], v[242:243], v[106:107] op_sel_hi:[1,0,1]
    v_cvt_pk_bf16_f32 v29, v106, v107
    v_pk_mul_f32 v[108:109], v[108:109], v[244:245] op_sel_hi:[1,0]
    v_pk_fma_f32 v[108:109], v[188:189], v[242:243], v[108:109] op_sel_hi:[1,0,1]
    v_cvt_pk_bf16_f32 v30, v108, v109
    v_pk_mul_f32 v[110:111], v[110:111], v[244:245] op_sel_hi:[1,0]
    v_pk_fma_f32 v[110:111], v[190:191], v[242:243], v[110:111] op_sel_hi:[1,0,1]
    v_cvt_pk_bf16_f32 v31, v110, v111
    s_waitcnt lgkmcnt(2)
    v_pk_mul_f32 v[112:113], v[112:113], v[244:245] op_sel_hi:[1,0]
    v_pk_fma_f32 v[112:113], v[192:193], v[242:243], v[112:113] op_sel_hi:[1,0,1]
    v_cvt_pk_bf16_f32 v32, v112, v113
    v_pk_mul_f32 v[114:115], v[114:115], v[244:245] op_sel_hi:[1,0]
    v_pk_fma_f32 v[114:115], v[194:195], v[242:243], v[114:115] op_sel_hi:[1,0,1]
    v_cvt_pk_bf16_f32 v33, v114, v115
    v_pk_mul_f32 v[116:117], v[116:117], v[244:245] op_sel_hi:[1,0]
    v_pk_fma_f32 v[116:117], v[196:197], v[242:243], v[116:117] op_sel_hi:[1,0,1]
    v_cvt_pk_bf16_f32 v34, v116, v117
    v_pk_mul_f32 v[118:119], v[118:119], v[244:245] op_sel_hi:[1,0]
    v_pk_fma_f32 v[118:119], v[198:199], v[242:243], v[118:119] op_sel_hi:[1,0,1]
    v_cvt_pk_bf16_f32 v35, v118, v119
    v_pk_mul_f32 v[120:121], v[120:121], v[244:245] op_sel_hi:[1,0]
    v_pk_fma_f32 v[120:121], v[200:201], v[242:243], v[120:121] op_sel_hi:[1,0,1]
    v_cvt_pk_bf16_f32 v36, v120, v121
    v_pk_mul_f32 v[122:123], v[122:123], v[244:245] op_sel_hi:[1,0]
    v_pk_fma_f32 v[122:123], v[202:203], v[242:243], v[122:123] op_sel_hi:[1,0,1]
    v_cvt_pk_bf16_f32 v37, v122, v123
    v_pk_mul_f32 v[124:125], v[124:125], v[244:245] op_sel_hi:[1,0]
    v_pk_fma_f32 v[124:125], v[204:205], v[242:243], v[124:125] op_sel_hi:[1,0,1]
    v_cvt_pk_bf16_f32 v38, v124, v125
    v_pk_mul_f32 v[126:127], v[126:127], v[244:245] op_sel_hi:[1,0]
    v_pk_fma_f32 v[126:127], v[206:207], v[242:243], v[126:127] op_sel_hi:[1,0,1]
    v_cvt_pk_bf16_f32 v39, v126, v127
    s_waitcnt lgkmcnt(0)
    v_pk_mul_f32 v[128:129], v[128:129], v[244:245] op_sel_hi:[1,0]
    v_pk_fma_f32 v[128:129], v[208:209], v[242:243], v[128:129] op_sel_hi:[1,0,1]
    v_cvt_pk_bf16_f32 v40, v128, v129
    v_pk_mul_f32 v[130:131], v[130:131], v[244:245] op_sel_hi:[1,0]
    v_pk_fma_f32 v[130:131], v[210:211], v[242:243], v[130:131] op_sel_hi:[1,0,1]
    v_cvt_pk_bf16_f32 v41, v130, v131
    v_pk_mul_f32 v[132:133], v[132:133], v[244:245] op_sel_hi:[1,0]
    v_pk_fma_f32 v[132:133], v[212:213], v[242:243], v[132:133] op_sel_hi:[1,0,1]
    v_cvt_pk_bf16_f32 v42, v132, v133
    v_pk_mul_f32 v[134:135], v[134:135], v[244:245] op_sel_hi:[1,0]
    v_pk_fma_f32 v[134:135], v[214:215], v[242:243], v[134:135] op_sel_hi:[1,0,1]
    v_cvt_pk_bf16_f32 v43, v134, v135
    s_nop 1
    v_mfma_f32_32x32x16_bf16 v[160:175], a[0:3], v[24:27], 0
    v_mfma_f32_32x32x16_bf16 v[160:175], a[4:7], v[28:31], v[160:175]
    v_mfma_f32_32x32x16_bf16 v[160:175], a[12:15], v[40:43], v[160:175]
    v_mfma_f32_32x32x16_bf16 v[176:191], a[16:19], v[24:27], 0
    v_mfma_f32_32x32x16_bf16 v[176:191], a[20:23], v[28:31], v[176:191]
    v_mfma_f32_32x32x16_bf16 v[176:191], a[28:31], v[40:43], v[176:191]
    v_mfma_f32_32x32x16_bf16 v[192:207], a[0:3], v[16:19], 0
    v_mfma_f32_32x32x16_bf16 v[192:207], a[4:7], v[20:23], v[192:207]
    v_mfma_f32_32x32x16_bf16 v[192:207], a[8:11], v[40:43], v[192:207]
    v_mfma_f32_32x32x16_bf16 v[208:223], a[16:19], v[16:19], 0
    v_mfma_f32_32x32x16_bf16 v[208:223], a[20:23], v[20:23], v[208:223]
    v_mfma_f32_32x32x16_bf16 v[208:223], a[24:27], v[40:43], v[208:223]
    v_and_b32 v3, 31, v2
    v_lshl_add_u32 v3, v1, 5, v3
    v_mul_u32_u24 v3, 80, v3
    v_lshl_add_u32 v4, v14, 3, v3
    v_add_u32 v4, 20736, v4
    ds_write_b64 v4, v[32:33] offset:0
    ds_write_b64 v4, v[34:35] offset:16
    ds_write_b64 v4, v[36:37] offset:32
    ds_write_b64 v4, v[38:39] offset:48
    v_mov_b32 v5, 0x3f80
    v_cndmask_b32 v6, v5, v42, s[58:59]
    v_cndmask_b32 v7, 0, v43, s[58:59]
    ds_write_b64 v4, v[6:7] offset:64
    v_mul_u32_u24 v5, 10240, v14
    v_add_u32 v3, v3, v5
    s_nop 3
    v_max3_f32 v72, v160, v161, v162
    v_min3_f32 v73, v160, v161, v162
    v_max3_f32 v72, v72, v163, v164
    v_min3_f32 v73, v73, v163, v164
    v_max3_f32 v72, v72, v165, v166
    v_min3_f32 v73, v73, v165, v166
    v_max3_f32 v72, v72, v167, v168
    v_min3_f32 v73, v73, v167, v168
    v_max3_f32 v72, v72, v169, v170
    v_min3_f32 v73, v73, v169, v170
    v_max3_f32 v72, v72, v171, v172
    v_min3_f32 v73, v73, v171, v172
    v_max3_f32 v72, v72, v173, v174
    v_min3_f32 v73, v73, v173, v174
    v_max3_f32 v72, v72, v175, v176
    v_min3_f32 v73, v73, v175, v176
    v_max_f32 v72, v72, v177
    v_min_f32 v73, v73, v177
    v_mul_f32 v72, 0xbfb8aa3b, v72
    v_mul_f32 v73, 0x3fb8aa3b, v73
    v_fma_f32 v74, v160, s60, v72
    v_fma_f32 v92, v160, s61, v73
    v_fma_f32 v75, v161, s60, v72
    v_fma_f32 v93, v161, s61, v73
    v_fma_f32 v76, v162, s60, v72
    v_fma_f32 v94, v162, s61, v73
    v_fma_f32 v77, v163, s60, v72
    v_fma_f32 v95, v163, s61, v73
    v_fma_f32 v78, v164, s60, v72
    v_fma_f32 v96, v164, s61, v73
    v_fma_f32 v79, v165, s60, v72
    v_fma_f32 v97, v165, s61, v73
    v_fma_f32 v80, v166, s60, v72
    v_fma_f32 v98, v166, s61, v73
    v_fma_f32 v81, v167, s60, v72
    v_fma_f32 v99, v167, s61, v73
    v_fma_f32 v82, v168, s60, v72
    v_fma_f32 v100, v168, s61, v73
    v_fma_f32 v83, v169, s60, v72
    v_fma_f32 v101, v169, s61, v73
    v_fma_f32 v84, v170, s60, v72
    v_fma_f32 v102, v170, s61, v73
    v_fma_f32 v85, v171, s60, v72
    v_fma_f32 v103, v171, s61, v73
    v_fma_f32 v86, v172, s60, v72
    v_fma_f32 v104, v172, s61, v73
    v_fma_f32 v87, v173, s60, v72
    v_fma_f32 v105, v173, s61, v73
    v_fma_f32 v88, v174, s60, v72
    v_fma_f32 v106, v174, s61, v73
    v_fma_f32 v89, v175, s60, v72
    v_fma_f32 v107, v175, s61, v73
    v_fma_f32 v90, v176, s60, v72
    v_fma_f32 v108, v176, s61, v73
    v_fma_f32 v91, v177, s60, v72
    v_fma_f32 v109, v177, s61, v73
    v_exp_f32 v74, v74
    v_exp_f32 v92, v92
    v_exp_f32 v75, v75
    v_exp_f32 v93, v93
    v_exp_f32 v76, v76
    v_exp_f32 v94, v94
    v_exp_f32 v77, v77
    v_exp_f32 v95, v95
    v_exp_f32 v78, v78
    v_exp_f32 v96, v96
    v_exp_f32 v79, v79
    v_exp_f32 v97, v97
    v_exp_f32 v80, v80
    v_exp_f32 v98, v98
    v_exp_f32 v81, v81
    v_exp_f32 v99, v99
    v_exp_f32 v82, v82
    v_exp_f32 v100, v100
    v_exp_f32 v83, v83
    v_exp_f32 v101, v101
    v_exp_f32 v84, v84
    v_exp_f32 v102, v102
    v_exp_f32 v85, v85
    v_exp_f32 v103, v103
    v_exp_f32 v86, v86
    v_exp_f32 v104, v104
    v_exp_f32 v87, v87
    v_exp_f32 v105, v105
    v_exp_f32 v88, v88
    v_exp_f32 v106, v106
    v_exp_f32 v89, v89
    v_exp_f32 v107, v107
    v_exp_f32 v90, v90
    v_exp_f32 v108, v108
    v_exp_f32 v91, v91
    v_exp_f32 v109, v109
    v_pk_add_f32 v[110:111], v[74:75], v[76:77]
    v_pk_add_f32 v[112:113], v[92:93], v[94:95]
    v_pk_add_f32 v[110:111], v[110:111], v[78:79]
    v_pk_add_f32 v[112:113], v[112:113], v[96:97]
    v_pk_add_f32 v[110:111], v[110:111], v[80:81]
    v_pk_add_f32 v[112:113], v[112:113], v[98:99]
    v_pk_add_f32 v[110:111], v[110:111], v[82:83]
    v_pk_add_f32 v[112:113], v[112:113], v[100:101]
    v_pk_add_f32 v[110:111], v[110:111], v[84:85]
    v_pk_add_f32 v[112:113], v[112:113], v[102:103]
    v_pk_add_f32 v[110:111], v[110:111], v[86:87]
    v_pk_add_f32 v[112:113], v[112:113], v[104:105]
    v_pk_add_f32 v[110:111], v[110:111], v[88:89]
    v_pk_add_f32 v[112:113], v[112:113], v[106:107]
    v_pk_add_f32 v[110:111], v[110:111], v[90:91]
    v_pk_add_f32 v[112:113], v[112:113], v[108:109]
    v_add_f32 v110, v110, v111
    v_add_f32 v112, v112, v113
    v_rcp_f32 v110, v110
    v_rcp_f32 v112, v112
    v_mov_b32 v57, 0
    v_mov_b32 v67, 0
    v_pk_mul_f32 v[74:75], v[74:75], v[110:111] op_sel_hi:[1,0]
    v_pk_mul_f32 v[92:93], v[92:93], v[112:113] op_sel_hi:[1,0]
    v_pk_mul_f32 v[76:77], v[76:77], v[110:111] op_sel_hi:[1,0]
    v_pk_mul_f32 v[94:95], v[94:95], v[112:113] op_sel_hi:[1,0]
    v_pk_mul_f32 v[78:79], v[78:79], v[110:111] op_sel_hi:[1,0]
    v_pk_mul_f32 v[96:97], v[96:97], v[112:113] op_sel_hi:[1,0]
    v_pk_mul_f32 v[80:81], v[80:81], v[110:111] op_sel_hi:[1,0]
    v_pk_mul_f32 v[98:99], v[98:99], v[112:113] op_sel_hi:[1,0]
    v_pk_mul_f32 v[82:83], v[82:83], v[110:111] op_sel_hi:[1,0]
    v_pk_mul_f32 v[100:101], v[100:101], v[112:113] op_sel_hi:[1,0]
    v_pk_mul_f32 v[84:85], v[84:85], v[110:111] op_sel_hi:[1,0]
    v_pk_mul_f32 v[102:103], v[102:103], v[112:113] op_sel_hi:[1,0]
    v_pk_mul_f32 v[86:87], v[86:87], v[110:111] op_sel_hi:[1,0]
    v_pk_mul_f32 v[104:105], v[104:105], v[112:113] op_sel_hi:[1,0]
    v_pk_mul_f32 v[88:89], v[88:89], v[110:111] op_sel_hi:[1,0]
    v_pk_mul_f32 v[106:107], v[106:107], v[112:113] op_sel_hi:[1,0]
    v_pk_mul_f32 v[90:91], v[90:91], v[110:111] op_sel_hi:[1,0]
    v_pk_mul_f32 v[108:109], v[108:109], v[112:113] op_sel_hi:[1,0]
    v_cvt_pk_bf16_f32 v48, v74, v75
    v_cvt_pk_bf16_f32 v58, v92, v93
    v_cvt_pk_bf16_f32 v49, v76, v77
    v_cvt_pk_bf16_f32 v59, v94, v95
    v_cvt_pk_bf16_f32 v50, v78, v79
    v_cvt_pk_bf16_f32 v60, v96, v97
    v_cvt_pk_bf16_f32 v51, v80, v81
    v_cvt_pk_bf16_f32 v61, v98, v99
    v_cvt_pk_bf16_f32 v52, v82, v83
    v_cvt_pk_bf16_f32 v62, v100, v101
    v_cvt_pk_bf16_f32 v53, v84, v85
    v_cvt_pk_bf16_f32 v63, v102, v103
    v_cvt_pk_bf16_f32 v54, v86, v87
    v_cvt_pk_bf16_f32 v64, v104, v105
    v_cvt_pk_bf16_f32 v55, v88, v89
    v_cvt_pk_bf16_f32 v65, v106, v107
    v_cvt_pk_bf16_f32 v56, v90, v91
    v_cvt_pk_bf16_f32 v66, v108, v109
    ds_write_b128 v3, v[48:51] offset:0
    ds_write_b128 v3, v[52:55] offset:16
    ds_write_b128 v3, v[56:59] offset:32
    ds_write_b128 v3, v[60:63] offset:48
    ds_write_b128 v3, v[64:67] offset:64
    v_lshl_add_u32 v5, v14, 3, v13
    v_mul_u32_u24 v5, 80, v5
    s_lshr_b32 s50, s42, 1
    s_and_b32 s51, s42, 1
    s_mul_i32 s52, s50, 10240
    s_mul_i32 s53, s51, 40
    s_add_u32 s52, s52, s53
    v_lshlrev_b32 v6, 3, v15
    v_add3_u32 v8, v5, v6, s52
    s_lshl_b32 s53, s50, 5
    v_add_u32 v6, s53, v6
    v_cmp_ge_u32 vcc, 4, v15
    v_mov_b32 v7, 72
    s_nop 0
    v_cndmask_b32 v6, v7, v6, vcc
    v_add_u32 v9, v5, v6
    v_add_u32 v9, 20736, v9
    s_lshl_b32 s54, s40, 4
    s_add_u32 s54, s54, s41
    s_mul_i32 s54, s54, 7680
    v_and_b32 v5, 31, v2
    s_mul_i32 s53, s42, 1920
    s_add_u32 s54, s54, s53
    v_mul_u32_u24 v10, 384, v14
    v_lshl_add_u32 v10, v5, 4, v10
    v_cmp_gt_u32 vcc, 24, v5
    v_mov_b32 v7, 0x40000000
    s_nop 0
    v_cndmask_b32 v10, v7, v10, vcc
    v_cndmask_b32 v11, v7, v10, s[58:59]
    s_waitcnt lgkmcnt(0)
    s_barrier
    ds_read_b64_tr_b16 v[160:161], v8 offset:0
    ds_read_b64_tr_b16 a[32:33], v9 offset:0
    ds_read_b64_tr_b16 v[162:163], v8 offset:320
    ds_read_b64_tr_b16 a[34:35], v9 offset:320
    ds_read_b64_tr_b16 v[164:165], v8 offset:1280
    ds_read_b64_tr_b16 a[36:37], v9 offset:1280
    ds_read_b64_tr_b16 v[166:167], v8 offset:1600
    ds_read_b64_tr_b16 a[38:39], v9 offset:1600
    ds_read_b64_tr_b16 v[168:169], v8 offset:2560
    ds_read_b64_tr_b16 a[40:41], v9 offset:2560
    ds_read_b64_tr_b16 v[170:171], v8 offset:2880
    ds_read_b64_tr_b16 a[42:43], v9 offset:2880
    ds_read_b64_tr_b16 v[172:173], v8 offset:3840
    ds_read_b64_tr_b16 a[44:45], v9 offset:3840
    ds_read_b64_tr_b16 v[174:175], v8 offset:4160
    ds_read_b64_tr_b16 a[46:47], v9 offset:4160
    ds_read_b64_tr_b16 v[176:177], v8 offset:5120
    ds_read_b64_tr_b16 a[48:49], v9 offset:5120
    ds_read_b64_tr_b16 v[178:179], v8 offset:5440
    ds_read_b64_tr_b16 a[50:51], v9 offset:5440
    ds_read_b64_tr_b16 v[180:181], v8 offset:6400
    ds_read_b64_tr_b16 a[52:53], v9 offset:6400
    ds_read_b64_tr_b16 v[182:183], v8 offset:6720
    ds_read_b64_tr_b16 a[54:55], v9 offset:6720
    ds_read_b64_tr_b16 v[184:185], v8 offset:7680
    ds_read_b64_tr_b16 a[56:57], v9 offset:7680
    ds_read_b64_tr_b16 v[186:187], v8 offset:8000
    ds_read_b64_tr_b16 a[58:59], v9 offset:8000
    ds_read_b64_tr_b16 v[188:189], v8 offset:8960
    ds_read_b64_tr_b16 a[60:61], v9 offset:8960
    ds_read_b64_tr_b16 v[190:191], v8 offset:9280
    ds_read_b64_tr_b16 a[62:63], v9 offset:9280
    s_waitcnt lgkmcnt(15)
    v_mfma_f32_32x32x16_bf16 v[128:143], v[160:163], a[32:35], 0
    s_waitcnt lgkmcnt(15)
    v_mfma_f32_32x32x16_bf16 v[128:143], v[164:167], a[36:39], v[128:143]
    s_waitcnt lgkmcnt(15)
    v_mfma_f32_32x32x16_bf16 v[128:143], v[168:171], a[40:43], v[128:143]
    s_waitcnt lgkmcnt(15)
    v_mfma_f32_32x32x16_bf16 v[128:143], v[172:175], a[44:47], v[128:143]
    s_waitcnt lgkmcnt(12)
    v_mfma_f32_32x32x16_bf16 v[128:143], v[176:179], a[48:51], v[128:143]
    s_waitcnt lgkmcnt(8)
    v_mfma_f32_32x32x16_bf16 v[128:143], v[180:183], a[52:55], v[128:143]
    s_waitcnt lgkmcnt(4)
    v_mfma_f32_32x32x16_bf16 v[128:143], v[184:187], a[56:59], v[128:143]
    s_waitcnt lgkmcnt(0)
    v_mfma_f32_32x32x16_bf16 v[128:143], v[188:191], a[60:63], v[128:143]
    s_mul_i32 s52, s2, 20480
    s_mul_i32 s53, s42, 5120
    s_add_u32 s52, s52, s53
    v_lshlrev_b32 v3, 4, v2
    v_add_u32 v4, 4096, v3
    s_nop 7
    buffer_store_dwordx4 v[128:131], v10, s[28:31], s54 offen sc1
    buffer_store_dwordx4 v[132:135], v10, s[28:31], s54 offen offset:768 sc1
    buffer_store_dwordx4 v[136:139], v11, s[28:31], s54 offen offset:1536 sc1
    s_add_u32 s100, s100, 0x9e3779b9
    v_mov_b32 v232, s100
    v_lshlrev_b32 v233, 2, v2
    v_lshlrev_b32 v234, 7, v2
    s_lshl_b32 s46, s40, 11
    s_add_u32 s46, s46, 65536
    s_lshl_b32 s47, s41, 11
    s_add_u32 s47, s47, 131072
    s_mov_b32 s12, s4
    s_mov_b32 s13, s5
    s_mov_b32 s14, 0x240000
    s_mov_b32 s15, 0x00020000
    s_and_b32 s50, s40, 7
    s_lshr_b32 s51, s40, 3
    s_mul_i32 s48, s51, 5
    s_add_u32 s48, s48, s50
    s_add_u32 s50, s50, s51
    s_cmp_lt_u32 s50, 5
    s_cselect_b32 s49, 1, 0
    s_cselect_b32 s101, 1, 0
    s_lshl_b32 s50, s48, 7
    s_lshl_b32 s51, s41, 2
    s_add_u32 s51, s51, s42
    v_lshrrev_b32 v16, 3, v2
    v_bfe_u32 v17, v2, 4, 1
    v_lshlrev_b32 v17, 2, v17
    v_and_b32 v18, 7, v2
    v_xor_b32 v17, v17, v18
    v_lshlrev_b32 v17, 4, v17
    v_add_u32 v17, s50, v17
    v_and_b32 v18, 1, v1
    v_mul_u32_u24 v18, 18, v18
    v_lshrrev_b32 v19, 1, v1
    v_lshl_add_u32 v20, v19, 3, v18
    v_add_u32 v20, v20, v16
    v_mul_u32_u24 v20, 1152, v20
    v_add_u32 v22, v20, v17
    v_mul_u32_u24 v20, 144, v19
    v_lshrrev_b32 v21, 1, v16
    v_mul_u32_u24 v21, 36, v21
    v_and_b32 v16, 1, v16
    v_add3_u32 v20, v20, v21, v16
    v_add3_u32 v20, v20, v18, 16
    v_mul_u32_u24 v20, 1152, v20
    v_add_u32 v23, v20, v17
    v_lshrrev_b32 v24, 3, v2
    s_lshl_b32 s52, s51, 5
    v_add_u32 v24, s52, v24
    v_mul_u32_u24 v24, 1152, v24
    v_and_b32 v16, 7, v2
    v_lshrrev_b32 v17, 4, v2
    v_xor_b32 v16, v16, v17
    v_lshlrev_b32 v16, 4, v16
    v_add3_u32 v24, v24, v16, s50
    v_xor_b32 v25, 64, v24
    s_lshl_b32 s53, s42, 12
    s_add_u32 s53, s53, 106496
    s_lshl_b32 s54, s42, 10
    s_add_u32 s54, s54, 32768
    s_cmp_eq_u32 s49, 0
    s_cbranch_scc1 L_sequential_preLN__linear_kernel_hedgehog__swiglu_ffn__prompt_kernel_nodma
    s_mov_b32 s44, 0
    s_add_u32 m0, s54, 0
    s_mov_b32 s44, 0
    buffer_load_dwordx4 v22, s[16:19], s44 offen lds
    s_add_u32 m0, s54, 4096
    s_mov_b32 s44, 41472
    buffer_load_dwordx4 v22, s[16:19], s44 offen lds
    s_add_u32 m0, s54, 8192
    s_mov_b32 s44, 82944
    buffer_load_dwordx4 v22, s[16:19], s44 offen lds
    s_add_u32 m0, s54, 12288
    s_mov_b32 s44, 124416
    buffer_load_dwordx4 v22, s[16:19], s44 offen lds
    s_add_u32 m0, s54, 16384
    s_mov_b32 s44, 165888
    buffer_load_dwordx4 v22, s[16:19], s44 offen lds
    s_add_u32 m0, s54, 20480
    s_mov_b32 s44, 207360
    buffer_load_dwordx4 v22, s[16:19], s44 offen lds
    s_add_u32 m0, s54, 24576
    s_mov_b32 s44, 248832
    buffer_load_dwordx4 v22, s[16:19], s44 offen lds
    s_add_u32 m0, s54, 28672
    s_mov_b32 s44, 290304
    buffer_load_dwordx4 v22, s[16:19], s44 offen lds
    s_add_u32 m0, s54, 32768
    s_mov_b32 s44, 331776
    buffer_load_dwordx4 v22, s[16:19], s44 offen lds
    s_add_u32 m0, s54, 36864
    s_mov_b32 s44, 373248
    buffer_load_dwordx4 v22, s[16:19], s44 offen lds
    s_add_u32 m0, s54, 40960
    s_mov_b32 s44, 414720
    buffer_load_dwordx4 v22, s[16:19], s44 offen lds
    s_add_u32 m0, s54, 45056
    s_mov_b32 s44, 456192
    buffer_load_dwordx4 v22, s[16:19], s44 offen lds
    s_add_u32 m0, s54, 49152
    s_mov_b32 s44, 497664
    buffer_load_dwordx4 v22, s[16:19], s44 offen lds
    s_add_u32 m0, s54, 53248
    s_mov_b32 s44, 539136
    buffer_load_dwordx4 v22, s[16:19], s44 offen lds
    s_add_u32 m0, s54, 57344
    s_mov_b32 s44, 580608
    buffer_load_dwordx4 v22, s[16:19], s44 offen lds
    s_add_u32 m0, s54, 61440
    s_mov_b32 s44, 622080
    buffer_load_dwordx4 v22, s[16:19], s44 offen lds
    s_add_u32 m0, s54, 65536
    s_mov_b32 s44, 0
    buffer_load_dwordx4 v23, s[16:19], s44 offen lds
    s_add_u32 m0, s54, 69632
    s_mov_b32 s44, 331776
    buffer_load_dwordx4 v23, s[16:19], s44 offen lds
    s_add_u32 m0, s53, 0
    s_mov_b32 s44, 0
    buffer_load_dwordx4 v24, s[12:15], s44 offen lds
    s_add_u32 m0, s53, 1024
    s_mov_b32 s44, 9216
    buffer_load_dwordx4 v25, s[12:15], s44 offen lds
    s_add_u32 m0, s53, 2048
    s_mov_b32 s44, 18432
    buffer_load_dwordx4 v24, s[12:15], s44 offen lds
    s_add_u32 m0, s53, 3072
    s_mov_b32 s44, 27648
    buffer_load_dwordx4 v25, s[12:15], s44 offen lds
    s_waitcnt vmcnt(22)
    s_branch L_sequential_preLN__linear_kernel_hedgehog__swiglu_ffn__prompt_kernel_dmad
L_sequential_preLN__linear_kernel_hedgehog__swiglu_ffn__prompt_kernel_nodma:
    s_waitcnt vmcnt(0)
L_sequential_preLN__linear_kernel_hedgehog__swiglu_ffn__prompt_kernel_dmad:
    s_barrier
    s_cmp_lg_u32 s42, 0
    s_cbranch_scc1 L_sequential_preLN__linear_kernel_hedgehog__swiglu_ffn__prompt_kernel_pub1
    s_lshl_b32 s44, s41, 7
    s_add_u32 s44, s44, s46
    s_mov_b64 exec, 0xffffffff
    buffer_store_dword v232, v233, s[24:27], s44 offen sc0 sc1
    s_mov_b64 exec, -1
L_sequential_preLN__linear_kernel_hedgehog__swiglu_ffn__prompt_kernel_pub1:
    v_max3_f32 v72, v192, v193, v194
    v_min3_f32 v73, v192, v193, v194
    v_max3_f32 v72, v72, v195, v196
    v_min3_f32 v73, v73, v195, v196
    v_max3_f32 v72, v72, v197, v198
    v_min3_f32 v73, v73, v197, v198
    v_max3_f32 v72, v72, v199, v200
    v_min3_f32 v73, v73, v199, v200
    v_max3_f32 v72, v72, v201, v202
    v_min3_f32 v73, v73, v201, v202
    v_max3_f32 v72, v72, v203, v204
    v_min3_f32 v73, v73, v203, v204
    v_max3_f32 v72, v72, v205, v206
    v_min3_f32 v73, v73, v205, v206
    v_max3_f32 v72, v72, v207, v208
    v_min3_f32 v73, v73, v207, v208
    v_max_f32 v72, v72, v209
    v_min_f32 v73, v73, v209
    v_mul_f32 v72, 0xbfb8aa3b, v72
    v_mul_f32 v73, 0x3fb8aa3b, v73
    v_fma_f32 v74, v192, s60, v72
    v_fma_f32 v92, v192, s61, v73
    v_fma_f32 v75, v193, s60, v72
    v_fma_f32 v93, v193, s61, v73
    v_fma_f32 v76, v194, s60, v72
    v_fma_f32 v94, v194, s61, v73
    v_fma_f32 v77, v195, s60, v72
    v_fma_f32 v95, v195, s61, v73
    v_fma_f32 v78, v196, s60, v72
    v_fma_f32 v96, v196, s61, v73
    v_fma_f32 v79, v197, s60, v72
    v_fma_f32 v97, v197, s61, v73
    v_fma_f32 v80, v198, s60, v72
    v_fma_f32 v98, v198, s61, v73
    v_fma_f32 v81, v199, s60, v72
    v_fma_f32 v99, v199, s61, v73
    v_fma_f32 v82, v200, s60, v72
    v_fma_f32 v100, v200, s61, v73
    v_fma_f32 v83, v201, s60, v72
    v_fma_f32 v101, v201, s61, v73
    v_fma_f32 v84, v202, s60, v72
    v_fma_f32 v102, v202, s61, v73
    v_fma_f32 v85, v203, s60, v72
    v_fma_f32 v103, v203, s61, v73
    v_fma_f32 v86, v204, s60, v72
    v_fma_f32 v104, v204, s61, v73
    v_fma_f32 v87, v205, s60, v72
    v_fma_f32 v105, v205, s61, v73
    v_fma_f32 v88, v206, s60, v72
    v_fma_f32 v106, v206, s61, v73
    v_fma_f32 v89, v207, s60, v72
    v_fma_f32 v107, v207, s61, v73
    v_fma_f32 v90, v208, s60, v72
    v_fma_f32 v108, v208, s61, v73
    v_fma_f32 v91, v209, s60, v72
    v_fma_f32 v109, v209, s61, v73
    v_exp_f32 v74, v74
    v_exp_f32 v92, v92
    v_exp_f32 v75, v75
    v_exp_f32 v93, v93
    v_exp_f32 v76, v76
    v_exp_f32 v94, v94
    v_exp_f32 v77, v77
    v_exp_f32 v95, v95
    v_exp_f32 v78, v78
    v_exp_f32 v96, v96
    v_exp_f32 v79, v79
    v_exp_f32 v97, v97
    v_exp_f32 v80, v80
    v_exp_f32 v98, v98
    v_exp_f32 v81, v81
    v_exp_f32 v99, v99
    v_exp_f32 v82, v82
    v_exp_f32 v100, v100
    v_exp_f32 v83, v83
    v_exp_f32 v101, v101
    v_exp_f32 v84, v84
    v_exp_f32 v102, v102
    v_exp_f32 v85, v85
    v_exp_f32 v103, v103
    v_exp_f32 v86, v86
    v_exp_f32 v104, v104
    v_exp_f32 v87, v87
    v_exp_f32 v105, v105
    v_exp_f32 v88, v88
    v_exp_f32 v106, v106
    v_exp_f32 v89, v89
    v_exp_f32 v107, v107
    v_exp_f32 v90, v90
    v_exp_f32 v108, v108
    v_exp_f32 v91, v91
    v_exp_f32 v109, v109
    v_pk_add_f32 v[110:111], v[74:75], v[76:77]
    v_pk_add_f32 v[112:113], v[92:93], v[94:95]
    v_pk_add_f32 v[110:111], v[110:111], v[78:79]
    v_pk_add_f32 v[112:113], v[112:113], v[96:97]
    v_pk_add_f32 v[110:111], v[110:111], v[80:81]
    v_pk_add_f32 v[112:113], v[112:113], v[98:99]
    v_pk_add_f32 v[110:111], v[110:111], v[82:83]
    v_pk_add_f32 v[112:113], v[112:113], v[100:101]
    v_pk_add_f32 v[110:111], v[110:111], v[84:85]
    v_pk_add_f32 v[112:113], v[112:113], v[102:103]
    v_pk_add_f32 v[110:111], v[110:111], v[86:87]
    v_pk_add_f32 v[112:113], v[112:113], v[104:105]
    v_pk_add_f32 v[110:111], v[110:111], v[88:89]
    v_pk_add_f32 v[112:113], v[112:113], v[106:107]
    v_pk_add_f32 v[110:111], v[110:111], v[90:91]
    v_pk_add_f32 v[112:113], v[112:113], v[108:109]
    v_add_f32 v110, v110, v111
    v_add_f32 v112, v112, v113
    v_rcp_f32 v110, v110
    v_rcp_f32 v112, v112
    v_mov_b32 v57, 0
    v_mov_b32 v67, 0
    v_pk_mul_f32 v[74:75], v[74:75], v[110:111] op_sel_hi:[1,0]
    v_pk_mul_f32 v[92:93], v[92:93], v[112:113] op_sel_hi:[1,0]
    v_pk_mul_f32 v[76:77], v[76:77], v[110:111] op_sel_hi:[1,0]
    v_pk_mul_f32 v[94:95], v[94:95], v[112:113] op_sel_hi:[1,0]
    v_pk_mul_f32 v[78:79], v[78:79], v[110:111] op_sel_hi:[1,0]
    v_pk_mul_f32 v[96:97], v[96:97], v[112:113] op_sel_hi:[1,0]
    v_pk_mul_f32 v[80:81], v[80:81], v[110:111] op_sel_hi:[1,0]
    v_pk_mul_f32 v[98:99], v[98:99], v[112:113] op_sel_hi:[1,0]
    v_pk_mul_f32 v[82:83], v[82:83], v[110:111] op_sel_hi:[1,0]
    v_pk_mul_f32 v[100:101], v[100:101], v[112:113] op_sel_hi:[1,0]
    v_pk_mul_f32 v[84:85], v[84:85], v[110:111] op_sel_hi:[1,0]
    v_pk_mul_f32 v[102:103], v[102:103], v[112:113] op_sel_hi:[1,0]
    v_pk_mul_f32 v[86:87], v[86:87], v[110:111] op_sel_hi:[1,0]
    v_pk_mul_f32 v[104:105], v[104:105], v[112:113] op_sel_hi:[1,0]
    v_pk_mul_f32 v[88:89], v[88:89], v[110:111] op_sel_hi:[1,0]
    v_pk_mul_f32 v[106:107], v[106:107], v[112:113] op_sel_hi:[1,0]
    v_pk_mul_f32 v[90:91], v[90:91], v[110:111] op_sel_hi:[1,0]
    v_pk_mul_f32 v[108:109], v[108:109], v[112:113] op_sel_hi:[1,0]
    v_cvt_pk_bf16_f32 v48, v74, v75
    v_cvt_pk_bf16_f32 v58, v92, v93
    v_cvt_pk_bf16_f32 v49, v76, v77
    v_cvt_pk_bf16_f32 v59, v94, v95
    v_cvt_pk_bf16_f32 v50, v78, v79
    v_cvt_pk_bf16_f32 v60, v96, v97
    v_cvt_pk_bf16_f32 v51, v80, v81
    v_cvt_pk_bf16_f32 v61, v98, v99
    v_cvt_pk_bf16_f32 v52, v82, v83
    v_cvt_pk_bf16_f32 v62, v100, v101
    v_cvt_pk_bf16_f32 v53, v84, v85
    v_cvt_pk_bf16_f32 v63, v102, v103
    v_cvt_pk_bf16_f32 v54, v86, v87
    v_cvt_pk_bf16_f32 v64, v104, v105
    v_cvt_pk_bf16_f32 v55, v88, v89
    v_cvt_pk_bf16_f32 v65, v106, v107
    v_cvt_pk_bf16_f32 v56, v90, v91
    v_cvt_pk_bf16_f32 v66, v108, v109
    v_lshlrev_b32 v3, 4, v0
    v_add_u32 v4, 4096, v3
    v_cmp_gt_u32 vcc, 224, v0
    v_mov_b32 v5, 0x40000000
    v_lshlrev_b32 v6, 4, v2
    v_cndmask_b32 v4, v5, v4, vcc
    s_add_u32 s20, s10, 0x800000
    s_addc_u32 s21, s11, 0
    s_mov_b32 s22, 0x240000
    s_mov_b32 s23, 0x00020000
    v_and_b32 v32, 31, v2
    v_bfe_u32 v33, v32, 2, 1
    v_and_b32 v34, 3, v32
    v_lshrrev_b32 v35, 3, v32
    v_lshl_add_u32 v34, v35, 2, v34
    v_lshl_add_u32 v8, v14, 1, v34
    v_mul_u32_u24 v8, 80, v8
    v_mul_u32_u24 v35, 1920, v14
    v_add_u32 v8, v8, v35
    v_add_u32 v9, 1280, v8
    v_add_u32 v35, 1600, v35
    v_cmp_eq_u32 vcc, 2, v34
    v_mov_b32 v36, 3840
    s_nop 0
    v_cndmask_b32 v9, v9, v35, vcc
    v_cmp_lt_u32 vcc, 2, v34
    s_nop 1
    v_cndmask_b32 v9, v9, v36, vcc
    v_cmp_eq_u32 vcc, v14, v33
    s_nop 1
    v_cndmask_b32 v8, v36, v8, vcc
    v_cndmask_b32 v9, v36, v9, vcc
    v_add_u32 v32, 0, v0
    v_mul_u32_u24 v33, 2731, v32
    v_lshrrev_b32 v33, 16, v33
    v_mul_u32_u24 v34, 24, v33
    v_sub_u32 v34, v32, v34
    v_mul_u32_u24 v35, 52, v33
    v_lshrrev_b32 v35, 8, v35
    v_mul_u32_u24 v36, 5, v35
    v_sub_u32 v36, v33, v36
    v_mul_u32_u24 v203, 80, v34
    v_lshl_add_u32 v203, v36, 3, v203
    v_and_b32 v36, 1, v35
    v_mul_u32_u24 v36, 40, v36
    v_lshrrev_b32 v35, 1, v35
    v_mul_u32_u24 v35, 1920, v35
    v_add3_u32 v203, v203, v35, v36
    v_add_u32 v32, 256, v0
    v_mul_u32_u24 v33, 2731, v32
    v_lshrrev_b32 v33, 16, v33
    v_mul_u32_u24 v34, 24, v33
    v_sub_u32 v34, v32, v34
    v_mul_u32_u24 v35, 52, v33
    v_lshrrev_b32 v35, 8, v35
    v_mul_u32_u24 v36, 5, v35
    v_sub_u32 v36, v33, v36
    v_mul_u32_u24 v204, 80, v34
    v_lshl_add_u32 v204, v36, 3, v204
    v_and_b32 v36, 1, v35
    v_mul_u32_u24 v36, 40, v36
    v_lshrrev_b32 v35, 1, v35
    v_mul_u32_u24 v35, 1920, v35
    v_add3_u32 v204, v204, v35, v36
    v_lshlrev_b32 v32, 3, v32
    v_cmp_gt_u32 vcc, 224, v0
    s_nop 1
    v_cndmask_b32 v204, v32, v204, vcc
    s_mov_b32 s45, 0x8000
    s_mov_b64 exec, 0xffff
L_sequential_preLN__linear_kernel_hedgehog__swiglu_ffn__prompt_kernel_poll1:
    buffer_load_dword v248, v234, s[24:27], s46 offen offset:0 sc0 sc1
    s_waitcnt vmcnt(0)
    v_cmp_ne_u32 vcc, v248, v232
    s_sub_u32 s45, s45, 1
    s_cbranch_scc1 L_sequential_preLN__linear_kernel_hedgehog__swiglu_ffn__prompt_kernel_poll1d
    s_cbranch_vccz L_sequential_preLN__linear_kernel_hedgehog__swiglu_ffn__prompt_kernel_poll1d
    s_sleep 1
    s_branch L_sequential_preLN__linear_kernel_hedgehog__swiglu_ffn__prompt_kernel_poll1
L_sequential_preLN__linear_kernel_hedgehog__swiglu_ffn__prompt_kernel_poll1d:
    s_mov_b64 exec, -1
    s_mul_i32 s45, s40, 122880
    s_and_b32 s56, s41, 3
    s_mul_i32 s44, s56, 30720
    s_add_u32 s44, s44, s45
    s_add_u32 s56, s56, 1
    s_and_b32 s56, s56, 3
    buffer_load_dwordx4 v[72:75], v3, s[28:31], s44 offen sc1
    buffer_load_dwordx4 v[76:79], v4, s[28:31], s44 offen sc1
    s_add_u32 s44, s44, 7680
    buffer_load_dwordx4 v[80:83], v3, s[28:31], s44 offen sc1
    buffer_load_dwordx4 v[84:87], v4, s[28:31], s44 offen sc1
    s_add_u32 s44, s44, 7680
    buffer_load_dwordx4 v[88:91], v3, s[28:31], s44 offen sc1
    buffer_load_dwordx4 v[92:95], v4, s[28:31], s44 offen sc1
    s_add_u32 s44, s44, 7680
    buffer_load_dwordx4 v[96:99], v3, s[28:31], s44 offen sc1
    buffer_load_dwordx4 v[100:103], v4, s[28:31], s44 offen sc1
    s_mul_i32 s44, s56, 30720
    s_add_u32 s44, s44, s45
    s_add_u32 s56, s56, 1
    s_and_b32 s56, s56, 3
    buffer_load_dwordx4 v[104:107], v3, s[28:31], s44 offen sc1
    buffer_load_dwordx4 v[108:111], v4, s[28:31], s44 offen sc1
    s_add_u32 s44, s44, 7680
    buffer_load_dwordx4 v[112:115], v3, s[28:31], s44 offen sc1
    buffer_load_dwordx4 v[116:119], v4, s[28:31], s44 offen sc1
    s_add_u32 s44, s44, 7680
    buffer_load_dwordx4 v[120:123], v3, s[28:31], s44 offen sc1
    buffer_load_dwordx4 v[124:127], v4, s[28:31], s44 offen sc1
    s_add_u32 s44, s44, 7680
    buffer_load_dwordx4 v[128:131], v3, s[28:31], s44 offen sc1
    buffer_load_dwordx4 v[132:135], v4, s[28:31], s44 offen sc1
    s_mul_i32 s44, s56, 30720
    s_add_u32 s44, s44, s45
    s_add_u32 s56, s56, 1
    s_and_b32 s56, s56, 3
    buffer_load_dwordx4 v[136:139], v3, s[28:31], s44 offen sc1
    buffer_load_dwordx4 v[140:143], v4, s[28:31], s44 offen sc1
    s_add_u32 s44, s44, 7680
    buffer_load_dwordx4 v[144:147], v3, s[28:31], s44 offen sc1
    buffer_load_dwordx4 v[148:151], v4, s[28:31], s44 offen sc1
    s_add_u32 s44, s44, 7680
    buffer_load_dwordx4 v[152:155], v3, s[28:31], s44 offen sc1
    buffer_load_dwordx4 v[156:159], v4, s[28:31], s44 offen sc1
    s_add_u32 s44, s44, 7680
    buffer_load_dwordx4 v[160:163], v3, s[28:31], s44 offen sc1
    buffer_load_dwordx4 v[164:167], v4, s[28:31], s44 offen sc1
    s_mul_i32 s44, s56, 30720
    s_add_u32 s44, s44, s45
    s_add_u32 s56, s56, 1
    s_and_b32 s56, s56, 3
    buffer_load_dwordx4 v[168:171], v3, s[28:31], s44 offen sc1
    buffer_load_dwordx4 v[172:175], v4, s[28:31], s44 offen sc1
    s_add_u32 s44, s44, 7680
    buffer_load_dwordx4 v[176:179], v3, s[28:31], s44 offen sc1
    buffer_load_dwordx4 v[180:183], v4, s[28:31], s44 offen sc1
    s_add_u32 s44, s44, 7680
    buffer_load_dwordx4 v[184:187], v3, s[28:31], s44 offen sc1
    buffer_load_dwordx4 v[188:191], v4, s[28:31], s44 offen sc1
    s_add_u32 s44, s44, 7680
    buffer_load_dwordx4 v[192:195], v3, s[28:31], s44 offen sc1
    buffer_load_dwordx4 v[196:199], v4, s[28:31], s44 offen sc1
    s_waitcnt vmcnt(28)
    v_pk_add_f32 v[72:73], v[72:73], v[80:81]
    v_pk_add_f32 v[74:75], v[74:75], v[82:83]
    v_pk_add_f32 v[76:77], v[76:77], v[84:85]
    v_pk_add_f32 v[78:79], v[78:79], v[86:87]
    s_waitcnt vmcnt(26)
    v_pk_add_f32 v[72:73], v[72:73], v[88:89]
    v_pk_add_f32 v[74:75], v[74:75], v[90:91]
    v_pk_add_f32 v[76:77], v[76:77], v[92:93]
    v_pk_add_f32 v[78:79], v[78:79], v[94:95]
    s_waitcnt vmcnt(24)
    v_pk_add_f32 v[72:73], v[72:73], v[96:97]
    v_pk_add_f32 v[74:75], v[74:75], v[98:99]
    v_pk_add_f32 v[76:77], v[76:77], v[100:101]
    v_pk_add_f32 v[78:79], v[78:79], v[102:103]
    s_waitcnt vmcnt(22)
    v_pk_add_f32 v[72:73], v[72:73], v[104:105]
    v_pk_add_f32 v[74:75], v[74:75], v[106:107]
    v_pk_add_f32 v[76:77], v[76:77], v[108:109]
    v_pk_add_f32 v[78:79], v[78:79], v[110:111]
    s_waitcnt vmcnt(20)
    v_pk_add_f32 v[72:73], v[72:73], v[112:113]
    v_pk_add_f32 v[74:75], v[74:75], v[114:115]
    v_pk_add_f32 v[76:77], v[76:77], v[116:117]
    v_pk_add_f32 v[78:79], v[78:79], v[118:119]
    s_waitcnt vmcnt(18)
    v_pk_add_f32 v[72:73], v[72:73], v[120:121]
    v_pk_add_f32 v[74:75], v[74:75], v[122:123]
    v_pk_add_f32 v[76:77], v[76:77], v[124:125]
    v_pk_add_f32 v[78:79], v[78:79], v[126:127]
    s_waitcnt vmcnt(16)
    v_pk_add_f32 v[72:73], v[72:73], v[128:129]
    v_pk_add_f32 v[74:75], v[74:75], v[130:131]
    v_pk_add_f32 v[76:77], v[76:77], v[132:133]
    v_pk_add_f32 v[78:79], v[78:79], v[134:135]
    s_waitcnt vmcnt(14)
    v_pk_add_f32 v[72:73], v[72:73], v[136:137]
    v_pk_add_f32 v[74:75], v[74:75], v[138:139]
    v_pk_add_f32 v[76:77], v[76:77], v[140:141]
    v_pk_add_f32 v[78:79], v[78:79], v[142:143]
    s_waitcnt vmcnt(12)
    v_pk_add_f32 v[72:73], v[72:73], v[144:145]
    v_pk_add_f32 v[74:75], v[74:75], v[146:147]
    v_pk_add_f32 v[76:77], v[76:77], v[148:149]
    v_pk_add_f32 v[78:79], v[78:79], v[150:151]
    s_waitcnt vmcnt(10)
    v_pk_add_f32 v[72:73], v[72:73], v[152:153]
    v_pk_add_f32 v[74:75], v[74:75], v[154:155]
    v_pk_add_f32 v[76:77], v[76:77], v[156:157]
    v_pk_add_f32 v[78:79], v[78:79], v[158:159]
    s_waitcnt vmcnt(8)
    v_pk_add_f32 v[72:73], v[72:73], v[160:161]
    v_pk_add_f32 v[74:75], v[74:75], v[162:163]
    v_pk_add_f32 v[76:77], v[76:77], v[164:165]
    v_pk_add_f32 v[78:79], v[78:79], v[166:167]
    s_waitcnt vmcnt(6)
    v_pk_add_f32 v[72:73], v[72:73], v[168:169]
    v_pk_add_f32 v[74:75], v[74:75], v[170:171]
    v_pk_add_f32 v[76:77], v[76:77], v[172:173]
    v_pk_add_f32 v[78:79], v[78:79], v[174:175]
    s_waitcnt vmcnt(4)
    v_pk_add_f32 v[72:73], v[72:73], v[176:177]
    v_pk_add_f32 v[74:75], v[74:75], v[178:179]
    v_pk_add_f32 v[76:77], v[76:77], v[180:181]
    v_pk_add_f32 v[78:79], v[78:79], v[182:183]
    s_waitcnt vmcnt(2)
    v_pk_add_f32 v[72:73], v[72:73], v[184:185]
    v_pk_add_f32 v[74:75], v[74:75], v[186:187]
    v_pk_add_f32 v[76:77], v[76:77], v[188:189]
    v_pk_add_f32 v[78:79], v[78:79], v[190:191]
    s_waitcnt vmcnt(0)
    v_pk_add_f32 v[72:73], v[72:73], v[192:193]
    v_pk_add_f32 v[74:75], v[74:75], v[194:195]
    v_pk_add_f32 v[76:77], v[76:77], v[196:197]
    v_pk_add_f32 v[78:79], v[78:79], v[198:199]
    v_cvt_pk_bf16_f32 v32, v72, v73
    v_cvt_pk_bf16_f32 v33, v74, v75
    v_cvt_pk_bf16_f32 v34, v76, v77
    v_cvt_pk_bf16_f32 v35, v78, v79
    ds_write_b64 v203, v[32:33]
    ds_write_b64 v204, v[34:35]
    s_waitcnt lgkmcnt(0)
    s_barrier
    ds_read_b128 v[72:75], v8 offset:0
    ds_read_b128 v[76:79], v8 offset:16
    ds_read_b128 v[80:83], v8 offset:32
    ds_read_b128 v[84:87], v8 offset:48
    ds_read_b128 v[88:91], v8 offset:64
    ds_read_b128 v[92:95], v9 offset:0
    ds_read_b128 v[96:99], v9 offset:16
    ds_read_b128 v[100:103], v9 offset:32
    ds_read_b128 v[104:107], v9 offset:48
    ds_read_b128 v[108:111], v9 offset:64
    s_waitcnt lgkmcnt(0)
    v_mfma_f32_32x32x16_bf16 v[120:135], v[72:75], v[48:51], 0
    v_mfma_f32_32x32x16_bf16 v[136:151], v[92:95], v[48:51], 0
    v_mfma_f32_32x32x16_bf16 v[120:135], v[76:79], v[52:55], v[120:135]
    v_mfma_f32_32x32x16_bf16 v[136:151], v[96:99], v[52:55], v[136:151]
    v_mfma_f32_32x32x16_bf16 v[120:135], v[80:83], v[56:59], v[120:135]
    v_mfma_f32_32x32x16_bf16 v[136:151], v[100:103], v[56:59], v[136:151]
    v_mfma_f32_32x32x16_bf16 v[120:135], v[84:87], v[60:63], v[120:135]
    v_mfma_f32_32x32x16_bf16 v[136:151], v[104:107], v[60:63], v[136:151]
    v_mfma_f32_32x32x16_bf16 v[120:135], v[88:91], v[64:67], v[120:135]
    v_mfma_f32_32x32x16_bf16 v[136:151], v[108:111], v[64:67], v[136:151]
    s_mul_i32 s55, s51, 36864
    s_lshl_b32 s56, s40, 11
    s_add_u32 s56, s56, s55
    s_lshl_b32 s57, s40, 8
    s_add_u32 s57, s57, s55
    s_add_u32 s57, s57, 32768
    s_nop 4
    s_nop 3
    v_add_f32 v42, 0x358637bd, v138
    v_rcp_f32 v42, v42
    s_nop 0
    v_pk_mul_f32 v[120:121], v[120:121], v[42:43] op_sel_hi:[1,0]
    v_pk_mul_f32 v[122:123], v[122:123], v[42:43] op_sel_hi:[1,0]
    v_pk_mul_f32 v[124:125], v[124:125], v[42:43] op_sel_hi:[1,0]
    v_pk_mul_f32 v[126:127], v[126:127], v[42:43] op_sel_hi:[1,0]
    v_pk_mul_f32 v[128:129], v[128:129], v[42:43] op_sel_hi:[1,0]
    v_pk_mul_f32 v[130:131], v[130:131], v[42:43] op_sel_hi:[1,0]
    v_pk_mul_f32 v[132:133], v[132:133], v[42:43] op_sel_hi:[1,0]
    v_pk_mul_f32 v[134:135], v[134:135], v[42:43] op_sel_hi:[1,0]
    v_pk_mul_f32 v[136:137], v[136:137], v[42:43] op_sel_hi:[1,0]
    v_cvt_pk_bf16_f32 v32, v120, v121
    v_cvt_pk_bf16_f32 v33, v122, v123
    v_cvt_pk_bf16_f32 v34, v124, v125
    v_cvt_pk_bf16_f32 v35, v126, v127
    v_cvt_pk_bf16_f32 v36, v128, v129
    v_cvt_pk_bf16_f32 v37, v130, v131
    v_cvt_pk_bf16_f32 v38, v132, v133
    v_cvt_pk_bf16_f32 v39, v134, v135
    v_cvt_pk_bf16_f32 v40, v136, v137
    buffer_store_dwordx4 v[32:35], v6, s[20:23], s56 offen sc1
    buffer_store_dwordx4 v[36:39], v6, s[20:23], s56 offen offset:1024 sc1
    buffer_store_dword v40, v233, s[20:23], s57 offen sc1
    s_waitcnt vmcnt(0)
    s_barrier
    s_cmp_lg_u32 s42, 0
    s_cbranch_scc1 L_sequential_preLN__linear_kernel_hedgehog__swiglu_ffn__prompt_kernel_pub2
    s_lshl_b32 s44, s40, 7
    s_add_u32 s44, s44, s47
    s_mov_b64 exec, 0xffffffff
    buffer_store_dword v232, v233, s[24:27], s44 offen sc0 sc1
    s_mov_b64 exec, -1
L_sequential_preLN__linear_kernel_hedgehog__swiglu_ffn__prompt_kernel_pub2:
    s_cmp_eq_u32 s49, 0
    s_cbranch_scc1 L_sequential_preLN__linear_kernel_hedgehog__swiglu_ffn__prompt_kernel_idle
    s_add_u32 s28, s10, 0xb00000
    s_addc_u32 s29, s11, 0
    s_mov_b32 s30, 0x240000
    s_mov_b32 s31, 0x00020000
    v_and_b32 v32, 31, v2
    v_lshlrev_b32 v32, 7, v32
    v_bfe_u32 v33, v2, 1, 3
    v_lshl_add_u32 v32, v33, 4, v32
    v_lshl_add_u32 v32, v14, 3, v32
    v_add_u32 v3, s53, v32
    v_bfe_u32 v32, v2, 4, 1
    s_lshl_b32 s52, s51, 1
    v_add_u32 v32, s52, v32
    v_mul_u32_u24 v32, 18432, v32
    v_and_b32 v33, 15, v2
    v_lshl_add_u32 v33, v14, 4, v33
    v_lshl_add_u32 v4, v33, 4, v32
    s_lshl_b32 s52, s48, 11
    v_lshl_add_u32 v32, v14, 3, v13
    v_lshlrev_b32 v32, 7, v32
    v_lshl_add_u32 v32, v15, 3, v32
    v_lshrrev_b32 v33, 1, v13
    v_lshl_add_u32 v32, v33, 6, v32
    v_add_u32 v8, 32768, v32
    v_xor_b32 v9, 64, v8
    s_mov_b32 s45, 0x8000
    s_mov_b64 exec, 0xffff
L_sequential_preLN__linear_kernel_hedgehog__swiglu_ffn__prompt_kernel_poll2:
    buffer_load_dword v248, v234, s[24:27], s47 offen offset:0 sc0 sc1
    s_waitcnt vmcnt(0)
    v_cmp_ne_u32 vcc, v248, v232
    s_sub_u32 s45, s45, 1
    s_cbranch_scc1 L_sequential_preLN__linear_kernel_hedgehog__swiglu_ffn__prompt_kernel_poll2d
    s_cbranch_vccz L_sequential_preLN__linear_kernel_hedgehog__swiglu_ffn__prompt_kernel_poll2d
    s_sleep 1
    s_branch L_sequential_preLN__linear_kernel_hedgehog__swiglu_ffn__prompt_kernel_poll2
L_sequential_preLN__linear_kernel_hedgehog__swiglu_ffn__prompt_kernel_poll2d:
    s_mov_b64 exec, -1
    s_cmp_lg_u32 s2, 0
    s_cbranch_scc1 L_sequential_preLN__linear_kernel_hedgehog__swiglu_ffn__prompt_kernel_noep
    s_cmp_lg_u32 s42, 3
    s_cbranch_scc1 L_sequential_preLN__linear_kernel_hedgehog__swiglu_ffn__prompt_kernel_noep
    s_mov_b32 s44, 258048
    s_mov_b64 exec, 1
    buffer_store_dword v232, v233, s[24:27], s44 offen sc0 sc1
    s_mov_b64 exec, -1
L_sequential_preLN__linear_kernel_hedgehog__swiglu_ffn__prompt_kernel_noep:
    s_mul_i32 s56, s40, 13
    s_lshr_b32 s56, s56, 3
    s_and_b32 s56, s56, 7
    s_mov_b32 s57, s56
    v_mov_b32 v7, v233
    s_add_u32 s44, s55, 32768
    buffer_load_dword v72, v7, s[20:23], s44 offen offset:0 sc1
    buffer_load_dword v73, v7, s[20:23], s44 offen offset:256 sc1
    buffer_load_dword v74, v7, s[20:23], s44 offen offset:512 sc1
    buffer_load_dword v75, v7, s[20:23], s44 offen offset:768 sc1
    buffer_load_dword v76, v7, s[20:23], s44 offen offset:1024 sc1
    buffer_load_dword v77, v7, s[20:23], s44 offen offset:1280 sc1
    buffer_load_dword v78, v7, s[20:23], s44 offen offset:1536 sc1
    buffer_load_dword v79, v7, s[20:23], s44 offen offset:1792 sc1
    buffer_load_dword v80, v7, s[20:23], s44 offen offset:2048 sc1
    buffer_load_dword v81, v7, s[20:23], s44 offen offset:2304 sc1
    buffer_load_dword v82, v7, s[20:23], s44 offen offset:2560 sc1
    buffer_load_dword v83, v7, s[20:23], s44 offen offset:2816 sc1
    buffer_load_dword v84, v7, s[20:23], s44 offen offset:3072 sc1
    buffer_load_dword v85, v7, s[20:23], s44 offen offset:3328 sc1
    buffer_load_dword v86, v7, s[20:23], s44 offen offset:3584 sc1
    buffer_load_dword v87, v7, s[20:23], s44 offen offset:3840 sc1
    s_lshl_b32 s44, s56, 12
    s_add_u32 s44, s44, s55
    s_add_u32 s56, s56, 1
    s_and_b32 s56, s56, 7
    buffer_load_dwordx4 v[88:91], v6, s[20:23], s44 offen offset:0 sc1
    buffer_load_dwordx4 v[92:95], v6, s[20:23], s44 offen offset:1024 sc1
    buffer_load_dwordx4 v[96:99], v6, s[20:23], s44 offen offset:2048 sc1
    buffer_load_dwordx4 v[100:103], v6, s[20:23], s44 offen offset:3072 sc1
    s_lshl_b32 s44, s56, 12
    s_add_u32 s44, s44, s55
    s_add_u32 s56, s56, 1
    s_and_b32 s56, s56, 7
    buffer_load_dwordx4 v[104:107], v6, s[20:23], s44 offen offset:0 sc1
    buffer_load_dwordx4 v[108:111], v6, s[20:23], s44 offen offset:1024 sc1
    buffer_load_dwordx4 v[112:115], v6, s[20:23], s44 offen offset:2048 sc1
    buffer_load_dwordx4 v[116:119], v6, s[20:23], s44 offen offset:3072 sc1
    s_lshl_b32 s44, s56, 12
    s_add_u32 s44, s44, s55
    s_add_u32 s56, s56, 1
    s_and_b32 s56, s56, 7
    buffer_load_dwordx4 v[120:123], v6, s[20:23], s44 offen offset:0 sc1
    buffer_load_dwordx4 v[124:127], v6, s[20:23], s44 offen offset:1024 sc1
    buffer_load_dwordx4 v[128:131], v6, s[20:23], s44 offen offset:2048 sc1
    buffer_load_dwordx4 v[132:135], v6, s[20:23], s44 offen offset:3072 sc1
    ds_read_b64 v[16:17], v3
    v_xor_b32 v5, 16, v3
    ds_read_b64 v[18:19], v5
    v_xor_b32 v5, 32, v3
    ds_read_b64 v[20:21], v5
    v_xor_b32 v5, 48, v3
    ds_read_b64 v[22:23], v5
    v_xor_b32 v5, 64, v3
    ds_read_b64 v[24:25], v5
    v_xor_b32 v5, 80, v3
    ds_read_b64 v[26:27], v5
    v_xor_b32 v5, 96, v3
    ds_read_b64 v[28:29], v5
    v_xor_b32 v5, 112, v3
    ds_read_b64 v[30:31], v5
    v_add_u32 v10, 0x10000, v8
    v_add_u32 v11, 0x10000, v9
    ds_read_b64_tr_b16 a[0:1], v10 offset:0
    ds_read_b64_tr_b16 a[2:3], v10 offset:512
    ds_read_b64_tr_b16 a[4:5], v11 offset:0
    ds_read_b64_tr_b16 a[6:7], v11 offset:512
    s_waitcnt lgkmcnt(2) vmcnt(24)
    v_mfma_f32_32x32x16_bf16 v[216:231], a[0:3], v[72:75], 0
    ds_read_b64_tr_b16 a[8:9], v10 offset:2048
    ds_read_b64_tr_b16 a[10:11], v10 offset:2560
    s_lshl_b32 s44, s56, 12
    s_add_u32 s44, s44, s55
    s_add_u32 s56, s56, 1
    s_and_b32 s56, s56, 7
    buffer_load_dwordx4 v[136:139], v6, s[20:23], s44 offen offset:0 sc1
    s_waitcnt lgkmcnt(2)
    v_mfma_f32_32x32x16_bf16 v[232:247], a[4:7], v[72:75], 0
    ds_read_b64_tr_b16 a[12:13], v11 offset:2048
    ds_read_b64_tr_b16 a[14:15], v11 offset:2560
    s_waitcnt lgkmcnt(2) vmcnt(21)
    v_mfma_f32_32x32x16_bf16 v[216:231], a[8:11], v[76:79], v[216:231]
    ds_read_b64_tr_b16 a[0:1], v10 offset:4096
    ds_read_b64_tr_b16 a[2:3], v10 offset:4608
    buffer_load_dwordx4 v[140:143], v6, s[20:23], s44 offen offset:1024 sc1
    s_waitcnt lgkmcnt(2)
    v_mfma_f32_32x32x16_bf16 v[232:247], a[12:15], v[76:79], v[232:247]
    ds_read_b64_tr_b16 a[4:5], v11 offset:4096
    ds_read_b64_tr_b16 a[6:7], v11 offset:4608
    s_waitcnt lgkmcnt(2) vmcnt(18)
    v_mfma_f32_32x32x16_bf16 v[216:231], a[0:3], v[80:83], v[216:231]
    ds_read_b64_tr_b16 a[8:9], v10 offset:6144
    ds_read_b64_tr_b16 a[10:11], v10 offset:6656
    buffer_load_dwordx4 v[144:147], v6, s[20:23], s44 offen offset:2048 sc1
    s_waitcnt lgkmcnt(2)
    v_mfma_f32_32x32x16_bf16 v[232:247], a[4:7], v[80:83], v[232:247]
    ds_read_b64_tr_b16 a[12:13], v11 offset:6144
    ds_read_b64_tr_b16 a[14:15], v11 offset:6656
    s_waitcnt lgkmcnt(2) vmcnt(15)
    v_mfma_f32_32x32x16_bf16 v[216:231], a[8:11], v[84:87], v[216:231]
    s_lshl_b32 s45, s57, 13
    v_add_u32 v10, s45, v8
    v_add_u32 v11, s45, v9
    s_add_u32 s57, s57, 1
    s_and_b32 s57, s57, 7
    ds_read_b64_tr_b16 a[0:1], v10 offset:0
    ds_read_b64_tr_b16 a[2:3], v10 offset:512
    buffer_load_dwordx4 v[148:151], v6, s[20:23], s44 offen offset:3072 sc1
    s_waitcnt lgkmcnt(2)
    v_mfma_f32_32x32x16_bf16 v[232:247], a[12:15], v[84:87], v[232:247]
    ds_read_b64_tr_b16 a[4:5], v11 offset:0
    ds_read_b64_tr_b16 a[6:7], v11 offset:512
    s_waitcnt lgkmcnt(2) vmcnt(15)
    v_mfma_f32_32x32x16_bf16 v[216:231], a[0:3], v[88:91], v[216:231]
    ds_read_b64_tr_b16 a[8:9], v10 offset:2048
    ds_read_b64_tr_b16 a[10:11], v10 offset:2560
    s_lshl_b32 s44, s56, 12
    s_add_u32 s44, s44, s55
    s_add_u32 s56, s56, 1
    s_and_b32 s56, s56, 7
    buffer_load_dwordx4 v[152:155], v6, s[20:23], s44 offen offset:0 sc1
    s_waitcnt lgkmcnt(2)
    v_mfma_f32_32x32x16_bf16 v[232:247], a[4:7], v[88:91], v[232:247]
    ds_read_b64_tr_b16 a[12:13], v11 offset:2048
    ds_read_b64_tr_b16 a[14:15], v11 offset:2560
    s_waitcnt lgkmcnt(2) vmcnt(15)
    v_mfma_f32_32x32x16_bf16 v[216:231], a[8:11], v[92:95], v[216:231]
    ds_read_b64_tr_b16 a[0:1], v10 offset:4096
    ds_read_b64_tr_b16 a[2:3], v10 offset:4608
    buffer_load_dwordx4 v[156:159], v6, s[20:23], s44 offen offset:1024 sc1
    s_waitcnt lgkmcnt(2)
    v_mfma_f32_32x32x16_bf16 v[232:247], a[12:15], v[92:95], v[232:247]
    ds_read_b64_tr_b16 a[4:5], v11 offset:4096
    ds_read_b64_tr_b16 a[6:7], v11 offset:4608
    s_waitcnt lgkmcnt(2) vmcnt(15)
    v_mfma_f32_32x32x16_bf16 v[216:231], a[0:3], v[96:99], v[216:231]
    ds_read_b64_tr_b16 a[8:9], v10 offset:6144
    ds_read_b64_tr_b16 a[10:11], v10 offset:6656
    buffer_load_dwordx4 v[160:163], v6, s[20:23], s44 offen offset:2048 sc1
    s_waitcnt lgkmcnt(2)
    v_mfma_f32_32x32x16_bf16 v[232:247], a[4:7], v[96:99], v[232:247]
    ds_read_b64_tr_b16 a[12:13], v11 offset:6144
    ds_read_b64_tr_b16 a[14:15], v11 offset:6656
    s_waitcnt lgkmcnt(2) vmcnt(15)
    v_mfma_f32_32x32x16_bf16 v[216:231], a[8:11], v[100:103], v[216:231]
    s_lshl_b32 s45, s57, 13
    v_add_u32 v10, s45, v8
    v_add_u32 v11, s45, v9
    s_add_u32 s57, s57, 1
    s_and_b32 s57, s57, 7
    ds_read_b64_tr_b16 a[0:1], v10 offset:0
    ds_read_b64_tr_b16 a[2:3], v10 offset:512
    buffer_load_dwordx4 v[164:167], v6, s[20:23], s44 offen offset:3072 sc1
    s_waitcnt lgkmcnt(2)
    v_mfma_f32_32x32x16_bf16 v[232:247], a[12:15], v[100:103], v[232:247]
    ds_read_b64_tr_b16 a[4:5], v11 offset:0
    ds_read_b64_tr_b16 a[6:7], v11 offset:512
    s_waitcnt lgkmcnt(2) vmcnt(15)
    v_mfma_f32_32x32x16_bf16 v[216:231], a[0:3], v[104:107], v[216:231]
    ds_read_b64_tr_b16 a[8:9], v10 offset:2048
    ds_read_b64_tr_b16 a[10:11], v10 offset:2560
    s_lshl_b32 s44, s56, 12
    s_add_u32 s44, s44, s55
    s_add_u32 s56, s56, 1
    s_and_b32 s56, s56, 7
    buffer_load_dwordx4 v[168:171], v6, s[20:23], s44 offen offset:0 sc1
    s_waitcnt lgkmcnt(2)
    v_mfma_f32_32x32x16_bf16 v[232:247], a[4:7], v[104:107], v[232:247]
    ds_read_b64_tr_b16 a[12:13], v11 offset:2048
    ds_read_b64_tr_b16 a[14:15], v11 offset:2560
    s_waitcnt lgkmcnt(2) vmcnt(15)
    v_mfma_f32_32x32x16_bf16 v[216:231], a[8:11], v[108:111], v[216:231]
    ds_read_b64_tr_b16 a[0:1], v10 offset:4096
    ds_read_b64_tr_b16 a[2:3], v10 offset:4608
    buffer_load_dwordx4 v[172:175], v6, s[20:23], s44 offen offset:1024 sc1
    s_waitcnt lgkmcnt(2)
    v_mfma_f32_32x32x16_bf16 v[232:247], a[12:15], v[108:111], v[232:247]
    ds_read_b64_tr_b16 a[4:5], v11 offset:4096
    ds_read_b64_tr_b16 a[6:7], v11 offset:4608
    s_waitcnt lgkmcnt(2) vmcnt(15)
    v_mfma_f32_32x32x16_bf16 v[216:231], a[0:3], v[112:115], v[216:231]
    ds_read_b64_tr_b16 a[8:9], v10 offset:6144
    ds_read_b64_tr_b16 a[10:11], v10 offset:6656
    buffer_load_dwordx4 v[176:179], v6, s[20:23], s44 offen offset:2048 sc1
    s_waitcnt lgkmcnt(2)
    v_mfma_f32_32x32x16_bf16 v[232:247], a[4:7], v[112:115], v[232:247]
    ds_read_b64_tr_b16 a[12:13], v11 offset:6144
    ds_read_b64_tr_b16 a[14:15], v11 offset:6656
    s_waitcnt lgkmcnt(2) vmcnt(15)
    v_mfma_f32_32x32x16_bf16 v[216:231], a[8:11], v[116:119], v[216:231]
    s_lshl_b32 s45, s57, 13
    v_add_u32 v10, s45, v8
    v_add_u32 v11, s45, v9
    s_add_u32 s57, s57, 1
    s_and_b32 s57, s57, 7
    ds_read_b64_tr_b16 a[0:1], v10 offset:0
    ds_read_b64_tr_b16 a[2:3], v10 offset:512
    buffer_load_dwordx4 v[180:183], v6, s[20:23], s44 offen offset:3072 sc1
    s_waitcnt lgkmcnt(2)
    v_mfma_f32_32x32x16_bf16 v[232:247], a[12:15], v[116:119], v[232:247]
    ds_read_b64_tr_b16 a[4:5], v11 offset:0
    ds_read_b64_tr_b16 a[6:7], v11 offset:512
    s_waitcnt lgkmcnt(2) vmcnt(15)
    v_mfma_f32_32x32x16_bf16 v[216:231], a[0:3], v[120:123], v[216:231]
    ds_read_b64_tr_b16 a[8:9], v10 offset:2048
    ds_read_b64_tr_b16 a[10:11], v10 offset:2560
    s_lshl_b32 s44, s56, 12
    s_add_u32 s44, s44, s55
    s_add_u32 s56, s56, 1
    s_and_b32 s56, s56, 7
    buffer_load_dwordx4 v[184:187], v6, s[20:23], s44 offen offset:0 sc1
    s_waitcnt lgkmcnt(2)
    v_mfma_f32_32x32x16_bf16 v[232:247], a[4:7], v[120:123], v[232:247]
    ds_read_b64_tr_b16 a[12:13], v11 offset:2048
    ds_read_b64_tr_b16 a[14:15], v11 offset:2560
    s_waitcnt lgkmcnt(2) vmcnt(15)
    v_mfma_f32_32x32x16_bf16 v[216:231], a[8:11], v[124:127], v[216:231]
    ds_read_b64_tr_b16 a[0:1], v10 offset:4096
    ds_read_b64_tr_b16 a[2:3], v10 offset:4608
    buffer_load_dwordx4 v[188:191], v6, s[20:23], s44 offen offset:1024 sc1
    s_waitcnt lgkmcnt(2)
    v_mfma_f32_32x32x16_bf16 v[232:247], a[12:15], v[124:127], v[232:247]
    ds_read_b64_tr_b16 a[4:5], v11 offset:4096
    ds_read_b64_tr_b16 a[6:7], v11 offset:4608
    s_waitcnt lgkmcnt(2) vmcnt(15)
    v_mfma_f32_32x32x16_bf16 v[216:231], a[0:3], v[128:131], v[216:231]
    ds_read_b64_tr_b16 a[8:9], v10 offset:6144
    ds_read_b64_tr_b16 a[10:11], v10 offset:6656
    buffer_load_dwordx4 v[192:195], v6, s[20:23], s44 offen offset:2048 sc1
    s_waitcnt lgkmcnt(2)
    v_mfma_f32_32x32x16_bf16 v[232:247], a[4:7], v[128:131], v[232:247]
    ds_read_b64_tr_b16 a[12:13], v11 offset:6144
    ds_read_b64_tr_b16 a[14:15], v11 offset:6656
    s_waitcnt lgkmcnt(2) vmcnt(15)
    v_mfma_f32_32x32x16_bf16 v[216:231], a[8:11], v[132:135], v[216:231]
    s_lshl_b32 s45, s57, 13
    v_add_u32 v10, s45, v8
    v_add_u32 v11, s45, v9
    s_add_u32 s57, s57, 1
    s_and_b32 s57, s57, 7
    ds_read_b64_tr_b16 a[0:1], v10 offset:0
    ds_read_b64_tr_b16 a[2:3], v10 offset:512
    buffer_load_dwordx4 v[196:199], v6, s[20:23], s44 offen offset:3072 sc1
    s_waitcnt lgkmcnt(2)
    v_mfma_f32_32x32x16_bf16 v[232:247], a[12:15], v[132:135], v[232:247]
    ds_read_b64_tr_b16 a[4:5], v11 offset:0
    ds_read_b64_tr_b16 a[6:7], v11 offset:512
    s_waitcnt lgkmcnt(2) vmcnt(15)
    v_mfma_f32_32x32x16_bf16 v[216:231], a[0:3], v[136:139], v[216:231]
    ds_read_b64_tr_b16 a[8:9], v10 offset:2048
    ds_read_b64_tr_b16 a[10:11], v10 offset:2560
    s_lshl_b32 s44, s56, 12
    s_add_u32 s44, s44, s55
    s_add_u32 s56, s56, 1
    s_and_b32 s56, s56, 7
    buffer_load_dwordx4 v[200:203], v6, s[20:23], s44 offen offset:0 sc1
    s_waitcnt lgkmcnt(2)
    v_mfma_f32_32x32x16_bf16 v[232:247], a[4:7], v[136:139], v[232:247]
    ds_read_b64_tr_b16 a[12:13], v11 offset:2048
    ds_read_b64_tr_b16 a[14:15], v11 offset:2560
    s_waitcnt lgkmcnt(2) vmcnt(15)
    v_mfma_f32_32x32x16_bf16 v[216:231], a[8:11], v[140:143], v[216:231]
    ds_read_b64_tr_b16 a[0:1], v10 offset:4096
    ds_read_b64_tr_b16 a[2:3], v10 offset:4608
    buffer_load_dwordx4 v[204:207], v6, s[20:23], s44 offen offset:1024 sc1
    s_waitcnt lgkmcnt(2)
    v_mfma_f32_32x32x16_bf16 v[232:247], a[12:15], v[140:143], v[232:247]
    ds_read_b64_tr_b16 a[4:5], v11 offset:4096
    ds_read_b64_tr_b16 a[6:7], v11 offset:4608
    s_waitcnt lgkmcnt(2) vmcnt(15)
    v_mfma_f32_32x32x16_bf16 v[216:231], a[0:3], v[144:147], v[216:231]
    ds_read_b64_tr_b16 a[8:9], v10 offset:6144
    ds_read_b64_tr_b16 a[10:11], v10 offset:6656
    buffer_load_dwordx4 v[208:211], v6, s[20:23], s44 offen offset:2048 sc1
    s_waitcnt lgkmcnt(2)
    v_mfma_f32_32x32x16_bf16 v[232:247], a[4:7], v[144:147], v[232:247]
    ds_read_b64_tr_b16 a[12:13], v11 offset:6144
    ds_read_b64_tr_b16 a[14:15], v11 offset:6656
    s_waitcnt lgkmcnt(2) vmcnt(15)
    v_mfma_f32_32x32x16_bf16 v[216:231], a[8:11], v[148:151], v[216:231]
    s_lshl_b32 s45, s57, 13
    v_add_u32 v10, s45, v8
    v_add_u32 v11, s45, v9
    s_add_u32 s57, s57, 1
    s_and_b32 s57, s57, 7
    ds_read_b64_tr_b16 a[0:1], v10 offset:0
    ds_read_b64_tr_b16 a[2:3], v10 offset:512
    buffer_load_dwordx4 v[212:215], v6, s[20:23], s44 offen offset:3072 sc1
    s_waitcnt lgkmcnt(2)
    v_mfma_f32_32x32x16_bf16 v[232:247], a[12:15], v[148:151], v[232:247]
    ds_read_b64_tr_b16 a[4:5], v11 offset:0
    ds_read_b64_tr_b16 a[6:7], v11 offset:512
    s_waitcnt lgkmcnt(2) vmcnt(15)
    v_mfma_f32_32x32x16_bf16 v[216:231], a[0:3], v[152:155], v[216:231]
    ds_read_b64_tr_b16 a[8:9], v10 offset:2048
    ds_read_b64_tr_b16 a[10:11], v10 offset:2560
    s_waitcnt lgkmcnt(2)
    v_mfma_f32_32x32x16_bf16 v[232:247], a[4:7], v[152:155], v[232:247]
    ds_read_b64_tr_b16 a[12:13], v11 offset:2048
    ds_read_b64_tr_b16 a[14:15], v11 offset:2560
    s_waitcnt lgkmcnt(2) vmcnt(14)
    v_mfma_f32_32x32x16_bf16 v[216:231], a[8:11], v[156:159], v[216:231]
    ds_read_b64_tr_b16 a[0:1], v10 offset:4096
    ds_read_b64_tr_b16 a[2:3], v10 offset:4608
    s_waitcnt lgkmcnt(2)
    v_mfma_f32_32x32x16_bf16 v[232:247], a[12:15], v[156:159], v[232:247]
    ds_read_b64_tr_b16 a[4:5], v11 offset:4096
    ds_read_b64_tr_b16 a[6:7], v11 offset:4608
    s_waitcnt lgkmcnt(2) vmcnt(13)
    v_mfma_f32_32x32x16_bf16 v[216:231], a[0:3], v[160:163], v[216:231]
    ds_read_b64_tr_b16 a[8:9], v10 offset:6144
    ds_read_b64_tr_b16 a[10:11], v10 offset:6656
    s_waitcnt lgkmcnt(2)
    v_mfma_f32_32x32x16_bf16 v[232:247], a[4:7], v[160:163], v[232:247]
    ds_read_b64_tr_b16 a[12:13], v11 offset:6144
    ds_read_b64_tr_b16 a[14:15], v11 offset:6656
    s_waitcnt lgkmcnt(2) vmcnt(12)
    v_mfma_f32_32x32x16_bf16 v[216:231], a[8:11], v[164:167], v[216:231]
    s_lshl_b32 s45, s57, 13
    v_add_u32 v10, s45, v8
    v_add_u32 v11, s45, v9
    s_add_u32 s57, s57, 1
    s_and_b32 s57, s57, 7
    ds_read_b64_tr_b16 a[0:1], v10 offset:0
    ds_read_b64_tr_b16 a[2:3], v10 offset:512
    s_waitcnt lgkmcnt(2)
    v_mfma_f32_32x32x16_bf16 v[232:247], a[12:15], v[164:167], v[232:247]
    ds_read_b64_tr_b16 a[4:5], v11 offset:0
    ds_read_b64_tr_b16 a[6:7], v11 offset:512
    s_waitcnt lgkmcnt(2) vmcnt(11)
    v_mfma_f32_32x32x16_bf16 v[216:231], a[0:3], v[168:171], v[216:231]
    ds_read_b64_tr_b16 a[8:9], v10 offset:2048
    ds_read_b64_tr_b16 a[10:11], v10 offset:2560
    s_waitcnt lgkmcnt(2)
    v_mfma_f32_32x32x16_bf16 v[232:247], a[4:7], v[168:171], v[232:247]
    ds_read_b64_tr_b16 a[12:13], v11 offset:2048
    ds_read_b64_tr_b16 a[14:15], v11 offset:2560
    s_waitcnt lgkmcnt(2) vmcnt(10)
    v_mfma_f32_32x32x16_bf16 v[216:231], a[8:11], v[172:175], v[216:231]
    ds_read_b64_tr_b16 a[0:1], v10 offset:4096
    ds_read_b64_tr_b16 a[2:3], v10 offset:4608
    s_waitcnt lgkmcnt(2)
    v_mfma_f32_32x32x16_bf16 v[232:247], a[12:15], v[172:175], v[232:247]
    ds_read_b64_tr_b16 a[4:5], v11 offset:4096
    ds_read_b64_tr_b16 a[6:7], v11 offset:4608
    s_waitcnt lgkmcnt(2) vmcnt(9)
    v_mfma_f32_32x32x16_bf16 v[216:231], a[0:3], v[176:179], v[216:231]
    ds_read_b64_tr_b16 a[8:9], v10 offset:6144
    ds_read_b64_tr_b16 a[10:11], v10 offset:6656
    s_waitcnt lgkmcnt(2)
    v_mfma_f32_32x32x16_bf16 v[232:247], a[4:7], v[176:179], v[232:247]
    ds_read_b64_tr_b16 a[12:13], v11 offset:6144
    ds_read_b64_tr_b16 a[14:15], v11 offset:6656
    s_waitcnt lgkmcnt(2) vmcnt(8)
    v_mfma_f32_32x32x16_bf16 v[216:231], a[8:11], v[180:183], v[216:231]
    s_lshl_b32 s45, s57, 13
    v_add_u32 v10, s45, v8
    v_add_u32 v11, s45, v9
    s_add_u32 s57, s57, 1
    s_and_b32 s57, s57, 7
    ds_read_b64_tr_b16 a[0:1], v10 offset:0
    ds_read_b64_tr_b16 a[2:3], v10 offset:512
    s_waitcnt lgkmcnt(2)
    v_mfma_f32_32x32x16_bf16 v[232:247], a[12:15], v[180:183], v[232:247]
    ds_read_b64_tr_b16 a[4:5], v11 offset:0
    ds_read_b64_tr_b16 a[6:7], v11 offset:512
    s_waitcnt lgkmcnt(2) vmcnt(7)
    v_mfma_f32_32x32x16_bf16 v[216:231], a[0:3], v[184:187], v[216:231]
    ds_read_b64_tr_b16 a[8:9], v10 offset:2048
    ds_read_b64_tr_b16 a[10:11], v10 offset:2560
    s_waitcnt lgkmcnt(2)
    v_mfma_f32_32x32x16_bf16 v[232:247], a[4:7], v[184:187], v[232:247]
    ds_read_b64_tr_b16 a[12:13], v11 offset:2048
    ds_read_b64_tr_b16 a[14:15], v11 offset:2560
    s_waitcnt lgkmcnt(2) vmcnt(6)
    v_mfma_f32_32x32x16_bf16 v[216:231], a[8:11], v[188:191], v[216:231]
    ds_read_b64_tr_b16 a[0:1], v10 offset:4096
    ds_read_b64_tr_b16 a[2:3], v10 offset:4608
    s_waitcnt lgkmcnt(2)
    v_mfma_f32_32x32x16_bf16 v[232:247], a[12:15], v[188:191], v[232:247]
    ds_read_b64_tr_b16 a[4:5], v11 offset:4096
    ds_read_b64_tr_b16 a[6:7], v11 offset:4608
    s_waitcnt lgkmcnt(2) vmcnt(5)
    v_mfma_f32_32x32x16_bf16 v[216:231], a[0:3], v[192:195], v[216:231]
    ds_read_b64_tr_b16 a[8:9], v10 offset:6144
    ds_read_b64_tr_b16 a[10:11], v10 offset:6656
    s_waitcnt lgkmcnt(2)
    v_mfma_f32_32x32x16_bf16 v[232:247], a[4:7], v[192:195], v[232:247]
    ds_read_b64_tr_b16 a[12:13], v11 offset:6144
    ds_read_b64_tr_b16 a[14:15], v11 offset:6656
    s_waitcnt lgkmcnt(2) vmcnt(4)
    v_mfma_f32_32x32x16_bf16 v[216:231], a[8:11], v[196:199], v[216:231]
    s_lshl_b32 s45, s57, 13
    v_add_u32 v10, s45, v8
    v_add_u32 v11, s45, v9
    s_add_u32 s57, s57, 1
    s_and_b32 s57, s57, 7
    ds_read_b64_tr_b16 a[0:1], v10 offset:0
    ds_read_b64_tr_b16 a[2:3], v10 offset:512
    s_waitcnt lgkmcnt(2)
    v_mfma_f32_32x32x16_bf16 v[232:247], a[12:15], v[196:199], v[232:247]
    ds_read_b64_tr_b16 a[4:5], v11 offset:0
    ds_read_b64_tr_b16 a[6:7], v11 offset:512
    s_waitcnt lgkmcnt(2) vmcnt(3)
    v_mfma_f32_32x32x16_bf16 v[216:231], a[0:3], v[200:203], v[216:231]
    ds_read_b64_tr_b16 a[8:9], v10 offset:2048
    ds_read_b64_tr_b16 a[10:11], v10 offset:2560
    s_waitcnt lgkmcnt(2)
    v_mfma_f32_32x32x16_bf16 v[232:247], a[4:7], v[200:203], v[232:247]
    ds_read_b64_tr_b16 a[12:13], v11 offset:2048
    ds_read_b64_tr_b16 a[14:15], v11 offset:2560
    s_waitcnt lgkmcnt(2) vmcnt(2)
    v_mfma_f32_32x32x16_bf16 v[216:231], a[8:11], v[204:207], v[216:231]
    ds_read_b64_tr_b16 a[0:1], v10 offset:4096
    ds_read_b64_tr_b16 a[2:3], v10 offset:4608
    s_waitcnt lgkmcnt(2)
    v_mfma_f32_32x32x16_bf16 v[232:247], a[12:15], v[204:207], v[232:247]
    ds_read_b64_tr_b16 a[4:5], v11 offset:4096
    ds_read_b64_tr_b16 a[6:7], v11 offset:4608
    s_waitcnt lgkmcnt(2) vmcnt(1)
    v_mfma_f32_32x32x16_bf16 v[216:231], a[0:3], v[208:211], v[216:231]
    ds_read_b64_tr_b16 a[8:9], v10 offset:6144
    ds_read_b64_tr_b16 a[10:11], v10 offset:6656
    s_waitcnt lgkmcnt(2)
    v_mfma_f32_32x32x16_bf16 v[232:247], a[4:7], v[208:211], v[232:247]
    ds_read_b64_tr_b16 a[12:13], v11 offset:6144
    ds_read_b64_tr_b16 a[14:15], v11 offset:6656
    s_waitcnt lgkmcnt(2) vmcnt(0)
    v_mfma_f32_32x32x16_bf16 v[216:231], a[8:11], v[212:215], v[216:231]
    s_waitcnt lgkmcnt(0)
    v_mfma_f32_32x32x16_bf16 v[232:247], a[12:15], v[212:215], v[232:247]
    s_nop 11
    v_lshlrev_b32 v32, 16, v16
    v_and_b32 v33, 0xffff0000, v16
    v_lshlrev_b32 v34, 16, v17
    v_and_b32 v35, 0xffff0000, v17
    v_pk_add_f32 v[32:33], v[32:33], v[216:217]
    v_pk_add_f32 v[34:35], v[34:35], v[218:219]
    v_cvt_pk_bf16_f32 v40, v32, v33
    v_cvt_pk_bf16_f32 v41, v34, v35
    v_lshlrev_b32 v32, 16, v20
    v_and_b32 v33, 0xffff0000, v20
    v_lshlrev_b32 v34, 16, v21
    v_and_b32 v35, 0xffff0000, v21
    v_pk_add_f32 v[32:33], v[32:33], v[224:225]
    v_pk_add_f32 v[34:35], v[34:35], v[226:227]
    v_cvt_pk_bf16_f32 v42, v32, v33
    v_cvt_pk_bf16_f32 v43, v34, v35
    buffer_store_dwordx4 v[40:43], v4, s[28:31], s52 offen offset:0 sc1
    v_lshlrev_b32 v32, 16, v18
    v_and_b32 v33, 0xffff0000, v18
    v_lshlrev_b32 v34, 16, v19
    v_and_b32 v35, 0xffff0000, v19
    v_pk_add_f32 v[32:33], v[32:33], v[220:221]
    v_pk_add_f32 v[34:35], v[34:35], v[222:223]
    v_cvt_pk_bf16_f32 v44, v32, v33
    v_cvt_pk_bf16_f32 v45, v34, v35
    v_lshlrev_b32 v32, 16, v22
    v_and_b32 v33, 0xffff0000, v22
    v_lshlrev_b32 v34, 16, v23
    v_and_b32 v35, 0xffff0000, v23
    v_pk_add_f32 v[32:33], v[32:33], v[228:229]
    v_pk_add_f32 v[34:35], v[34:35], v[230:231]
    v_cvt_pk_bf16_f32 v46, v32, v33
    v_cvt_pk_bf16_f32 v47, v34, v35
    buffer_store_dwordx4 v[44:47], v4, s[28:31], s52 offen offset:512 sc1
    v_lshlrev_b32 v32, 16, v24
    v_and_b32 v33, 0xffff0000, v24
    v_lshlrev_b32 v34, 16, v25
    v_and_b32 v35, 0xffff0000, v25
    v_pk_add_f32 v[32:33], v[32:33], v[232:233]
    v_pk_add_f32 v[34:35], v[34:35], v[234:235]
    v_cvt_pk_bf16_f32 v40, v32, v33
    v_cvt_pk_bf16_f32 v41, v34, v35
    v_lshlrev_b32 v32, 16, v28
    v_and_b32 v33, 0xffff0000, v28
    v_lshlrev_b32 v34, 16, v29
    v_and_b32 v35, 0xffff0000, v29
    v_pk_add_f32 v[32:33], v[32:33], v[240:241]
    v_pk_add_f32 v[34:35], v[34:35], v[242:243]
    v_cvt_pk_bf16_f32 v42, v32, v33
    v_cvt_pk_bf16_f32 v43, v34, v35
    buffer_store_dwordx4 v[40:43], v4, s[28:31], s52 offen offset:1024 sc1
    v_lshlrev_b32 v32, 16, v26
    v_and_b32 v33, 0xffff0000, v26
    v_lshlrev_b32 v34, 16, v27
    v_and_b32 v35, 0xffff0000, v27
    v_pk_add_f32 v[32:33], v[32:33], v[236:237]
    v_pk_add_f32 v[34:35], v[34:35], v[238:239]
    v_cvt_pk_bf16_f32 v44, v32, v33
    v_cvt_pk_bf16_f32 v45, v34, v35
    v_lshlrev_b32 v32, 16, v30
    v_and_b32 v33, 0xffff0000, v30
    v_lshlrev_b32 v34, 16, v31
    v_and_b32 v35, 0xffff0000, v31
    v_pk_add_f32 v[32:33], v[32:33], v[244:245]
    v_pk_add_f32 v[34:35], v[34:35], v[246:247]
    v_cvt_pk_bf16_f32 v46, v32, v33
    v_cvt_pk_bf16_f32 v47, v34, v35
    buffer_store_dwordx4 v[44:47], v4, s[28:31], s52 offen offset:1536 sc1
    v_mov_b32 v232, s100
    v_mov_b32 v233, v7
    s_lshl_b32 s46, s41, 11
    s_add_u32 s46, s46, 196608
    s_waitcnt vmcnt(0)
    s_barrier
    s_cmp_lg_u32 s42, 0
    s_cbranch_scc1 L_sequential_preLN__linear_kernel_hedgehog__swiglu_ffn__prompt_kernel_pub3
    s_lshl_b32 s44, s48, 7
    s_add_u32 s44, s44, s46
    s_mov_b64 exec, 0xffffffff
    buffer_store_dword v232, v233, s[24:27], s44 offen sc0 sc1
    s_mov_b64 exec, -1
L_sequential_preLN__linear_kernel_hedgehog__swiglu_ffn__prompt_kernel_pub3:
    s_branch L_sequential_preLN__linear_kernel_hedgehog__swiglu_ffn__prompt_kernel_fin
L_sequential_preLN__linear_kernel_hedgehog__swiglu_ffn__prompt_kernel_idle:
    s_sub_u32 s44, s40, 5
    s_cmp_ge_u32 s40, 8
    s_cselect_b32 s45, 4, 0
    s_sub_u32 s44, s44, s45
    s_mul_i32 s45, s41, 7
    s_add_u32 s44, s44, s45
    s_mul_i32 s44, s44, 47488
    v_lshlrev_b32 v3, 7, v0
    v_add_u32 v4, 0x8000, v3
    v_cmp_gt_u32 vcc, 115, v0
    s_mov_b32 s12, s66
    s_mov_b32 s13, s67
    s_mov_b32 s14, 0x510000
    s_mov_b32 s15, 0x00020000
    s_mov_b32 s16, s68
    s_mov_b32 s17, s69
    s_mov_b32 s18, 0x510000
    s_mov_b32 s19, 0x00020000
    v_cndmask_b32 v4, v5, v4, vcc
L_sequential_preLN__linear_kernel_hedgehog__swiglu_ffn__prompt_kernel_fin:
    s_mov_b64 s[4:5], s[64:65]
    s_mov_b64 s[6:7], s[66:67]
    s_mov_b64 s[8:9], s[68:69]
    s_load_dwordx2 s[66:67], s[0:1], 64
    s_and_b32 s40, s2, 6
    s_bfe_u32 s59, s2, 0x10003
    s_add_u32 s40, s40, s59
    s_lshr_b32 s59, s2, 4
    s_and_b32 s41, s2, 1
    s_lshl_b32 s41, s41, 4
    s_add_u32 s41, s41, s59
    v_lshlrev_b32 v3, 4, v2
    s_add_u32 s60, s10, 0xe00000
    s_addc_u32 s61, s11, 0
    s_mov_b32 s62, 0x40000
    s_mov_b32 s63, 0x00020000
    v_mov_b32 v192, s100
    v_lshlrev_b32 v193, 7, v2
    s_lshr_b32 s65, s41, 1
    s_lshl_b32 s65, s65, 11
    s_add_u32 s65, s65, 0x30000
    s_lshl_b32 s64, s41, 11
    s_lshl_b32 s43, s41, 2
    s_add_u32 s43, s43, s42
    s_mul_i32 s43, s43, 18432
    v_and_b32 v5, 7, v2
    v_bfe_u32 v6, v2, 4, 2
    v_lshlrev_b32 v6, 1, v6
    v_xor_b32 v5, v5, v6
    v_lshlrev_b32 v5, 4, v5
    v_mul_u32_u24 v6, 48, v1
    v_lshrrev_b32 v7, 3, v2
    v_add_u32 v6, v6, v7
    v_mul_u32_u24 v7, 9216, v6
    v_add_u32 v8, v5, v7
    v_add_u32 v9, 72704, v8
    v_add_u32 v10, 145408, v8
    v_mul_u32_u24 v7, 1152, v6
    v_add_u32 v11, v5, v7
    v_add_u32 v12, 8192, v11
    v_add_u32 v13, 16384, v11
    s_mov_b32 s12, s4
    s_mov_b32 s13, s5
    s_mov_b32 s14, 0x510000
    s_mov_b32 s15, 0x00020000
    s_mov_b32 s16, s6
    s_mov_b32 s17, s7
    s_mov_b32 s18, 0x510000
    s_mov_b32 s19, 0x00020000
    s_mov_b32 s28, s8
    s_mov_b32 s29, s9
    s_mov_b32 s30, 0x510000
    s_mov_b32 s31, 0x00020000
    s_add_u32 s24, s10, 0x1000000
    s_addc_u32 s25, s11, 0
    s_mov_b32 s26, 0x1200000
    s_mov_b32 s27, 0x00020000
    s_add_u32 s20, s10, 0xb00000
    s_addc_u32 s21, s11, 0
    s_mov_b32 s22, 0x240000
    s_mov_b32 s23, 0x00020000
    s_mul_i32 s47, s40, 1152
    s_mul_i32 s48, s40, 663552
    s_mul_i32 s46, s42, 6144
    s_add_u32 m0, s46, 0
    s_add_u32 s44, s47, 0
    buffer_load_dwordx4 v8, s[12:15], s44 offen offset:0 lds
    buffer_load_dwordx4 v9, s[12:15], s44 offen offset:1024 lds
    buffer_load_dwordx4 v10, s[12:15], s44 offen offset:2048 lds
    s_add_u32 m0, s46, 3072
    s_add_u32 s45, s47, 221184
    buffer_load_dwordx4 v8, s[12:15], s45 offen offset:0 lds
    buffer_load_dwordx4 v9, s[12:15], s45 offen offset:1024 lds
    buffer_load_dwordx4 v10, s[12:15], s45 offen offset:2048 lds
    s_add_u32 m0, s46, 24576
    s_add_u32 s44, s47, 1769472
    buffer_load_dwordx4 v8, s[12:15], s44 offen offset:0 lds
    buffer_load_dwordx4 v9, s[12:15], s44 offen offset:1024 lds
    buffer_load_dwordx4 v10, s[12:15], s44 offen offset:2048 lds
    s_add_u32 m0, s46, 27648
    s_add_u32 s45, s47, 1990656
    buffer_load_dwordx4 v8, s[12:15], s45 offen offset:0 lds
    buffer_load_dwordx4 v9, s[12:15], s45 offen offset:1024 lds
    buffer_load_dwordx4 v10, s[12:15], s45 offen offset:2048 lds
    s_add_u32 m0, s46, 49152
    s_add_u32 s44, s47, 3538944
    buffer_load_dwordx4 v8, s[12:15], s44 offen offset:0 lds
    buffer_load_dwordx4 v9, s[12:15], s44 offen offset:1024 lds
    buffer_load_dwordx4 v10, s[12:15], s44 offen offset:2048 lds
    s_add_u32 m0, s46, 52224
    s_add_u32 s45, s47, 3760128
    buffer_load_dwordx4 v8, s[12:15], s45 offen offset:0 lds
    buffer_load_dwordx4 v9, s[12:15], s45 offen offset:1024 lds
    buffer_load_dwordx4 v10, s[12:15], s45 offen offset:2048 lds
    v_bfe_u32 v5, v2, 2, 4
    v_bfe_u32 v6, v5, 1, 2
    v_xor_b32 v6, v6, v1
    v_lshlrev_b32 v6, 5, v6
    v_lshl_add_u32 v6, v5, 7, v6
    v_and_b32 v7, 3, v2
    v_lshl_add_u32 v14, v7, 3, v6
    v_add_u32 v15, 49152, v14
    v_add_u32 v16, 98304, v14
    v_lshl_add_u32 v5, v1, 10, v3
    v_add_u32 v20, 73728, v5
    v_add_u32 v21, 110592, v5
    v_add_u32 v22, 73728, v3
    v_add_u32 v23, 110592, v3
    v_lshrrev_b32 v5, 1, v1
    v_lshl_add_u32 v24, v5, 12, v22
    v_and_b32 v5, 1, v1
    v_lshl_add_u32 v24, v5, 3, v24
    v_add_u32 v25, 49152, v24
    v_lshl_add_u32 v27, v1, 11, v3
    s_mul_i32 s52, s40, 2359296
    s_mul_i32 s53, s41, 73728
    s_add_u32 s52, s52, s53
    s_mov_b32 s50, 0xbfb8aa3b
    v_mul_u32_u24 v5, 27, v1
    v_add_u32 v5, v5, v2
    v_cmp_gt_u32 vcc, 27, v2
    s_mul_i32 s54, s59, 108
    v_add_u32 v5, s54, v5
    v_mul_u32_u24 v6, 21846, v5
    v_lshrrev_b32 v6, 16, v6
    v_mul_u32_u24 v7, 3, v6
    v_sub_u32 v7, v5, v7
    v_lshlrev_b32 v7, 7, v7
    v_mul_u32_u24 v4, 9216, v6
    v_add_u32 v4, v4, v7
    v_mul_u32_u24 v5, 1152, v6
    v_add_u32 v5, v5, v7
    v_mov_b32 v7, 0x40000000
    v_cndmask_b32 v4, v7, v4, vcc
    v_cndmask_b32 v5, v7, v5, vcc
    buffer_load_dword v6, v4, s[12:15], s47 offen offset:0
    buffer_load_dword v6, v4, s[16:19], s47 offen offset:0
    s_mov_b32 s55, 0x8000
    s_mov_b64 exec, 0x1ff
L_sequential_preLN__linear_kernel_hedgehog__swiglu_ffn__prompt_kernelf_poll3:
    buffer_load_dword v212, v193, s[60:63], s65 offen offset:0 sc0 sc1
    s_waitcnt vmcnt(0)
    v_cmp_ne_u32 vcc, v212, v192
    s_sub_u32 s55, s55, 1
    s_cbranch_scc1 L_sequential_preLN__linear_kernel_hedgehog__swiglu_ffn__prompt_kernelf_poll3d
    s_cbranch_vccz L_sequential_preLN__linear_kernel_hedgehog__swiglu_ffn__prompt_kernelf_poll3d
    s_sleep 1
    s_branch L_sequential_preLN__linear_kernel_hedgehog__swiglu_ffn__prompt_kernelf_poll3
L_sequential_preLN__linear_kernel_hedgehog__swiglu_ffn__prompt_kernelf_poll3d:
    s_mov_b64 exec, -1
    buffer_load_dwordx4 v[32:35], v3, s[20:23], s43 offen offset:0 sc1
    buffer_load_dwordx4 v[36:39], v3, s[20:23], s43 offen offset:1024 sc1
    buffer_load_dwordx4 v[40:43], v3, s[20:23], s43 offen offset:2048 sc1
    buffer_load_dwordx4 v[44:47], v3, s[20:23], s43 offen offset:3072 sc1
    s_add_u32 s43, s43, 4096
    buffer_load_dwordx4 v[48:51], v3, s[20:23], s43 offen offset:0 sc1
    buffer_load_dwordx4 v[52:55], v3, s[20:23], s43 offen offset:1024 sc1
    buffer_load_dwordx4 v[56:59], v3, s[20:23], s43 offen offset:2048 sc1
    buffer_load_dwordx4 v[60:63], v3, s[20:23], s43 offen offset:3072 sc1
    s_add_u32 s43, s43, 4096
    buffer_load_dwordx4 v[64:67], v3, s[20:23], s43 offen offset:0 sc1
    buffer_load_dwordx4 v[68:71], v3, s[20:23], s43 offen offset:1024 sc1
    buffer_load_dwordx4 v[72:75], v3, s[20:23], s43 offen offset:2048 sc1
    buffer_load_dwordx4 v[76:79], v3, s[20:23], s43 offen offset:3072 sc1
    s_add_u32 s43, s43, 4096
    buffer_load_dwordx4 v[80:83], v3, s[20:23], s43 offen offset:0 sc1
    buffer_load_dwordx4 v[84:87], v3, s[20:23], s43 offen offset:1024 sc1
    buffer_load_dwordx4 v[88:91], v3, s[20:23], s43 offen offset:2048 sc1
    buffer_load_dwordx4 v[92:95], v3, s[20:23], s43 offen offset:3072 sc1
    s_add_u32 s43, s43, 4096
    buffer_load_dwordx4 v[96:99], v3, s[20:23], s43 offen offset:0 sc1
    buffer_load_dwordx4 v[100:103], v3, s[20:23], s43 offen offset:1024 sc1
    s_mov_b32 s49, 0x3f803f80
    v_mov_b32 v192, 0
    v_mov_b32 v193, 0
    v_mov_b32 v194, 0
    v_mov_b32 v195, 0
    s_waitcnt vmcnt(15)
    v_dot2c_f32_bf16 v192, s49, v32
    v_dot2c_f32_bf16 v194, v32, v32
    v_dot2c_f32_bf16 v193, s49, v33
    v_dot2c_f32_bf16 v195, v33, v33
    v_dot2c_f32_bf16 v192, s49, v34
    v_dot2c_f32_bf16 v194, v34, v34
    v_dot2c_f32_bf16 v193, s49, v35
    v_dot2c_f32_bf16 v195, v35, v35
    v_dot2c_f32_bf16 v192, s49, v36
    v_dot2c_f32_bf16 v194, v36, v36
    v_dot2c_f32_bf16 v193, s49, v37
    v_dot2c_f32_bf16 v195, v37, v37
    v_dot2c_f32_bf16 v192, s49, v38
    v_dot2c_f32_bf16 v194, v38, v38
    v_dot2c_f32_bf16 v193, s49, v39
    v_dot2c_f32_bf16 v195, v39, v39
    v_dot2c_f32_bf16 v192, s49, v40
    v_dot2c_f32_bf16 v194, v40, v40
    v_dot2c_f32_bf16 v193, s49, v41
    v_dot2c_f32_bf16 v195, v41, v41
    v_dot2c_f32_bf16 v192, s49, v42
    v_dot2c_f32_bf16 v194, v42, v42
    v_dot2c_f32_bf16 v193, s49, v43
    v_dot2c_f32_bf16 v195, v43, v43
    s_waitcnt vmcnt(12)
    v_dot2c_f32_bf16 v192, s49, v44
    v_dot2c_f32_bf16 v194, v44, v44
    v_dot2c_f32_bf16 v193, s49, v45
    v_dot2c_f32_bf16 v195, v45, v45
    v_dot2c_f32_bf16 v192, s49, v46
    v_dot2c_f32_bf16 v194, v46, v46
    v_dot2c_f32_bf16 v193, s49, v47
    v_dot2c_f32_bf16 v195, v47, v47
    v_dot2c_f32_bf16 v192, s49, v48
    v_dot2c_f32_bf16 v194, v48, v48
    v_dot2c_f32_bf16 v193, s49, v49
    v_dot2c_f32_bf16 v195, v49, v49
    v_dot2c_f32_bf16 v192, s49, v50
    v_dot2c_f32_bf16 v194, v50, v50
    v_dot2c_f32_bf16 v193, s49, v51
    v_dot2c_f32_bf16 v195, v51, v51
    v_dot2c_f32_bf16 v192, s49, v52
    v_dot2c_f32_bf16 v194, v52, v52
    v_dot2c_f32_bf16 v193, s49, v53
    v_dot2c_f32_bf16 v195, v53, v53
    v_dot2c_f32_bf16 v192, s49, v54
    v_dot2c_f32_bf16 v194, v54, v54
    v_dot2c_f32_bf16 v193, s49, v55
    v_dot2c_f32_bf16 v195, v55, v55
    s_waitcnt vmcnt(9)
    v_dot2c_f32_bf16 v192, s49, v56
    v_dot2c_f32_bf16 v194, v56, v56
    v_dot2c_f32_bf16 v193, s49, v57
    v_dot2c_f32_bf16 v195, v57, v57
    v_dot2c_f32_bf16 v192, s49, v58
    v_dot2c_f32_bf16 v194, v58, v58
    v_dot2c_f32_bf16 v193, s49, v59
    v_dot2c_f32_bf16 v195, v59, v59
    v_dot2c_f32_bf16 v192, s49, v60
    v_dot2c_f32_bf16 v194, v60, v60
    v_dot2c_f32_bf16 v193, s49, v61
    v_dot2c_f32_bf16 v195, v61, v61
    v_dot2c_f32_bf16 v192, s49, v62
    v_dot2c_f32_bf16 v194, v62, v62
    v_dot2c_f32_bf16 v193, s49, v63
    v_dot2c_f32_bf16 v195, v63, v63
    v_dot2c_f32_bf16 v192, s49, v64
    v_dot2c_f32_bf16 v194, v64, v64
    v_dot2c_f32_bf16 v193, s49, v65
    v_dot2c_f32_bf16 v195, v65, v65
    v_dot2c_f32_bf16 v192, s49, v66
    v_dot2c_f32_bf16 v194, v66, v66
    v_dot2c_f32_bf16 v193, s49, v67
    v_dot2c_f32_bf16 v195, v67, v67
    s_waitcnt vmcnt(6)
    v_dot2c_f32_bf16 v192, s49, v68
    v_dot2c_f32_bf16 v194, v68, v68
    v_dot2c_f32_bf16 v193, s49, v69
    v_dot2c_f32_bf16 v195, v69, v69
    v_dot2c_f32_bf16 v192, s49, v70
    v_dot2c_f32_bf16 v194, v70, v70
    v_dot2c_f32_bf16 v193, s49, v71
    v_dot2c_f32_bf16 v195, v71, v71
    v_dot2c_f32_bf16 v192, s49, v72
    v_dot2c_f32_bf16 v194, v72, v72
    v_dot2c_f32_bf16 v193, s49, v73
    v_dot2c_f32_bf16 v195, v73, v73
    v_dot2c_f32_bf16 v192, s49, v74
    v_dot2c_f32_bf16 v194, v74, v74
    v_dot2c_f32_bf16 v193, s49, v75
    v_dot2c_f32_bf16 v195, v75, v75
    v_dot2c_f32_bf16 v192, s49, v76
    v_dot2c_f32_bf16 v194, v76, v76
    v_dot2c_f32_bf16 v193, s49, v77
    v_dot2c_f32_bf16 v195, v77, v77
    v_dot2c_f32_bf16 v192, s49, v78
    v_dot2c_f32_bf16 v194, v78, v78
    v_dot2c_f32_bf16 v193, s49, v79
    v_dot2c_f32_bf16 v195, v79, v79
    s_waitcnt vmcnt(3)
    v_dot2c_f32_bf16 v192, s49, v80
    v_dot2c_f32_bf16 v194, v80, v80
    v_dot2c_f32_bf16 v193, s49, v81
    v_dot2c_f32_bf16 v195, v81, v81
    v_dot2c_f32_bf16 v192, s49, v82
    v_dot2c_f32_bf16 v194, v82, v82
    v_dot2c_f32_bf16 v193, s49, v83
    v_dot2c_f32_bf16 v195, v83, v83
    v_dot2c_f32_bf16 v192, s49, v84
    v_dot2c_f32_bf16 v194, v84, v84
    v_dot2c_f32_bf16 v193, s49, v85
    v_dot2c_f32_bf16 v195, v85, v85
    v_dot2c_f32_bf16 v192, s49, v86
    v_dot2c_f32_bf16 v194, v86, v86
    v_dot2c_f32_bf16 v193, s49, v87
    v_dot2c_f32_bf16 v195, v87, v87
    v_dot2c_f32_bf16 v192, s49, v88
    v_dot2c_f32_bf16 v194, v88, v88
    v_dot2c_f32_bf16 v193, s49, v89
    v_dot2c_f32_bf16 v195, v89, v89
    v_dot2c_f32_bf16 v192, s49, v90
    v_dot2c_f32_bf16 v194, v90, v90
    v_dot2c_f32_bf16 v193, s49, v91
    v_dot2c_f32_bf16 v195, v91, v91
    s_waitcnt vmcnt(0)
    v_dot2c_f32_bf16 v192, s49, v92
    v_dot2c_f32_bf16 v194, v92, v92
    v_dot2c_f32_bf16 v193, s49, v93
    v_dot2c_f32_bf16 v195, v93, v93
    v_dot2c_f32_bf16 v192, s49, v94
    v_dot2c_f32_bf16 v194, v94, v94
    v_dot2c_f32_bf16 v193, s49, v95
    v_dot2c_f32_bf16 v195, v95, v95
    v_dot2c_f32_bf16 v192, s49, v96
    v_dot2c_f32_bf16 v194, v96, v96
    v_dot2c_f32_bf16 v193, s49, v97
    v_dot2c_f32_bf16 v195, v97, v97
    v_dot2c_f32_bf16 v192, s49, v98
    v_dot2c_f32_bf16 v194, v98, v98
    v_dot2c_f32_bf16 v193, s49, v99
    v_dot2c_f32_bf16 v195, v99, v99
    v_dot2c_f32_bf16 v192, s49, v100
    v_dot2c_f32_bf16 v194, v100, v100
    v_dot2c_f32_bf16 v193, s49, v101
    v_dot2c_f32_bf16 v195, v101, v101
    v_dot2c_f32_bf16 v192, s49, v102
    v_dot2c_f32_bf16 v194, v102, v102
    v_dot2c_f32_bf16 v193, s49, v103
    v_dot2c_f32_bf16 v195, v103, v103
    s_nop 2
    v_add_f32 v192, v192, v193
    v_add_f32 v194, v194, v195
    v_mov_b32 v193, v192
    v_mov_b32 v195, v194
    s_nop 1
    v_permlane16_swap_b32 v192, v193
    v_permlane16_swap_b32 v194, v195
    s_nop 0
    v_add_f32 v192, v192, v193
    v_add_f32 v194, v194, v195
    v_mov_b32 v193, v192
    v_mov_b32 v195, v194
    s_nop 1
    v_permlane32_swap_b32 v192, v193
    v_permlane32_swap_b32 v194, v195
    s_nop 0
    v_add_f32 v192, v192, v193
    v_add_f32 v194, v194, v195
    v_mul_f32 v192, 0x3ae38e39, v192
    v_mul_f32 v194, 0x3ae38e39, v194
    v_fma_f32 v194, -v192, v192, v194
    v_max_f32 v194, 0, v194
    v_add_f32 v194, 0x3727c5ac, v194
    v_rsq_f32 v194, v194
    s_nop 0
    v_mul_f32 v196, v192, v194
    v_sub_f32 v196, 0, v196
    v_lshlrev_b32 v198, 16, v32
    v_and_b32 v199, 0xffff0000, v32
    v_pk_fma_f32 v[198:199], v[198:199], v[194:195], v[196:197] op_sel_hi:[1,0,0]
    v_cvt_pk_bf16_f32 v32, v198, v199
    v_lshlrev_b32 v200, 16, v33
    v_and_b32 v201, 0xffff0000, v33
    v_pk_fma_f32 v[200:201], v[200:201], v[194:195], v[196:197] op_sel_hi:[1,0,0]
    v_cvt_pk_bf16_f32 v33, v200, v201
    v_lshlrev_b32 v198, 16, v34
    v_and_b32 v199, 0xffff0000, v34
    v_pk_fma_f32 v[198:199], v[198:199], v[194:195], v[196:197] op_sel_hi:[1,0,0]
    v_cvt_pk_bf16_f32 v34, v198, v199
    v_lshlrev_b32 v200, 16, v35
    v_and_b32 v201, 0xffff0000, v35
    v_pk_fma_f32 v[200:201], v[200:201], v[194:195], v[196:197] op_sel_hi:[1,0,0]
    v_cvt_pk_bf16_f32 v35, v200, v201
    ds_write_b128 v20, v[32:35] offset:0
    v_lshlrev_b32 v198, 16, v36
    v_and_b32 v199, 0xffff0000, v36
    v_pk_fma_f32 v[198:199], v[198:199], v[194:195], v[196:197] op_sel_hi:[1,0,0]
    v_cvt_pk_bf16_f32 v36, v198, v199
    v_lshlrev_b32 v200, 16, v37
    v_and_b32 v201, 0xffff0000, v37
    v_pk_fma_f32 v[200:201], v[200:201], v[194:195], v[196:197] op_sel_hi:[1,0,0]
    v_cvt_pk_bf16_f32 v37, v200, v201
    v_lshlrev_b32 v198, 16, v38
    v_and_b32 v199, 0xffff0000, v38
    v_pk_fma_f32 v[198:199], v[198:199], v[194:195], v[196:197] op_sel_hi:[1,0,0]
    v_cvt_pk_bf16_f32 v38, v198, v199
    v_lshlrev_b32 v200, 16, v39
    v_and_b32 v201, 0xffff0000, v39
    v_pk_fma_f32 v[200:201], v[200:201], v[194:195], v[196:197] op_sel_hi:[1,0,0]
    v_cvt_pk_bf16_f32 v39, v200, v201
    ds_write_b128 v20, v[36:39] offset:4096
    v_lshlrev_b32 v198, 16, v40
    v_and_b32 v199, 0xffff0000, v40
    v_pk_fma_f32 v[198:199], v[198:199], v[194:195], v[196:197] op_sel_hi:[1,0,0]
    v_cvt_pk_bf16_f32 v40, v198, v199
    v_lshlrev_b32 v200, 16, v41
    v_and_b32 v201, 0xffff0000, v41
    v_pk_fma_f32 v[200:201], v[200:201], v[194:195], v[196:197] op_sel_hi:[1,0,0]
    v_cvt_pk_bf16_f32 v41, v200, v201
    v_lshlrev_b32 v198, 16, v42
    v_and_b32 v199, 0xffff0000, v42
    v_pk_fma_f32 v[198:199], v[198:199], v[194:195], v[196:197] op_sel_hi:[1,0,0]
    v_cvt_pk_bf16_f32 v42, v198, v199
    v_lshlrev_b32 v200, 16, v43
    v_and_b32 v201, 0xffff0000, v43
    v_pk_fma_f32 v[200:201], v[200:201], v[194:195], v[196:197] op_sel_hi:[1,0,0]
    v_cvt_pk_bf16_f32 v43, v200, v201
    ds_write_b128 v20, v[40:43] offset:8192
    v_lshlrev_b32 v198, 16, v44
    v_and_b32 v199, 0xffff0000, v44
    v_pk_fma_f32 v[198:199], v[198:199], v[194:195], v[196:197] op_sel_hi:[1,0,0]
    v_cvt_pk_bf16_f32 v44, v198, v199
    v_lshlrev_b32 v200, 16, v45
    v_and_b32 v201, 0xffff0000, v45
    v_pk_fma_f32 v[200:201], v[200:201], v[194:195], v[196:197] op_sel_hi:[1,0,0]
    v_cvt_pk_bf16_f32 v45, v200, v201
    v_lshlrev_b32 v198, 16, v46
    v_and_b32 v199, 0xffff0000, v46
    v_pk_fma_f32 v[198:199], v[198:199], v[194:195], v[196:197] op_sel_hi:[1,0,0]
    v_cvt_pk_bf16_f32 v46, v198, v199
    v_lshlrev_b32 v200, 16, v47
    v_and_b32 v201, 0xffff0000, v47
    v_pk_fma_f32 v[200:201], v[200:201], v[194:195], v[196:197] op_sel_hi:[1,0,0]
    v_cvt_pk_bf16_f32 v47, v200, v201
    ds_write_b128 v20, v[44:47] offset:12288
    v_lshlrev_b32 v198, 16, v48
    v_and_b32 v199, 0xffff0000, v48
    v_pk_fma_f32 v[198:199], v[198:199], v[194:195], v[196:197] op_sel_hi:[1,0,0]
    v_cvt_pk_bf16_f32 v48, v198, v199
    v_lshlrev_b32 v200, 16, v49
    v_and_b32 v201, 0xffff0000, v49
    v_pk_fma_f32 v[200:201], v[200:201], v[194:195], v[196:197] op_sel_hi:[1,0,0]
    v_cvt_pk_bf16_f32 v49, v200, v201
    v_lshlrev_b32 v198, 16, v50
    v_and_b32 v199, 0xffff0000, v50
    v_pk_fma_f32 v[198:199], v[198:199], v[194:195], v[196:197] op_sel_hi:[1,0,0]
    v_cvt_pk_bf16_f32 v50, v198, v199
    v_lshlrev_b32 v200, 16, v51
    v_and_b32 v201, 0xffff0000, v51
    v_pk_fma_f32 v[200:201], v[200:201], v[194:195], v[196:197] op_sel_hi:[1,0,0]
    v_cvt_pk_bf16_f32 v51, v200, v201
    ds_write_b128 v20, v[48:51] offset:16384
    v_lshlrev_b32 v198, 16, v52
    v_and_b32 v199, 0xffff0000, v52
    v_pk_fma_f32 v[198:199], v[198:199], v[194:195], v[196:197] op_sel_hi:[1,0,0]
    v_cvt_pk_bf16_f32 v52, v198, v199
    v_lshlrev_b32 v200, 16, v53
    v_and_b32 v201, 0xffff0000, v53
    v_pk_fma_f32 v[200:201], v[200:201], v[194:195], v[196:197] op_sel_hi:[1,0,0]
    v_cvt_pk_bf16_f32 v53, v200, v201
    v_lshlrev_b32 v198, 16, v54
    v_and_b32 v199, 0xffff0000, v54
    v_pk_fma_f32 v[198:199], v[198:199], v[194:195], v[196:197] op_sel_hi:[1,0,0]
    v_cvt_pk_bf16_f32 v54, v198, v199
    v_lshlrev_b32 v200, 16, v55
    v_and_b32 v201, 0xffff0000, v55
    v_pk_fma_f32 v[200:201], v[200:201], v[194:195], v[196:197] op_sel_hi:[1,0,0]
    v_cvt_pk_bf16_f32 v55, v200, v201
    ds_write_b128 v20, v[52:55] offset:20480
    v_lshlrev_b32 v198, 16, v56
    v_and_b32 v199, 0xffff0000, v56
    v_pk_fma_f32 v[198:199], v[198:199], v[194:195], v[196:197] op_sel_hi:[1,0,0]
    v_cvt_pk_bf16_f32 v56, v198, v199
    v_lshlrev_b32 v200, 16, v57
    v_and_b32 v201, 0xffff0000, v57
    v_pk_fma_f32 v[200:201], v[200:201], v[194:195], v[196:197] op_sel_hi:[1,0,0]
    v_cvt_pk_bf16_f32 v57, v200, v201
    v_lshlrev_b32 v198, 16, v58
    v_and_b32 v199, 0xffff0000, v58
    v_pk_fma_f32 v[198:199], v[198:199], v[194:195], v[196:197] op_sel_hi:[1,0,0]
    v_cvt_pk_bf16_f32 v58, v198, v199
    v_lshlrev_b32 v200, 16, v59
    v_and_b32 v201, 0xffff0000, v59
    v_pk_fma_f32 v[200:201], v[200:201], v[194:195], v[196:197] op_sel_hi:[1,0,0]
    v_cvt_pk_bf16_f32 v59, v200, v201
    ds_write_b128 v20, v[56:59] offset:24576
    v_lshlrev_b32 v198, 16, v60
    v_and_b32 v199, 0xffff0000, v60
    v_pk_fma_f32 v[198:199], v[198:199], v[194:195], v[196:197] op_sel_hi:[1,0,0]
    v_cvt_pk_bf16_f32 v60, v198, v199
    v_lshlrev_b32 v200, 16, v61
    v_and_b32 v201, 0xffff0000, v61
    v_pk_fma_f32 v[200:201], v[200:201], v[194:195], v[196:197] op_sel_hi:[1,0,0]
    v_cvt_pk_bf16_f32 v61, v200, v201
    v_lshlrev_b32 v198, 16, v62
    v_and_b32 v199, 0xffff0000, v62
    v_pk_fma_f32 v[198:199], v[198:199], v[194:195], v[196:197] op_sel_hi:[1,0,0]
    v_cvt_pk_bf16_f32 v62, v198, v199
    v_lshlrev_b32 v200, 16, v63
    v_and_b32 v201, 0xffff0000, v63
    v_pk_fma_f32 v[200:201], v[200:201], v[194:195], v[196:197] op_sel_hi:[1,0,0]
    v_cvt_pk_bf16_f32 v63, v200, v201
    ds_write_b128 v20, v[60:63] offset:28672
    v_lshlrev_b32 v198, 16, v64
    v_and_b32 v199, 0xffff0000, v64
    v_pk_fma_f32 v[198:199], v[198:199], v[194:195], v[196:197] op_sel_hi:[1,0,0]
    v_cvt_pk_bf16_f32 v64, v198, v199
    v_lshlrev_b32 v200, 16, v65
    v_and_b32 v201, 0xffff0000, v65
    v_pk_fma_f32 v[200:201], v[200:201], v[194:195], v[196:197] op_sel_hi:[1,0,0]
    v_cvt_pk_bf16_f32 v65, v200, v201
    v_lshlrev_b32 v198, 16, v66
    v_and_b32 v199, 0xffff0000, v66
    v_pk_fma_f32 v[198:199], v[198:199], v[194:195], v[196:197] op_sel_hi:[1,0,0]
    v_cvt_pk_bf16_f32 v66, v198, v199
    v_lshlrev_b32 v200, 16, v67
    v_and_b32 v201, 0xffff0000, v67
    v_pk_fma_f32 v[200:201], v[200:201], v[194:195], v[196:197] op_sel_hi:[1,0,0]
    v_cvt_pk_bf16_f32 v67, v200, v201
    ds_write_b128 v20, v[64:67] offset:32768
    v_lshlrev_b32 v198, 16, v68
    v_and_b32 v199, 0xffff0000, v68
    v_pk_fma_f32 v[198:199], v[198:199], v[194:195], v[196:197] op_sel_hi:[1,0,0]
    v_cvt_pk_bf16_f32 v68, v198, v199
    v_lshlrev_b32 v200, 16, v69
    v_and_b32 v201, 0xffff0000, v69
    v_pk_fma_f32 v[200:201], v[200:201], v[194:195], v[196:197] op_sel_hi:[1,0,0]
    v_cvt_pk_bf16_f32 v69, v200, v201
    v_lshlrev_b32 v198, 16, v70
    v_and_b32 v199, 0xffff0000, v70
    v_pk_fma_f32 v[198:199], v[198:199], v[194:195], v[196:197] op_sel_hi:[1,0,0]
    v_cvt_pk_bf16_f32 v70, v198, v199
    v_lshlrev_b32 v200, 16, v71
    v_and_b32 v201, 0xffff0000, v71
    v_pk_fma_f32 v[200:201], v[200:201], v[194:195], v[196:197] op_sel_hi:[1,0,0]
    v_cvt_pk_bf16_f32 v71, v200, v201
    ds_write_b128 v21, v[68:71] offset:0
    v_lshlrev_b32 v198, 16, v72
    v_and_b32 v199, 0xffff0000, v72
    v_pk_fma_f32 v[198:199], v[198:199], v[194:195], v[196:197] op_sel_hi:[1,0,0]
    v_cvt_pk_bf16_f32 v72, v198, v199
    v_lshlrev_b32 v200, 16, v73
    v_and_b32 v201, 0xffff0000, v73
    v_pk_fma_f32 v[200:201], v[200:201], v[194:195], v[196:197] op_sel_hi:[1,0,0]
    v_cvt_pk_bf16_f32 v73, v200, v201
    v_lshlrev_b32 v198, 16, v74
    v_and_b32 v199, 0xffff0000, v74
    v_pk_fma_f32 v[198:199], v[198:199], v[194:195], v[196:197] op_sel_hi:[1,0,0]
    v_cvt_pk_bf16_f32 v74, v198, v199
    v_lshlrev_b32 v200, 16, v75
    v_and_b32 v201, 0xffff0000, v75
    v_pk_fma_f32 v[200:201], v[200:201], v[194:195], v[196:197] op_sel_hi:[1,0,0]
    v_cvt_pk_bf16_f32 v75, v200, v201
    ds_write_b128 v21, v[72:75] offset:4096
    v_lshlrev_b32 v198, 16, v76
    v_and_b32 v199, 0xffff0000, v76
    v_pk_fma_f32 v[198:199], v[198:199], v[194:195], v[196:197] op_sel_hi:[1,0,0]
    v_cvt_pk_bf16_f32 v76, v198, v199
    v_lshlrev_b32 v200, 16, v77
    v_and_b32 v201, 0xffff0000, v77
    v_pk_fma_f32 v[200:201], v[200:201], v[194:195], v[196:197] op_sel_hi:[1,0,0]
    v_cvt_pk_bf16_f32 v77, v200, v201
    v_lshlrev_b32 v198, 16, v78
    v_and_b32 v199, 0xffff0000, v78
    v_pk_fma_f32 v[198:199], v[198:199], v[194:195], v[196:197] op_sel_hi:[1,0,0]
    v_cvt_pk_bf16_f32 v78, v198, v199
    v_lshlrev_b32 v200, 16, v79
    v_and_b32 v201, 0xffff0000, v79
    v_pk_fma_f32 v[200:201], v[200:201], v[194:195], v[196:197] op_sel_hi:[1,0,0]
    v_cvt_pk_bf16_f32 v79, v200, v201
    ds_write_b128 v21, v[76:79] offset:8192
    v_lshlrev_b32 v198, 16, v80
    v_and_b32 v199, 0xffff0000, v80
    v_pk_fma_f32 v[198:199], v[198:199], v[194:195], v[196:197] op_sel_hi:[1,0,0]
    v_cvt_pk_bf16_f32 v80, v198, v199
    v_lshlrev_b32 v200, 16, v81
    v_and_b32 v201, 0xffff0000, v81
    v_pk_fma_f32 v[200:201], v[200:201], v[194:195], v[196:197] op_sel_hi:[1,0,0]
    v_cvt_pk_bf16_f32 v81, v200, v201
    v_lshlrev_b32 v198, 16, v82
    v_and_b32 v199, 0xffff0000, v82
    v_pk_fma_f32 v[198:199], v[198:199], v[194:195], v[196:197] op_sel_hi:[1,0,0]
    v_cvt_pk_bf16_f32 v82, v198, v199
    v_lshlrev_b32 v200, 16, v83
    v_and_b32 v201, 0xffff0000, v83
    v_pk_fma_f32 v[200:201], v[200:201], v[194:195], v[196:197] op_sel_hi:[1,0,0]
    v_cvt_pk_bf16_f32 v83, v200, v201
    ds_write_b128 v21, v[80:83] offset:12288
    v_lshlrev_b32 v198, 16, v84
    v_and_b32 v199, 0xffff0000, v84
    v_pk_fma_f32 v[198:199], v[198:199], v[194:195], v[196:197] op_sel_hi:[1,0,0]
    v_cvt_pk_bf16_f32 v84, v198, v199
    v_lshlrev_b32 v200, 16, v85
    v_and_b32 v201, 0xffff0000, v85
    v_pk_fma_f32 v[200:201], v[200:201], v[194:195], v[196:197] op_sel_hi:[1,0,0]
    v_cvt_pk_bf16_f32 v85, v200, v201
    v_lshlrev_b32 v198, 16, v86
    v_and_b32 v199, 0xffff0000, v86
    v_pk_fma_f32 v[198:199], v[198:199], v[194:195], v[196:197] op_sel_hi:[1,0,0]
    v_cvt_pk_bf16_f32 v86, v198, v199
    v_lshlrev_b32 v200, 16, v87
    v_and_b32 v201, 0xffff0000, v87
    v_pk_fma_f32 v[200:201], v[200:201], v[194:195], v[196:197] op_sel_hi:[1,0,0]
    v_cvt_pk_bf16_f32 v87, v200, v201
    ds_write_b128 v21, v[84:87] offset:16384
    v_lshlrev_b32 v198, 16, v88
    v_and_b32 v199, 0xffff0000, v88
    v_pk_fma_f32 v[198:199], v[198:199], v[194:195], v[196:197] op_sel_hi:[1,0,0]
    v_cvt_pk_bf16_f32 v88, v198, v199
    v_lshlrev_b32 v200, 16, v89
    v_and_b32 v201, 0xffff0000, v89
    v_pk_fma_f32 v[200:201], v[200:201], v[194:195], v[196:197] op_sel_hi:[1,0,0]
    v_cvt_pk_bf16_f32 v89, v200, v201
    v_lshlrev_b32 v198, 16, v90
    v_and_b32 v199, 0xffff0000, v90
    v_pk_fma_f32 v[198:199], v[198:199], v[194:195], v[196:197] op_sel_hi:[1,0,0]
    v_cvt_pk_bf16_f32 v90, v198, v199
    v_lshlrev_b32 v200, 16, v91
    v_and_b32 v201, 0xffff0000, v91
    v_pk_fma_f32 v[200:201], v[200:201], v[194:195], v[196:197] op_sel_hi:[1,0,0]
    v_cvt_pk_bf16_f32 v91, v200, v201
    ds_write_b128 v21, v[88:91] offset:20480
    v_lshlrev_b32 v198, 16, v92
    v_and_b32 v199, 0xffff0000, v92
    v_pk_fma_f32 v[198:199], v[198:199], v[194:195], v[196:197] op_sel_hi:[1,0,0]
    v_cvt_pk_bf16_f32 v92, v198, v199
    v_lshlrev_b32 v200, 16, v93
    v_and_b32 v201, 0xffff0000, v93
    v_pk_fma_f32 v[200:201], v[200:201], v[194:195], v[196:197] op_sel_hi:[1,0,0]
    v_cvt_pk_bf16_f32 v93, v200, v201
    v_lshlrev_b32 v198, 16, v94
    v_and_b32 v199, 0xffff0000, v94
    v_pk_fma_f32 v[198:199], v[198:199], v[194:195], v[196:197] op_sel_hi:[1,0,0]
    v_cvt_pk_bf16_f32 v94, v198, v199
    v_lshlrev_b32 v200, 16, v95
    v_and_b32 v201, 0xffff0000, v95
    v_pk_fma_f32 v[200:201], v[200:201], v[194:195], v[196:197] op_sel_hi:[1,0,0]
    v_cvt_pk_bf16_f32 v95, v200, v201
    ds_write_b128 v21, v[92:95] offset:24576
    v_lshlrev_b32 v198, 16, v96
    v_and_b32 v199, 0xffff0000, v96
    v_pk_fma_f32 v[198:199], v[198:199], v[194:195], v[196:197] op_sel_hi:[1,0,0]
    v_cvt_pk_bf16_f32 v96, v198, v199
    v_lshlrev_b32 v200, 16, v97
    v_and_b32 v201, 0xffff0000, v97
    v_pk_fma_f32 v[200:201], v[200:201], v[194:195], v[196:197] op_sel_hi:[1,0,0]
    v_cvt_pk_bf16_f32 v97, v200, v201
    v_lshlrev_b32 v198, 16, v98
    v_and_b32 v199, 0xffff0000, v98
    v_pk_fma_f32 v[198:199], v[198:199], v[194:195], v[196:197] op_sel_hi:[1,0,0]
    v_cvt_pk_bf16_f32 v98, v198, v199
    v_lshlrev_b32 v200, 16, v99
    v_and_b32 v201, 0xffff0000, v99
    v_pk_fma_f32 v[200:201], v[200:201], v[194:195], v[196:197] op_sel_hi:[1,0,0]
    v_cvt_pk_bf16_f32 v99, v200, v201
    ds_write_b128 v21, v[96:99] offset:28672
    v_lshlrev_b32 v198, 16, v100
    v_and_b32 v199, 0xffff0000, v100
    v_pk_fma_f32 v[198:199], v[198:199], v[194:195], v[196:197] op_sel_hi:[1,0,0]
    v_cvt_pk_bf16_f32 v100, v198, v199
    v_lshlrev_b32 v200, 16, v101
    v_and_b32 v201, 0xffff0000, v101
    v_pk_fma_f32 v[200:201], v[200:201], v[194:195], v[196:197] op_sel_hi:[1,0,0]
    v_cvt_pk_bf16_f32 v101, v200, v201
    v_lshlrev_b32 v198, 16, v102
    v_and_b32 v199, 0xffff0000, v102
    v_pk_fma_f32 v[198:199], v[198:199], v[194:195], v[196:197] op_sel_hi:[1,0,0]
    v_cvt_pk_bf16_f32 v102, v198, v199
    v_lshlrev_b32 v200, 16, v103
    v_and_b32 v201, 0xffff0000, v103
    v_pk_fma_f32 v[200:201], v[200:201], v[194:195], v[196:197] op_sel_hi:[1,0,0]
    v_cvt_pk_bf16_f32 v103, v200, v201
    ds_write_b128 v21, v[100:103] offset:32768
    s_waitcnt lgkmcnt(0)
    s_barrier
    ds_read_b64_tr_b16 v[144:145], v14 offset:0
    ds_read_b64_tr_b16 v[146:147], v14 offset:2048
    ds_read_b64_tr_b16 v[148:149], v14 offset:4096
    ds_read_b64_tr_b16 v[150:151], v14 offset:6144
    ds_read_b64_tr_b16 v[152:153], v14 offset:8192
    ds_read_b64_tr_b16 v[154:155], v14 offset:10240
    ds_read_b64_tr_b16 v[156:157], v14 offset:12288
    ds_read_b64_tr_b16 v[158:159], v14 offset:14336
    ds_read_b64_tr_b16 v[160:161], v14 offset:16384
    ds_read_b64_tr_b16 v[162:163], v14 offset:18432
    ds_read_b64_tr_b16 v[164:165], v14 offset:20480
    ds_read_b64_tr_b16 v[166:167], v14 offset:22528
    ds_read_b128 a[0:3], v22 offset:0
    ds_read_b128 a[4:7], v22 offset:1024
    ds_read_b128 a[8:11], v22 offset:2048
    ds_read_b128 a[12:15], v22 offset:3072
    ds_read_b128 a[16:19], v22 offset:4096
    ds_read_b128 a[20:23], v22 offset:5120
    ds_read_b128 a[24:27], v22 offset:6144
    ds_read_b128 a[28:31], v22 offset:7168
    ds_read_b128 a[32:35], v22 offset:8192
    ds_read_b128 a[36:39], v22 offset:9216
    ds_read_b128 a[40:43], v22 offset:10240
    ds_read_b128 a[44:47], v22 offset:11264
    ds_read_b128 a[48:51], v22 offset:12288
    ds_read_b128 a[52:55], v22 offset:13312
    ds_read_b128 a[56:59], v22 offset:14336
    ds_read_b128 a[60:63], v22 offset:15360
    ds_read_b128 a[64:67], v22 offset:16384
    ds_read_b128 a[68:71], v22 offset:17408
    ds_read_b128 a[72:75], v22 offset:18432
    ds_read_b128 a[76:79], v22 offset:19456
    ds_read_b128 a[80:83], v22 offset:20480
    ds_read_b128 a[84:87], v22 offset:21504
    ds_read_b128 a[88:91], v22 offset:22528
    ds_read_b128 a[92:95], v22 offset:23552
    s_waitcnt lgkmcnt(0)
    s_barrier
    v_mfma_f32_16x16x32_bf16 v[32:35], v[144:147], a[0:3], 0
    s_add_u32 m0, s46, 0
    s_add_u32 s44, s47, 0
    buffer_load_dwordx4 v8, s[16:19], s44 offen offset:0 lds
    ds_read_b64_tr_b16 v[168:169], v14 offset:24576
    ds_read_b64_tr_b16 v[170:171], v14 offset:26624
    v_mfma_f32_16x16x32_bf16 v[32:35], v[148:151], a[16:19], v[32:35]
    buffer_load_dwordx4 v9, s[16:19], s44 offen offset:1024 lds
    ds_read_b64_tr_b16 v[172:173], v14 offset:28672
    ds_read_b64_tr_b16 v[174:175], v14 offset:30720
    v_mfma_f32_16x16x32_bf16 v[36:39], v[144:147], a[4:7], 0
    buffer_load_dwordx4 v10, s[16:19], s44 offen offset:2048 lds
    ds_read_b64_tr_b16 v[176:177], v14 offset:32768
    ds_read_b64_tr_b16 v[178:179], v14 offset:34816
    v_mfma_f32_16x16x32_bf16 v[36:39], v[148:151], a[20:23], v[36:39]
    s_add_u32 m0, s46, 3072
    s_add_u32 s45, s47, 221184
    buffer_load_dwordx4 v8, s[16:19], s45 offen offset:0 lds
    ds_read_b64_tr_b16 v[180:181], v14 offset:36864
    v_mfma_f32_16x16x32_bf16 v[40:43], v[144:147], a[8:11], 0
    ds_read_b64_tr_b16 v[182:183], v14 offset:38912
    buffer_load_dwordx4 v9, s[16:19], s45 offen offset:1024 lds
    ds_read_b64_tr_b16 v[184:185], v14 offset:40960
    v_mfma_f32_16x16x32_bf16 v[40:43], v[148:151], a[24:27], v[40:43]
    ds_read_b64_tr_b16 v[186:187], v14 offset:43008
    buffer_load_dwordx4 v10, s[16:19], s45 offen offset:2048 lds
    ds_read_b64_tr_b16 v[188:189], v14 offset:45056
    v_mfma_f32_16x16x32_bf16 v[44:47], v[144:147], a[12:15], 0
    ds_read_b64_tr_b16 v[190:191], v14 offset:47104
    s_add_u32 m0, s46, 73728
    s_add_u32 s44, s47, 1769472
    buffer_load_dwordx4 v8, s[16:19], s44 offen offset:0 lds
    ds_read_b128 a[96:99], v22 offset:24576
    v_mfma_f32_16x16x32_bf16 v[44:47], v[148:151], a[28:31], v[44:47]
    ds_read_b128 a[100:103], v22 offset:25600
    buffer_load_dwordx4 v9, s[16:19], s44 offen offset:1024 lds
    v_mfma_f32_16x16x32_bf16 v[32:35], v[152:155], a[32:35], v[32:35]
    ds_read_b128 a[104:107], v22 offset:26624
    ds_read_b128 a[108:111], v22 offset:27648
    buffer_load_dwordx4 v10, s[16:19], s44 offen offset:2048 lds
    v_mfma_f32_16x16x32_bf16 v[32:35], v[156:159], a[48:51], v[32:35]
    ds_read_b128 a[112:115], v22 offset:28672
    ds_read_b128 a[116:119], v22 offset:29696
    s_add_u32 m0, s46, 76800
    s_add_u32 s45, s47, 1990656
    buffer_load_dwordx4 v8, s[16:19], s45 offen offset:0 lds
    v_mfma_f32_16x16x32_bf16 v[36:39], v[152:155], a[36:39], v[36:39]
    ds_read_b128 a[120:123], v22 offset:30720
    ds_read_b128 a[124:127], v22 offset:31744
    v_mfma_f32_16x16x32_bf16 v[36:39], v[156:159], a[52:55], v[36:39]
    buffer_load_dwordx4 v9, s[16:19], s45 offen offset:1024 lds
    ds_read_b128 a[128:131], v22 offset:32768
    ds_read_b128 a[132:135], v22 offset:33792
    v_mfma_f32_16x16x32_bf16 v[40:43], v[152:155], a[40:43], v[40:43]
    buffer_load_dwordx4 v10, s[16:19], s45 offen offset:2048 lds
    ds_read_b128 a[136:139], v22 offset:34816
    ds_read_b128 a[140:143], v22 offset:35840
    v_mfma_f32_16x16x32_bf16 v[40:43], v[156:159], a[56:59], v[40:43]
    buffer_load_dword v6, v4, s[12:15], s47 offen offset:384
    ds_read_b128 a[144:147], v23 offset:0
    ds_read_b128 a[148:151], v23 offset:1024
    v_mfma_f32_16x16x32_bf16 v[44:47], v[152:155], a[44:47], v[44:47]
    ds_read_b128 a[152:155], v23 offset:2048
    ds_read_b128 a[156:159], v23 offset:3072
    v_mfma_f32_16x16x32_bf16 v[44:47], v[156:159], a[60:63], v[44:47]
    ds_read_b128 a[160:163], v23 offset:4096
    ds_read_b128 a[164:167], v23 offset:5120
    ds_read_b128 a[168:171], v23 offset:6144
    v_mfma_f32_16x16x32_bf16 v[32:35], v[160:163], a[64:67], v[32:35]
    ds_read_b128 a[172:175], v23 offset:7168
    ds_read_b128 a[176:179], v23 offset:8192
    ds_read_b128 a[180:183], v23 offset:9216
    v_mfma_f32_16x16x32_bf16 v[32:35], v[164:167], a[80:83], v[32:35]
    ds_read_b128 a[184:187], v23 offset:10240
    ds_read_b128 a[188:191], v23 offset:11264
    v_mfma_f32_16x16x32_bf16 v[36:39], v[160:163], a[68:71], v[36:39]
    v_mfma_f32_16x16x32_bf16 v[36:39], v[164:167], a[84:87], v[36:39]
    v_mfma_f32_16x16x32_bf16 v[40:43], v[160:163], a[72:75], v[40:43]
    v_mfma_f32_16x16x32_bf16 v[40:43], v[164:167], a[88:91], v[40:43]
    v_mfma_f32_16x16x32_bf16 v[44:47], v[160:163], a[76:79], v[44:47]
    v_mfma_f32_16x16x32_bf16 v[44:47], v[164:167], a[92:95], v[44:47]
    s_waitcnt lgkmcnt(0) vmcnt(33)
    s_barrier
    v_mfma_f32_16x16x32_bf16 v[32:35], v[168:171], a[96:99], v[32:35]
    s_add_u32 m0, s46, 24576
    s_add_u32 s44, s47, 3538944
    buffer_load_dwordx4 v8, s[16:19], s44 offen offset:0 lds
    ds_read_b64_tr_b16 v[144:145], v15 offset:0
    ds_read_b64_tr_b16 v[146:147], v15 offset:2048
    v_mfma_f32_16x16x32_bf16 v[32:35], v[172:175], a[112:115], v[32:35]
    buffer_load_dwordx4 v9, s[16:19], s44 offen offset:1024 lds
    ds_read_b64_tr_b16 v[148:149], v15 offset:4096
    ds_read_b64_tr_b16 v[150:151], v15 offset:6144
    v_mfma_f32_16x16x32_bf16 v[36:39], v[168:171], a[100:103], v[36:39]
    buffer_load_dwordx4 v10, s[16:19], s44 offen offset:2048 lds
    ds_read_b64_tr_b16 v[152:153], v15 offset:8192
    v_mfma_f32_16x16x32_bf16 v[36:39], v[172:175], a[116:119], v[36:39]
    ds_read_b64_tr_b16 v[154:155], v15 offset:10240
    s_add_u32 m0, s46, 27648
    s_add_u32 s45, s47, 3760128
    buffer_load_dwordx4 v8, s[16:19], s45 offen offset:0 lds
    ds_read_b64_tr_b16 v[156:157], v15 offset:12288
    v_mfma_f32_16x16x32_bf16 v[40:43], v[168:171], a[104:107], v[40:43]
    ds_read_b64_tr_b16 v[158:159], v15 offset:14336
    buffer_load_dwordx4 v9, s[16:19], s45 offen offset:1024 lds
    ds_read_b64_tr_b16 v[160:161], v15 offset:16384
    v_mfma_f32_16x16x32_bf16 v[40:43], v[172:175], a[120:123], v[40:43]
    ds_read_b64_tr_b16 v[162:163], v15 offset:18432
    buffer_load_dwordx4 v10, s[16:19], s45 offen offset:2048 lds
    v_mfma_f32_16x16x32_bf16 v[44:47], v[168:171], a[108:111], v[44:47]
    ds_read_b64_tr_b16 v[164:165], v15 offset:20480
    ds_read_b64_tr_b16 v[166:167], v15 offset:22528
    s_add_u32 m0, s46, 98304
    s_add_u32 s44, s47, 128
    buffer_load_dwordx4 v8, s[12:15], s44 offen offset:0 lds
    v_mfma_f32_16x16x32_bf16 v[44:47], v[172:175], a[124:127], v[44:47]
    ds_read_b128 a[192:195], v23 offset:12288
    ds_read_b128 a[196:199], v23 offset:13312
    buffer_load_dwordx4 v9, s[12:15], s44 offen offset:1024 lds
    v_mfma_f32_16x16x32_bf16 v[32:35], v[176:179], a[128:131], v[32:35]
    ds_read_b128 a[200:203], v23 offset:14336
    ds_read_b128 a[204:207], v23 offset:15360
    v_mfma_f32_16x16x32_bf16 v[32:35], v[180:183], a[144:147], v[32:35]
    buffer_load_dwordx4 v10, s[12:15], s44 offen offset:2048 lds
    ds_read_b128 a[208:211], v23 offset:16384
    ds_read_b128 a[212:215], v23 offset:17408
    v_mfma_f32_16x16x32_bf16 v[36:39], v[176:179], a[132:135], v[36:39]
    s_add_u32 m0, s46, 101376
    s_add_u32 s45, s47, 221312
    buffer_load_dwordx4 v8, s[12:15], s45 offen offset:0 lds
    ds_read_b128 a[216:219], v23 offset:18432
    ds_read_b128 a[220:223], v23 offset:19456
    v_mfma_f32_16x16x32_bf16 v[36:39], v[180:183], a[148:151], v[36:39]
    buffer_load_dwordx4 v9, s[12:15], s45 offen offset:1024 lds
    ds_read_b128 a[224:227], v23 offset:20480
    v_mfma_f32_16x16x32_bf16 v[40:43], v[176:179], a[136:139], v[40:43]
    ds_read_b128 a[228:231], v23 offset:21504
    buffer_load_dwordx4 v10, s[12:15], s45 offen offset:2048 lds
    ds_read_b128 a[232:235], v23 offset:22528
    v_mfma_f32_16x16x32_bf16 v[40:43], v[180:183], a[152:155], v[40:43]
    ds_read_b128 a[236:239], v23 offset:23552
    ds_read_b128 a[240:243], v23 offset:24576
    ds_read_b128 a[244:247], v23 offset:25600
    v_mfma_f32_16x16x32_bf16 v[44:47], v[176:179], a[140:143], v[44:47]
    ds_read_b128 a[248:251], v23 offset:26624
    ds_read_b128 a[252:255], v23 offset:27648
    v_mfma_f32_16x16x32_bf16 v[44:47], v[180:183], a[156:159], v[44:47]
    ds_read_b128 v[224:227], v23 offset:28672
    ds_read_b128 v[228:231], v23 offset:29696
    ds_read_b128 v[232:235], v23 offset:30720
    v_mfma_f32_16x16x32_bf16 v[32:35], v[184:187], a[160:163], v[32:35]
    ds_read_b128 v[236:239], v23 offset:31744
    ds_read_b128 v[240:243], v23 offset:32768
    ds_read_b128 v[244:247], v23 offset:33792
    v_mfma_f32_16x16x32_bf16 v[32:35], v[188:191], a[176:179], v[32:35]
    ds_read_b128 v[248:251], v23 offset:34816
    ds_read_b128 v[252:255], v23 offset:35840
    v_mfma_f32_16x16x32_bf16 v[36:39], v[184:187], a[164:167], v[36:39]
    v_mfma_f32_16x16x32_bf16 v[36:39], v[188:191], a[180:183], v[36:39]
    v_mfma_f32_16x16x32_bf16 v[40:43], v[184:187], a[168:171], v[40:43]
    v_mfma_f32_16x16x32_bf16 v[40:43], v[188:191], a[184:187], v[40:43]
    v_mfma_f32_16x16x32_bf16 v[44:47], v[184:187], a[172:175], v[44:47]
    v_mfma_f32_16x16x32_bf16 v[44:47], v[188:191], a[188:191], v[44:47]
    s_waitcnt lgkmcnt(0) vmcnt(19)
    s_barrier
    v_mfma_f32_16x16x32_bf16 v[32:35], v[144:147], a[192:195], v[32:35]
    s_add_u32 m0, s46, 49152
    s_add_u32 s44, s47, 1769600
    buffer_load_dwordx4 v8, s[12:15], s44 offen offset:0 lds
    v_mfma_f32_16x16x32_bf16 v[32:35], v[148:151], a[208:211], v[32:35]
    ds_read_b64_tr_b16 v[168:169], v14 offset:0
    v_mfma_f32_16x16x32_bf16 v[36:39], v[144:147], a[196:199], v[36:39]
    ds_read_b64_tr_b16 v[170:171], v14 offset:2048
    v_mfma_f32_16x16x32_bf16 v[36:39], v[148:151], a[212:215], v[36:39]
    buffer_load_dwordx4 v9, s[12:15], s44 offen offset:1024 lds
    v_mfma_f32_16x16x32_bf16 v[40:43], v[144:147], a[200:203], v[40:43]
    ds_read_b64_tr_b16 v[172:173], v14 offset:4096
    v_mfma_f32_16x16x32_bf16 v[40:43], v[148:151], a[216:219], v[40:43]
    ds_read_b64_tr_b16 v[174:175], v14 offset:6144
    v_mfma_f32_16x16x32_bf16 v[44:47], v[144:147], a[204:207], v[44:47]
    buffer_load_dwordx4 v10, s[12:15], s44 offen offset:2048 lds
    v_mfma_f32_16x16x32_bf16 v[44:47], v[148:151], a[220:223], v[44:47]
    ds_read_b64_tr_b16 v[176:177], v14 offset:8192
    v_mfma_f32_16x16x32_bf16 v[32:35], v[152:155], a[224:227], v[32:35]
    ds_read_b64_tr_b16 v[178:179], v14 offset:10240
    v_mfma_f32_16x16x32_bf16 v[32:35], v[156:159], a[240:243], v[32:35]
    s_add_u32 m0, s46, 52224
    s_add_u32 s45, s47, 1990784
    buffer_load_dwordx4 v8, s[12:15], s45 offen offset:0 lds
    v_mfma_f32_16x16x32_bf16 v[36:39], v[152:155], a[228:231], v[36:39]
    ds_read_b64_tr_b16 v[180:181], v14 offset:12288
    v_mfma_f32_16x16x32_bf16 v[36:39], v[156:159], a[244:247], v[36:39]
    ds_read_b64_tr_b16 v[182:183], v14 offset:14336
    v_mfma_f32_16x16x32_bf16 v[40:43], v[152:155], a[232:235], v[40:43]
    buffer_load_dwordx4 v9, s[12:15], s45 offen offset:1024 lds
    v_mfma_f32_16x16x32_bf16 v[40:43], v[156:159], a[248:251], v[40:43]
    ds_read_b64_tr_b16 v[184:185], v14 offset:16384
    v_mfma_f32_16x16x32_bf16 v[44:47], v[152:155], a[236:239], v[44:47]
    ds_read_b64_tr_b16 v[186:187], v14 offset:18432
    v_mfma_f32_16x16x32_bf16 v[44:47], v[156:159], a[252:255], v[44:47]
    buffer_load_dwordx4 v10, s[12:15], s45 offen offset:2048 lds
    v_mfma_f32_16x16x32_bf16 v[32:35], v[160:163], v[224:227], v[32:35]
    ds_read_b64_tr_b16 v[188:189], v14 offset:20480
    v_mfma_f32_16x16x32_bf16 v[32:35], v[164:167], v[240:243], v[32:35]
    ds_read_b64_tr_b16 v[190:191], v14 offset:22528
    v_mfma_f32_16x16x32_bf16 v[36:39], v[160:163], v[228:231], v[36:39]
    v_mfma_f32_16x16x32_bf16 v[36:39], v[164:167], v[244:247], v[36:39]
    v_mfma_f32_16x16x32_bf16 v[40:43], v[160:163], v[232:235], v[40:43]
    v_mfma_f32_16x16x32_bf16 v[40:43], v[164:167], v[248:251], v[40:43]
    v_mfma_f32_16x16x32_bf16 v[44:47], v[160:163], v[236:239], v[44:47]
    v_mfma_f32_16x16x32_bf16 v[44:47], v[164:167], v[252:255], v[44:47]
    s_waitcnt lgkmcnt(0) vmcnt(19)
    s_barrier
    v_mfma_f32_16x16x32_bf16 v[64:67], v[168:171], a[0:3], 0
    s_add_u32 m0, s46, 0
    s_add_u32 s44, s47, 3539072
    buffer_load_dwordx4 v8, s[12:15], s44 offen offset:0 lds
    v_mul_f32 v192, s50, v32
    v_mfma_f32_16x16x32_bf16 v[64:67], v[172:175], a[16:19], v[64:67]
    ds_read_b64_tr_b16 v[144:145], v15 offset:24576
    v_mfma_f32_16x16x32_bf16 v[68:71], v[168:171], a[4:7], 0
    ds_read_b64_tr_b16 v[146:147], v15 offset:26624
    v_mul_f32 v193, s50, v33
    v_mfma_f32_16x16x32_bf16 v[68:71], v[172:175], a[20:23], v[68:71]
    buffer_load_dwordx4 v9, s[12:15], s44 offen offset:1024 lds
    v_mfma_f32_16x16x32_bf16 v[72:75], v[168:171], a[8:11], 0
    ds_read_b64_tr_b16 v[148:149], v15 offset:28672
    v_mul_f32 v194, s50, v34
    v_mfma_f32_16x16x32_bf16 v[72:75], v[172:175], a[24:27], v[72:75]
    ds_read_b64_tr_b16 v[150:151], v15 offset:30720
    v_mfma_f32_16x16x32_bf16 v[76:79], v[168:171], a[12:15], 0
    buffer_load_dwordx4 v10, s[12:15], s44 offen offset:2048 lds
    v_mfma_f32_16x16x32_bf16 v[76:79], v[172:175], a[28:31], v[76:79]
    ds_read_b64_tr_b16 v[152:153], v15 offset:32768
    v_mul_f32 v195, s50, v35
    v_mfma_f32_16x16x32_bf16 v[64:67], v[176:179], a[32:35], v[64:67]
    ds_read_b64_tr_b16 v[154:155], v15 offset:34816
    v_mfma_f32_16x16x32_bf16 v[64:67], v[180:183], a[48:51], v[64:67]
    s_add_u32 m0, s46, 3072
    s_add_u32 s45, s47, 3760256
    buffer_load_dwordx4 v8, s[12:15], s45 offen offset:0 lds
    v_exp_f32 v192, v192
    v_mfma_f32_16x16x32_bf16 v[68:71], v[176:179], a[36:39], v[68:71]
    ds_read_b64_tr_b16 v[156:157], v15 offset:36864
    v_mfma_f32_16x16x32_bf16 v[68:71], v[180:183], a[52:55], v[68:71]
    ds_read_b64_tr_b16 v[158:159], v15 offset:38912
    v_mfma_f32_16x16x32_bf16 v[72:75], v[176:179], a[40:43], v[72:75]
    buffer_load_dwordx4 v9, s[12:15], s45 offen offset:1024 lds
    v_exp_f32 v193, v193
    v_mfma_f32_16x16x32_bf16 v[72:75], v[180:183], a[56:59], v[72:75]
    ds_read_b64_tr_b16 v[160:161], v15 offset:40960
    v_mfma_f32_16x16x32_bf16 v[76:79], v[176:179], a[44:47], v[76:79]
    ds_read_b64_tr_b16 v[162:163], v15 offset:43008
    v_exp_f32 v194, v194
    v_mfma_f32_16x16x32_bf16 v[76:79], v[180:183], a[60:63], v[76:79]
    buffer_load_dwordx4 v10, s[12:15], s45 offen offset:2048 lds
    v_mfma_f32_16x16x32_bf16 v[64:67], v[184:187], a[64:67], v[64:67]
    ds_read_b64_tr_b16 v[164:165], v15 offset:45056
    v_exp_f32 v195, v195
    v_mfma_f32_16x16x32_bf16 v[64:67], v[188:191], a[80:83], v[64:67]
    ds_read_b64_tr_b16 v[166:167], v15 offset:47104
    v_mfma_f32_16x16x32_bf16 v[68:71], v[184:187], a[68:71], v[68:71]
    v_add_f32 v192, 1.0, v192
    v_mfma_f32_16x16x32_bf16 v[68:71], v[188:191], a[84:87], v[68:71]
    v_add_f32 v193, 1.0, v193
    v_add_f32 v194, 1.0, v194
    v_mfma_f32_16x16x32_bf16 v[72:75], v[184:187], a[72:75], v[72:75]
    v_add_f32 v195, 1.0, v195
    v_mfma_f32_16x16x32_bf16 v[72:75], v[188:191], a[88:91], v[72:75]
    v_rcp_f32 v192, v192
    v_rcp_f32 v193, v193
    v_mfma_f32_16x16x32_bf16 v[76:79], v[184:187], a[76:79], v[76:79]
    v_rcp_f32 v194, v194
    v_mfma_f32_16x16x32_bf16 v[76:79], v[188:191], a[92:95], v[76:79]
    v_rcp_f32 v195, v195
    s_waitcnt lgkmcnt(0) vmcnt(18)
    s_barrier
    v_mfma_f32_16x16x32_bf16 v[64:67], v[144:147], a[96:99], v[64:67]
    s_add_u32 m0, s46, 73728
    s_add_u32 s44, s47, 128
    buffer_load_dwordx4 v8, s[16:19], s44 offen offset:0 lds
    v_mul_f32 v32, v192, v32
    v_mfma_f32_16x16x32_bf16 v[64:67], v[148:151], a[112:115], v[64:67]
    ds_read_b64_tr_b16 v[168:169], v14 offset:24576
    v_mfma_f32_16x16x32_bf16 v[68:71], v[144:147], a[100:103], v[68:71]
    ds_read_b64_tr_b16 v[170:171], v14 offset:26624
    v_mul_f32 v33, v193, v33
    v_mfma_f32_16x16x32_bf16 v[68:71], v[148:151], a[116:119], v[68:71]
    buffer_load_dwordx4 v9, s[16:19], s44 offen offset:1024 lds
    v_mfma_f32_16x16x32_bf16 v[72:75], v[144:147], a[104:107], v[72:75]
    ds_read_b64_tr_b16 v[172:173], v14 offset:28672
    v_mul_f32 v34, v194, v34
    v_mfma_f32_16x16x32_bf16 v[72:75], v[148:151], a[120:123], v[72:75]
    ds_read_b64_tr_b16 v[174:175], v14 offset:30720
    v_mfma_f32_16x16x32_bf16 v[76:79], v[144:147], a[108:111], v[76:79]
    buffer_load_dwordx4 v10, s[16:19], s44 offen offset:2048 lds
    v_mul_f32 v35, v195, v35
    v_mfma_f32_16x16x32_bf16 v[76:79], v[148:151], a[124:127], v[76:79]
    ds_read_b64_tr_b16 v[176:177], v14 offset:32768
    v_mfma_f32_16x16x32_bf16 v[64:67], v[152:155], a[128:131], v[64:67]
    ds_read_b64_tr_b16 v[178:179], v14 offset:34816
    v_mul_f32 v196, s50, v36
    v_mfma_f32_16x16x32_bf16 v[64:67], v[156:159], a[144:147], v[64:67]
    s_add_u32 m0, s46, 76800
    s_add_u32 s45, s47, 221312
    buffer_load_dwordx4 v8, s[16:19], s45 offen offset:0 lds
    v_mfma_f32_16x16x32_bf16 v[68:71], v[152:155], a[132:135], v[68:71]
    ds_read_b64_tr_b16 v[180:181], v14 offset:36864
    v_mul_f32 v197, s50, v37
    v_mfma_f32_16x16x32_bf16 v[68:71], v[156:159], a[148:151], v[68:71]
    ds_read_b64_tr_b16 v[182:183], v14 offset:38912
    v_mfma_f32_16x16x32_bf16 v[72:75], v[152:155], a[136:139], v[72:75]
    buffer_load_dwordx4 v9, s[16:19], s45 offen offset:1024 lds
    v_mfma_f32_16x16x32_bf16 v[72:75], v[156:159], a[152:155], v[72:75]
    ds_read_b64_tr_b16 v[184:185], v14 offset:40960
    v_mul_f32 v198, s50, v38
    v_mfma_f32_16x16x32_bf16 v[76:79], v[152:155], a[140:143], v[76:79]
    ds_read_b64_tr_b16 v[186:187], v14 offset:43008
    v_mfma_f32_16x16x32_bf16 v[76:79], v[156:159], a[156:159], v[76:79]
    buffer_load_dwordx4 v10, s[16:19], s45 offen offset:2048 lds
    v_mul_f32 v199, s50, v39
    v_mfma_f32_16x16x32_bf16 v[64:67], v[160:163], a[160:163], v[64:67]
    ds_read_b64_tr_b16 v[188:189], v14 offset:45056
    v_mfma_f32_16x16x32_bf16 v[64:67], v[164:167], a[176:179], v[64:67]
    ds_read_b64_tr_b16 v[190:191], v14 offset:47104
    v_exp_f32 v196, v196
    v_mfma_f32_16x16x32_bf16 v[68:71], v[160:163], a[164:167], v[68:71]
    v_exp_f32 v197, v197
    v_mfma_f32_16x16x32_bf16 v[68:71], v[164:167], a[180:183], v[68:71]
    v_exp_f32 v198, v198
    v_exp_f32 v199, v199
    v_mfma_f32_16x16x32_bf16 v[72:75], v[160:163], a[168:171], v[72:75]
    v_add_f32 v196, 1.0, v196
    v_mfma_f32_16x16x32_bf16 v[72:75], v[164:167], a[184:187], v[72:75]
    v_add_f32 v197, 1.0, v197
    v_add_f32 v198, 1.0, v198
    v_mfma_f32_16x16x32_bf16 v[76:79], v[160:163], a[172:175], v[76:79]
    v_add_f32 v199, 1.0, v199
    v_mfma_f32_16x16x32_bf16 v[76:79], v[164:167], a[188:191], v[76:79]
    v_rcp_f32 v196, v196
    s_waitcnt lgkmcnt(0) vmcnt(18)
    s_barrier
    v_mfma_f32_16x16x32_bf16 v[64:67], v[168:171], a[192:195], v[64:67]
    s_add_u32 m0, s46, 24576
    s_add_u32 s44, s47, 1769600
    buffer_load_dwordx4 v8, s[16:19], s44 offen offset:0 lds
    v_rcp_f32 v197, v197
    v_mfma_f32_16x16x32_bf16 v[64:67], v[172:175], a[208:211], v[64:67]
    ds_read_b64_tr_b16 v[144:145], v16 offset:0
    v_mfma_f32_16x16x32_bf16 v[68:71], v[168:171], a[196:199], v[68:71]
    ds_read_b64_tr_b16 v[146:147], v16 offset:2048
    v_rcp_f32 v198, v198
    v_mfma_f32_16x16x32_bf16 v[68:71], v[172:175], a[212:215], v[68:71]
    buffer_load_dwordx4 v9, s[16:19], s44 offen offset:1024 lds
    v_mfma_f32_16x16x32_bf16 v[72:75], v[168:171], a[200:203], v[72:75]
    ds_read_b64_tr_b16 v[148:149], v16 offset:4096
    v_mfma_f32_16x16x32_bf16 v[72:75], v[172:175], a[216:219], v[72:75]
    ds_read_b64_tr_b16 v[150:151], v16 offset:6144
    v_rcp_f32 v199, v199
    v_mfma_f32_16x16x32_bf16 v[76:79], v[168:171], a[204:207], v[76:79]
    buffer_load_dwordx4 v10, s[16:19], s44 offen offset:2048 lds
    v_mfma_f32_16x16x32_bf16 v[76:79], v[172:175], a[220:223], v[76:79]
    ds_read_b64_tr_b16 v[152:153], v16 offset:8192
    v_mfma_f32_16x16x32_bf16 v[64:67], v[176:179], a[224:227], v[64:67]
    ds_read_b64_tr_b16 v[154:155], v16 offset:10240
    v_mul_f32 v36, v196, v36
    v_mfma_f32_16x16x32_bf16 v[64:67], v[180:183], a[240:243], v[64:67]
    s_add_u32 m0, s46, 27648
    s_add_u32 s45, s47, 1990784
    buffer_load_dwordx4 v8, s[16:19], s45 offen offset:0 lds
    v_mfma_f32_16x16x32_bf16 v[68:71], v[176:179], a[228:231], v[68:71]
    ds_read_b64_tr_b16 v[156:157], v16 offset:12288
    v_mul_f32 v37, v197, v37
    v_mfma_f32_16x16x32_bf16 v[68:71], v[180:183], a[244:247], v[68:71]
    ds_read_b64_tr_b16 v[158:159], v16 offset:14336
    v_mfma_f32_16x16x32_bf16 v[72:75], v[176:179], a[232:235], v[72:75]
    buffer_load_dwordx4 v9, s[16:19], s45 offen offset:1024 lds
    v_mfma_f32_16x16x32_bf16 v[72:75], v[180:183], a[248:251], v[72:75]
    ds_read_b64_tr_b16 v[160:161], v16 offset:16384
    v_mul_f32 v38, v198, v38
    v_mfma_f32_16x16x32_bf16 v[76:79], v[176:179], a[236:239], v[76:79]
    ds_read_b64_tr_b16 v[162:163], v16 offset:18432
    v_mfma_f32_16x16x32_bf16 v[76:79], v[180:183], a[252:255], v[76:79]
    buffer_load_dwordx4 v10, s[16:19], s45 offen offset:2048 lds
    v_mfma_f32_16x16x32_bf16 v[64:67], v[184:187], v[224:227], v[64:67]
    ds_read_b64_tr_b16 v[164:165], v16 offset:20480
    v_mul_f32 v39, v199, v39
    v_mfma_f32_16x16x32_bf16 v[64:67], v[188:191], v[240:243], v[64:67]
    ds_read_b64_tr_b16 v[166:167], v16 offset:22528
    v_mfma_f32_16x16x32_bf16 v[68:71], v[184:187], v[228:231], v[68:71]
    v_mul_f32 v200, s50, v40
    v_mul_f32 v201, s50, v41
    v_mfma_f32_16x16x32_bf16 v[68:71], v[188:191], v[244:247], v[68:71]
    v_mul_f32 v202, s50, v42
    v_mfma_f32_16x16x32_bf16 v[72:75], v[184:187], v[232:235], v[72:75]
    v_mul_f32 v203, s50, v43
    v_mfma_f32_16x16x32_bf16 v[72:75], v[188:191], v[248:251], v[72:75]
    v_exp_f32 v200, v200
    v_exp_f32 v201, v201
    v_mfma_f32_16x16x32_bf16 v[76:79], v[184:187], v[236:239], v[76:79]
    v_exp_f32 v202, v202
    v_mfma_f32_16x16x32_bf16 v[76:79], v[188:191], v[252:255], v[76:79]
    v_exp_f32 v203, v203
    s_waitcnt lgkmcnt(0) vmcnt(18)
    s_barrier
    v_mfma_f32_16x16x32_bf16 v[48:51], v[144:147], a[0:3], 0
    s_add_u32 m0, s46, 98304
    s_add_u32 s44, s47, 3539072
    buffer_load_dwordx4 v8, s[16:19], s44 offen offset:0 lds
    v_add_f32 v200, 1.0, v200
    v_mfma_f32_16x16x32_bf16 v[48:51], v[148:151], a[16:19], v[48:51]
    ds_read_b64_tr_b16 v[168:169], v15 offset:0
    v_mfma_f32_16x16x32_bf16 v[52:55], v[144:147], a[4:7], 0
    ds_read_b64_tr_b16 v[170:171], v15 offset:2048
    v_add_f32 v201, 1.0, v201
    v_mfma_f32_16x16x32_bf16 v[52:55], v[148:151], a[20:23], v[52:55]
    buffer_load_dwordx4 v9, s[16:19], s44 offen offset:1024 lds
    v_mfma_f32_16x16x32_bf16 v[56:59], v[144:147], a[8:11], 0
    ds_read_b64_tr_b16 v[172:173], v15 offset:4096
    v_add_f32 v202, 1.0, v202
    v_mfma_f32_16x16x32_bf16 v[56:59], v[148:151], a[24:27], v[56:59]
    ds_read_b64_tr_b16 v[174:175], v15 offset:6144
    v_mfma_f32_16x16x32_bf16 v[60:63], v[144:147], a[12:15], 0
    buffer_load_dwordx4 v10, s[16:19], s44 offen offset:2048 lds
    v_add_f32 v203, 1.0, v203
    v_mfma_f32_16x16x32_bf16 v[60:63], v[148:151], a[28:31], v[60:63]
    ds_read_b64_tr_b16 v[176:177], v15 offset:8192
    v_mfma_f32_16x16x32_bf16 v[48:51], v[152:155], a[32:35], v[48:51]
    ds_read_b64_tr_b16 v[178:179], v15 offset:10240
    v_rcp_f32 v200, v200
    v_mfma_f32_16x16x32_bf16 v[48:51], v[156:159], a[48:51], v[48:51]
    s_add_u32 m0, s46, 101376
    s_add_u32 s45, s47, 3760256
    buffer_load_dwordx4 v8, s[16:19], s45 offen offset:0 lds
    v_mfma_f32_16x16x32_bf16 v[52:55], v[152:155], a[36:39], v[52:55]
    ds_read_b64_tr_b16 v[180:181], v15 offset:12288
    v_rcp_f32 v201, v201
    v_mfma_f32_16x16x32_bf16 v[52:55], v[156:159], a[52:55], v[52:55]
    ds_read_b64_tr_b16 v[182:183], v15 offset:14336
    v_mfma_f32_16x16x32_bf16 v[56:59], v[152:155], a[40:43], v[56:59]
    buffer_load_dwordx4 v9, s[16:19], s45 offen offset:1024 lds
    v_rcp_f32 v202, v202
    v_mfma_f32_16x16x32_bf16 v[56:59], v[156:159], a[56:59], v[56:59]
    ds_read_b64_tr_b16 v[184:185], v15 offset:16384
    v_mfma_f32_16x16x32_bf16 v[60:63], v[152:155], a[44:47], v[60:63]
    ds_read_b64_tr_b16 v[186:187], v15 offset:18432
    v_rcp_f32 v203, v203
    v_mfma_f32_16x16x32_bf16 v[60:63], v[156:159], a[60:63], v[60:63]
    buffer_load_dwordx4 v10, s[16:19], s45 offen offset:2048 lds
    v_mfma_f32_16x16x32_bf16 v[48:51], v[160:163], a[64:67], v[48:51]
    ds_read_b64_tr_b16 v[188:189], v15 offset:20480
    v_mul_f32 v40, v200, v40
    v_mfma_f32_16x16x32_bf16 v[48:51], v[164:167], a[80:83], v[48:51]
    ds_read_b64_tr_b16 v[190:191], v15 offset:22528
    v_mfma_f32_16x16x32_bf16 v[52:55], v[160:163], a[68:71], v[52:55]
    v_mul_f32 v41, v201, v41
    v_mul_f32 v42, v202, v42
    v_mfma_f32_16x16x32_bf16 v[52:55], v[164:167], a[84:87], v[52:55]
    v_mul_f32 v43, v203, v43
    v_mfma_f32_16x16x32_bf16 v[56:59], v[160:163], a[72:75], v[56:59]
    v_mul_f32 v192, s50, v44
    v_mul_f32 v193, s50, v45
    v_mfma_f32_16x16x32_bf16 v[56:59], v[164:167], a[88:91], v[56:59]
    v_mul_f32 v194, s50, v46
    v_mfma_f32_16x16x32_bf16 v[60:63], v[160:163], a[76:79], v[60:63]
    v_mul_f32 v195, s50, v47
    v_exp_f32 v192, v192
    v_mfma_f32_16x16x32_bf16 v[60:63], v[164:167], a[92:95], v[60:63]
    v_exp_f32 v193, v193
    s_waitcnt lgkmcnt(0) vmcnt(18)
    s_barrier
    v_mfma_f32_16x16x32_bf16 v[48:51], v[168:171], a[96:99], v[48:51]
    s_add_u32 m0, s46, 49152
    s_add_u32 s44, s47, 256
    buffer_load_dwordx4 v8, s[12:15], s44 offen offset:0 lds
    v_exp_f32 v194, v194
    v_mfma_f32_16x16x32_bf16 v[48:51], v[172:175], a[112:115], v[48:51]
    ds_read_b64_tr_b16 v[144:145], v14 offset:0
    v_mfma_f32_16x16x32_bf16 v[52:55], v[168:171], a[100:103], v[52:55]
    ds_read_b64_tr_b16 v[146:147], v14 offset:2048
    v_exp_f32 v195, v195
    v_mfma_f32_16x16x32_bf16 v[52:55], v[172:175], a[116:119], v[52:55]
    buffer_load_dwordx4 v9, s[12:15], s44 offen offset:1024 lds
    v_mfma_f32_16x16x32_bf16 v[56:59], v[168:171], a[104:107], v[56:59]
    ds_read_b64_tr_b16 v[148:149], v14 offset:4096
    v_add_f32 v192, 1.0, v192
    v_mfma_f32_16x16x32_bf16 v[56:59], v[172:175], a[120:123], v[56:59]
    ds_read_b64_tr_b16 v[150:151], v14 offset:6144
    v_mfma_f32_16x16x32_bf16 v[60:63], v[168:171], a[108:111], v[60:63]
    buffer_load_dwordx4 v10, s[12:15], s44 offen offset:2048 lds
    v_mfma_f32_16x16x32_bf16 v[60:63], v[172:175], a[124:127], v[60:63]
    ds_read_b64_tr_b16 v[152:153], v14 offset:8192
    v_add_f32 v193, 1.0, v193
    v_mfma_f32_16x16x32_bf16 v[48:51], v[176:179], a[128:131], v[48:51]
    ds_read_b64_tr_b16 v[154:155], v14 offset:10240
    v_mfma_f32_16x16x32_bf16 v[48:51], v[180:183], a[144:147], v[48:51]
    s_add_u32 m0, s46, 52224
    s_add_u32 s45, s47, 221440
    buffer_load_dwordx4 v8, s[12:15], s45 offen offset:0 lds
    v_add_f32 v194, 1.0, v194
    v_mfma_f32_16x16x32_bf16 v[52:55], v[176:179], a[132:135], v[52:55]
    ds_read_b64_tr_b16 v[156:157], v14 offset:12288
    v_mfma_f32_16x16x32_bf16 v[52:55], v[180:183], a[148:151], v[52:55]
    ds_read_b64_tr_b16 v[158:159], v14 offset:14336
    v_mfma_f32_16x16x32_bf16 v[56:59], v[176:179], a[136:139], v[56:59]
    buffer_load_dwordx4 v9, s[12:15], s45 offen offset:1024 lds
    v_add_f32 v195, 1.0, v195
    v_mfma_f32_16x16x32_bf16 v[56:59], v[180:183], a[152:155], v[56:59]
    ds_read_b64_tr_b16 v[160:161], v14 offset:16384
    v_mfma_f32_16x16x32_bf16 v[60:63], v[176:179], a[140:143], v[60:63]
    ds_read_b64_tr_b16 v[162:163], v14 offset:18432
    v_rcp_f32 v192, v192
    v_mfma_f32_16x16x32_bf16 v[60:63], v[180:183], a[156:159], v[60:63]
    buffer_load_dwordx4 v10, s[12:15], s45 offen offset:2048 lds
    v_mfma_f32_16x16x32_bf16 v[48:51], v[184:187], a[160:163], v[48:51]
    ds_read_b64_tr_b16 v[164:165], v14 offset:20480
    v_rcp_f32 v193, v193
    v_mfma_f32_16x16x32_bf16 v[48:51], v[188:191], a[176:179], v[48:51]
    ds_read_b64_tr_b16 v[166:167], v14 offset:22528
    v_mfma_f32_16x16x32_bf16 v[52:55], v[184:187], a[164:167], v[52:55]
    v_rcp_f32 v194, v194
    v_mfma_f32_16x16x32_bf16 v[52:55], v[188:191], a[180:183], v[52:55]
    v_rcp_f32 v195, v195
    v_mul_f32 v44, v192, v44
    v_mfma_f32_16x16x32_bf16 v[56:59], v[184:187], a[168:171], v[56:59]
    v_mul_f32 v45, v193, v45
    v_mfma_f32_16x16x32_bf16 v[56:59], v[188:191], a[184:187], v[56:59]
    v_mul_f32 v46, v194, v46
    v_mul_f32 v47, v195, v47
    v_mfma_f32_16x16x32_bf16 v[60:63], v[184:187], a[172:175], v[60:63]
    v_mul_f32 v32, v32, v64
    v_mfma_f32_16x16x32_bf16 v[60:63], v[188:191], a[188:191], v[60:63]
    v_mul_f32 v33, v33, v65
    s_waitcnt lgkmcnt(0) vmcnt(18)
    s_barrier
    v_mfma_f32_16x16x32_bf16 v[48:51], v[144:147], a[192:195], v[48:51]
    s_add_u32 m0, s46, 0
    s_add_u32 s44, s47, 1769728
    buffer_load_dwordx4 v8, s[12:15], s44 offen offset:0 lds
    v_mul_f32 v34, v34, v66
    v_mfma_f32_16x16x32_bf16 v[48:51], v[148:151], a[208:211], v[48:51]
    ds_read_b64_tr_b16 v[168:169], v15 offset:24576
    v_mul_f32 v35, v35, v67
    v_mfma_f32_16x16x32_bf16 v[52:55], v[144:147], a[196:199], v[52:55]
    ds_read_b64_tr_b16 v[170:171], v15 offset:26624
    v_mfma_f32_16x16x32_bf16 v[52:55], v[148:151], a[212:215], v[52:55]
    buffer_load_dwordx4 v9, s[12:15], s44 offen offset:1024 lds
    v_cvt_pk_bf16_f32 v96, v32, v33
    v_mfma_f32_16x16x32_bf16 v[56:59], v[144:147], a[200:203], v[56:59]
    ds_read_b64_tr_b16 v[172:173], v15 offset:28672
    v_cvt_pk_bf16_f32 v97, v34, v35
    v_mfma_f32_16x16x32_bf16 v[56:59], v[148:151], a[216:219], v[56:59]
    ds_read_b64_tr_b16 v[174:175], v15 offset:30720
    v_mfma_f32_16x16x32_bf16 v[60:63], v[144:147], a[204:207], v[60:63]
    buffer_load_dwordx4 v10, s[12:15], s44 offen offset:2048 lds
    v_mul_f32 v36, v36, v68
    v_mfma_f32_16x16x32_bf16 v[60:63], v[148:151], a[220:223], v[60:63]
    ds_read_b64_tr_b16 v[176:177], v15 offset:32768
    v_mul_f32 v37, v37, v69
    v_mfma_f32_16x16x32_bf16 v[48:51], v[152:155], a[224:227], v[48:51]
    ds_read_b64_tr_b16 v[178:179], v15 offset:34816
    v_mfma_f32_16x16x32_bf16 v[48:51], v[156:159], a[240:243], v[48:51]
    s_add_u32 m0, s46, 3072
    s_add_u32 s45, s47, 1990912
    buffer_load_dwordx4 v8, s[12:15], s45 offen offset:0 lds
    v_mul_f32 v38, v38, v70
    v_mfma_f32_16x16x32_bf16 v[52:55], v[152:155], a[228:231], v[52:55]
    ds_read_b64_tr_b16 v[180:181], v15 offset:36864
    v_mul_f32 v39, v39, v71
    v_mfma_f32_16x16x32_bf16 v[52:55], v[156:159], a[244:247], v[52:55]
    ds_read_b64_tr_b16 v[182:183], v15 offset:38912
    v_mfma_f32_16x16x32_bf16 v[56:59], v[152:155], a[232:235], v[56:59]
    buffer_load_dwordx4 v9, s[12:15], s45 offen offset:1024 lds
    v_cvt_pk_bf16_f32 v98, v36, v37
    v_mfma_f32_16x16x32_bf16 v[56:59], v[156:159], a[248:251], v[56:59]
    ds_read_b64_tr_b16 v[184:185], v15 offset:40960
    v_cvt_pk_bf16_f32 v99, v38, v39
    v_mfma_f32_16x16x32_bf16 v[60:63], v[152:155], a[236:239], v[60:63]
    ds_read_b64_tr_b16 v[186:187], v15 offset:43008
    v_mfma_f32_16x16x32_bf16 v[60:63], v[156:159], a[252:255], v[60:63]
    buffer_load_dwordx4 v10, s[12:15], s45 offen offset:2048 lds
    v_mul_f32 v40, v40, v72
    v_mfma_f32_16x16x32_bf16 v[48:51], v[160:163], v[224:227], v[48:51]
    ds_read_b64_tr_b16 v[188:189], v15 offset:45056
    v_mul_f32 v41, v41, v73
    v_mfma_f32_16x16x32_bf16 v[48:51], v[164:167], v[240:243], v[48:51]
    ds_read_b64_tr_b16 v[190:191], v15 offset:47104
    v_mfma_f32_16x16x32_bf16 v[52:55], v[160:163], v[228:231], v[52:55]
    v_mul_f32 v42, v42, v74
    v_mul_f32 v43, v43, v75
    v_mfma_f32_16x16x32_bf16 v[52:55], v[164:167], v[244:247], v[52:55]
    v_cvt_pk_bf16_f32 v100, v40, v41
    v_cvt_pk_bf16_f32 v101, v42, v43
    v_mfma_f32_16x16x32_bf16 v[56:59], v[160:163], v[232:235], v[56:59]
    v_mul_f32 v44, v44, v76
    v_mfma_f32_16x16x32_bf16 v[56:59], v[164:167], v[248:251], v[56:59]
    v_mul_f32 v45, v45, v77
    v_mul_f32 v46, v46, v78
    v_mfma_f32_16x16x32_bf16 v[60:63], v[160:163], v[236:239], v[60:63]
    v_mul_f32 v47, v47, v79
    v_cvt_pk_bf16_f32 v102, v44, v45
    v_mfma_f32_16x16x32_bf16 v[60:63], v[164:167], v[252:255], v[60:63]
    v_cvt_pk_bf16_f32 v103, v46, v47
    s_waitcnt lgkmcnt(0) vmcnt(18)
    s_barrier
    v_mfma_f32_16x16x32_bf16 v[80:83], v[168:171], a[0:3], 0
    s_add_u32 m0, s46, 73728
    s_add_u32 s44, s47, 3539200
    buffer_load_dwordx4 v8, s[12:15], s44 offen offset:0 lds
    ds_read_b64_tr_b16 v[144:145], v14 offset:24576
    v_mfma_f32_16x16x32_bf16 v[80:83], v[172:175], a[16:19], v[80:83]
    ds_read_b64_tr_b16 v[146:147], v14 offset:26624
    v_mfma_f32_16x16x32_bf16 v[84:87], v[168:171], a[4:7], 0
    buffer_load_dwordx4 v9, s[12:15], s44 offen offset:1024 lds
    v_mul_f32 v192, s50, v48
    v_mfma_f32_16x16x32_bf16 v[84:87], v[172:175], a[20:23], v[84:87]
    ds_read_b64_tr_b16 v[148:149], v14 offset:28672
    v_mfma_f32_16x16x32_bf16 v[88:91], v[168:171], a[8:11], 0
    ds_read_b64_tr_b16 v[150:151], v14 offset:30720
    v_mul_f32 v193, s50, v49
    v_mfma_f32_16x16x32_bf16 v[88:91], v[172:175], a[24:27], v[88:91]
    buffer_load_dwordx4 v10, s[12:15], s44 offen offset:2048 lds
    v_mfma_f32_16x16x32_bf16 v[92:95], v[168:171], a[12:15], 0
    ds_read_b64_tr_b16 v[152:153], v14 offset:32768
    v_mul_f32 v194, s50, v50
    v_mfma_f32_16x16x32_bf16 v[92:95], v[172:175], a[28:31], v[92:95]
    ds_read_b64_tr_b16 v[154:155], v14 offset:34816
    v_mfma_f32_16x16x32_bf16 v[80:83], v[176:179], a[32:35], v[80:83]
    s_add_u32 m0, s46, 76800
    s_add_u32 s45, s47, 3760384
    buffer_load_dwordx4 v8, s[12:15], s45 offen offset:0 lds
    v_mul_f32 v195, s50, v51
    v_mfma_f32_16x16x32_bf16 v[80:83], v[180:183], a[48:51], v[80:83]
    ds_read_b64_tr_b16 v[156:157], v14 offset:36864
    v_mfma_f32_16x16x32_bf16 v[84:87], v[176:179], a[36:39], v[84:87]
    ds_read_b64_tr_b16 v[158:159], v14 offset:38912
    v_exp_f32 v192, v192
    v_mfma_f32_16x16x32_bf16 v[84:87], v[180:183], a[52:55], v[84:87]
    buffer_load_dwordx4 v9, s[12:15], s45 offen offset:1024 lds
    v_mfma_f32_16x16x32_bf16 v[88:91], v[176:179], a[40:43], v[88:91]
    ds_read_b64_tr_b16 v[160:161], v14 offset:40960
    v_mfma_f32_16x16x32_bf16 v[88:91], v[180:183], a[56:59], v[88:91]
    ds_read_b64_tr_b16 v[162:163], v14 offset:43008
    v_exp_f32 v193, v193
    v_mfma_f32_16x16x32_bf16 v[92:95], v[176:179], a[44:47], v[92:95]
    buffer_load_dwordx4 v10, s[12:15], s45 offen offset:2048 lds
    v_mfma_f32_16x16x32_bf16 v[92:95], v[180:183], a[60:63], v[92:95]
    ds_read_b64_tr_b16 v[164:165], v14 offset:45056
    v_exp_f32 v194, v194
    v_mfma_f32_16x16x32_bf16 v[80:83], v[184:187], a[64:67], v[80:83]
    ds_read_b64_tr_b16 v[166:167], v14 offset:47104
    v_mfma_f32_16x16x32_bf16 v[80:83], v[188:191], a[80:83], v[80:83]
    buffer_load_dword v6, v4, s[16:19], s47 offen offset:384
    v_exp_f32 v195, v195
    v_mfma_f32_16x16x32_bf16 v[84:87], v[184:187], a[68:71], v[84:87]
    v_add_f32 v192, 1.0, v192
    v_mfma_f32_16x16x32_bf16 v[84:87], v[188:191], a[84:87], v[84:87]
    v_add_f32 v193, 1.0, v193
    v_add_f32 v194, 1.0, v194
    v_mfma_f32_16x16x32_bf16 v[88:91], v[184:187], a[72:75], v[88:91]
    v_add_f32 v195, 1.0, v195
    v_mfma_f32_16x16x32_bf16 v[88:91], v[188:191], a[88:91], v[88:91]
    v_rcp_f32 v192, v192
    v_rcp_f32 v193, v193
    v_mfma_f32_16x16x32_bf16 v[92:95], v[184:187], a[76:79], v[92:95]
    v_rcp_f32 v194, v194
    v_mfma_f32_16x16x32_bf16 v[92:95], v[188:191], a[92:95], v[92:95]
    v_rcp_f32 v195, v195
    s_waitcnt lgkmcnt(0) vmcnt(19)
    s_barrier
    v_mfma_f32_16x16x32_bf16 v[80:83], v[144:147], a[96:99], v[80:83]
    s_add_u32 m0, s46, 24576
    s_add_u32 s44, s47, 256
    buffer_load_dwordx4 v8, s[16:19], s44 offen offset:0 lds
    v_mul_f32 v48, v192, v48
    v_mfma_f32_16x16x32_bf16 v[80:83], v[148:151], a[112:115], v[80:83]
    ds_read_b64_tr_b16 v[168:169], v16 offset:0
    v_mfma_f32_16x16x32_bf16 v[84:87], v[144:147], a[100:103], v[84:87]
    ds_read_b64_tr_b16 v[170:171], v16 offset:2048
    v_mul_f32 v49, v193, v49
    v_mfma_f32_16x16x32_bf16 v[84:87], v[148:151], a[116:119], v[84:87]
    buffer_load_dwordx4 v9, s[16:19], s44 offen offset:1024 lds
    v_mfma_f32_16x16x32_bf16 v[88:91], v[144:147], a[104:107], v[88:91]
    ds_read_b64_tr_b16 v[172:173], v16 offset:4096
    v_mul_f32 v50, v194, v50
    v_mfma_f32_16x16x32_bf16 v[88:91], v[148:151], a[120:123], v[88:91]
    ds_read_b64_tr_b16 v[174:175], v16 offset:6144
    v_mfma_f32_16x16x32_bf16 v[92:95], v[144:147], a[108:111], v[92:95]
    buffer_load_dwordx4 v10, s[16:19], s44 offen offset:2048 lds
    v_mul_f32 v51, v195, v51
    v_mfma_f32_16x16x32_bf16 v[92:95], v[148:151], a[124:127], v[92:95]
    ds_read_b64_tr_b16 v[176:177], v16 offset:8192
    v_mfma_f32_16x16x32_bf16 v[80:83], v[152:155], a[128:131], v[80:83]
    ds_read_b64_tr_b16 v[178:179], v16 offset:10240
    v_mul_f32 v196, s50, v52
    v_mfma_f32_16x16x32_bf16 v[80:83], v[156:159], a[144:147], v[80:83]
    s_add_u32 m0, s46, 27648
    s_add_u32 s45, s47, 221440
    buffer_load_dwordx4 v8, s[16:19], s45 offen offset:0 lds
    v_mfma_f32_16x16x32_bf16 v[84:87], v[152:155], a[132:135], v[84:87]
    ds_read_b64_tr_b16 v[180:181], v16 offset:12288
    v_mul_f32 v197, s50, v53
    v_mfma_f32_16x16x32_bf16 v[84:87], v[156:159], a[148:151], v[84:87]
    ds_read_b64_tr_b16 v[182:183], v16 offset:14336
    v_mfma_f32_16x16x32_bf16 v[88:91], v[152:155], a[136:139], v[88:91]
    buffer_load_dwordx4 v9, s[16:19], s45 offen offset:1024 lds
    v_mfma_f32_16x16x32_bf16 v[88:91], v[156:159], a[152:155], v[88:91]
    ds_read_b64_tr_b16 v[184:185], v16 offset:16384
    v_mul_f32 v198, s50, v54
    v_mfma_f32_16x16x32_bf16 v[92:95], v[152:155], a[140:143], v[92:95]
    ds_read_b64_tr_b16 v[186:187], v16 offset:18432
    v_mfma_f32_16x16x32_bf16 v[92:95], v[156:159], a[156:159], v[92:95]
    buffer_load_dwordx4 v10, s[16:19], s45 offen offset:2048 lds
    v_mul_f32 v199, s50, v55
    v_mfma_f32_16x16x32_bf16 v[80:83], v[160:163], a[160:163], v[80:83]
    ds_read_b64_tr_b16 v[188:189], v16 offset:20480
    v_mfma_f32_16x16x32_bf16 v[80:83], v[164:167], a[176:179], v[80:83]
    ds_read_b64_tr_b16 v[190:191], v16 offset:22528
    v_exp_f32 v196, v196
    v_mfma_f32_16x16x32_bf16 v[84:87], v[160:163], a[164:167], v[84:87]
    v_exp_f32 v197, v197
    v_mfma_f32_16x16x32_bf16 v[84:87], v[164:167], a[180:183], v[84:87]
    v_exp_f32 v198, v198
    v_exp_f32 v199, v199
    v_mfma_f32_16x16x32_bf16 v[88:91], v[160:163], a[168:171], v[88:91]
    v_add_f32 v196, 1.0, v196
    v_mfma_f32_16x16x32_bf16 v[88:91], v[164:167], a[184:187], v[88:91]
    v_add_f32 v197, 1.0, v197
    v_add_f32 v198, 1.0, v198
    v_mfma_f32_16x16x32_bf16 v[92:95], v[160:163], a[172:175], v[92:95]
    v_add_f32 v199, 1.0, v199
    v_mfma_f32_16x16x32_bf16 v[92:95], v[164:167], a[188:191], v[92:95]
    v_rcp_f32 v196, v196
    s_waitcnt lgkmcnt(0) vmcnt(19)
    s_barrier
    v_mfma_f32_16x16x32_bf16 v[80:83], v[168:171], a[192:195], v[80:83]
    s_add_u32 m0, s46, 98304
    s_add_u32 s44, s47, 1769728
    buffer_load_dwordx4 v8, s[16:19], s44 offen offset:0 lds
    v_rcp_f32 v197, v197
    v_mfma_f32_16x16x32_bf16 v[80:83], v[172:175], a[208:211], v[80:83]
    ds_read_b64_tr_b16 v[144:145], v15 offset:0
    v_mfma_f32_16x16x32_bf16 v[84:87], v[168:171], a[196:199], v[84:87]
    ds_read_b64_tr_b16 v[146:147], v15 offset:2048
    v_rcp_f32 v198, v198
    v_mfma_f32_16x16x32_bf16 v[84:87], v[172:175], a[212:215], v[84:87]
    buffer_load_dwordx4 v9, s[16:19], s44 offen offset:1024 lds
    v_mfma_f32_16x16x32_bf16 v[88:91], v[168:171], a[200:203], v[88:91]
    ds_read_b64_tr_b16 v[148:149], v15 offset:4096
    v_mfma_f32_16x16x32_bf16 v[88:91], v[172:175], a[216:219], v[88:91]
    ds_read_b64_tr_b16 v[150:151], v15 offset:6144
    v_rcp_f32 v199, v199
    v_mfma_f32_16x16x32_bf16 v[92:95], v[168:171], a[204:207], v[92:95]
    buffer_load_dwordx4 v10, s[16:19], s44 offen offset:2048 lds
    v_mfma_f32_16x16x32_bf16 v[92:95], v[172:175], a[220:223], v[92:95]
    ds_read_b64_tr_b16 v[152:153], v15 offset:8192
    v_mfma_f32_16x16x32_bf16 v[80:83], v[176:179], a[224:227], v[80:83]
    ds_read_b64_tr_b16 v[154:155], v15 offset:10240
    v_mul_f32 v52, v196, v52
    v_mfma_f32_16x16x32_bf16 v[80:83], v[180:183], a[240:243], v[80:83]
    s_add_u32 m0, s46, 101376
    s_add_u32 s45, s47, 1990912
    buffer_load_dwordx4 v8, s[16:19], s45 offen offset:0 lds
    v_mfma_f32_16x16x32_bf16 v[84:87], v[176:179], a[228:231], v[84:87]
    ds_read_b64_tr_b16 v[156:157], v15 offset:12288
    v_mul_f32 v53, v197, v53
    v_mfma_f32_16x16x32_bf16 v[84:87], v[180:183], a[244:247], v[84:87]
    ds_read_b64_tr_b16 v[158:159], v15 offset:14336
    v_mfma_f32_16x16x32_bf16 v[88:91], v[176:179], a[232:235], v[88:91]
    buffer_load_dwordx4 v9, s[16:19], s45 offen offset:1024 lds
    v_mfma_f32_16x16x32_bf16 v[88:91], v[180:183], a[248:251], v[88:91]
    ds_read_b64_tr_b16 v[160:161], v15 offset:16384
    v_mul_f32 v54, v198, v54
    v_mfma_f32_16x16x32_bf16 v[92:95], v[176:179], a[236:239], v[92:95]
    ds_read_b64_tr_b16 v[162:163], v15 offset:18432
    v_mfma_f32_16x16x32_bf16 v[92:95], v[180:183], a[252:255], v[92:95]
    buffer_load_dwordx4 v10, s[16:19], s45 offen offset:2048 lds
    v_mfma_f32_16x16x32_bf16 v[80:83], v[184:187], v[224:227], v[80:83]
    ds_read_b64_tr_b16 v[164:165], v15 offset:20480
    v_mul_f32 v55, v199, v55
    v_mfma_f32_16x16x32_bf16 v[80:83], v[188:191], v[240:243], v[80:83]
    ds_read_b64_tr_b16 v[166:167], v15 offset:22528
    v_mfma_f32_16x16x32_bf16 v[84:87], v[184:187], v[228:231], v[84:87]
    v_mul_f32 v200, s50, v56
    v_mul_f32 v201, s50, v57
    v_mfma_f32_16x16x32_bf16 v[84:87], v[188:191], v[244:247], v[84:87]
    v_mul_f32 v202, s50, v58
    v_mfma_f32_16x16x32_bf16 v[88:91], v[184:187], v[232:235], v[88:91]
    v_mul_f32 v203, s50, v59
    v_mfma_f32_16x16x32_bf16 v[88:91], v[188:191], v[248:251], v[88:91]
    v_exp_f32 v200, v200
    v_exp_f32 v201, v201
    v_mfma_f32_16x16x32_bf16 v[92:95], v[184:187], v[236:239], v[92:95]
    v_exp_f32 v202, v202
    v_mfma_f32_16x16x32_bf16 v[92:95], v[188:191], v[252:255], v[92:95]
    v_exp_f32 v203, v203
    s_waitcnt lgkmcnt(0) vmcnt(19)
    s_barrier
    v_mfma_f32_16x16x32_bf16 v[32:35], v[144:147], a[0:3], 0
    s_add_u32 m0, s46, 49152
    s_add_u32 s44, s47, 3539200
    buffer_load_dwordx4 v8, s[16:19], s44 offen offset:0 lds
    v_add_f32 v200, 1.0, v200
    v_mfma_f32_16x16x32_bf16 v[32:35], v[148:151], a[16:19], v[32:35]
    ds_read_b64_tr_b16 v[168:169], v14 offset:0
    v_mfma_f32_16x16x32_bf16 v[36:39], v[144:147], a[4:7], 0
    ds_read_b64_tr_b16 v[170:171], v14 offset:2048
    v_add_f32 v201, 1.0, v201
    v_mfma_f32_16x16x32_bf16 v[36:39], v[148:151], a[20:23], v[36:39]
    buffer_load_dwordx4 v9, s[16:19], s44 offen offset:1024 lds
    v_mfma_f32_16x16x32_bf16 v[40:43], v[144:147], a[8:11], 0
    ds_read_b64_tr_b16 v[172:173], v14 offset:4096
    v_add_f32 v202, 1.0, v202
    v_mfma_f32_16x16x32_bf16 v[40:43], v[148:151], a[24:27], v[40:43]
    ds_read_b64_tr_b16 v[174:175], v14 offset:6144
    v_mfma_f32_16x16x32_bf16 v[44:47], v[144:147], a[12:15], 0
    buffer_load_dwordx4 v10, s[16:19], s44 offen offset:2048 lds
    v_add_f32 v203, 1.0, v203
    v_mfma_f32_16x16x32_bf16 v[44:47], v[148:151], a[28:31], v[44:47]
    ds_read_b64_tr_b16 v[176:177], v14 offset:8192
    v_mfma_f32_16x16x32_bf16 v[32:35], v[152:155], a[32:35], v[32:35]
    ds_read_b64_tr_b16 v[178:179], v14 offset:10240
    v_rcp_f32 v200, v200
    v_mfma_f32_16x16x32_bf16 v[32:35], v[156:159], a[48:51], v[32:35]
    s_add_u32 m0, s46, 52224
    s_add_u32 s45, s47, 3760384
    buffer_load_dwordx4 v8, s[16:19], s45 offen offset:0 lds
    v_mfma_f32_16x16x32_bf16 v[36:39], v[152:155], a[36:39], v[36:39]
    ds_read_b64_tr_b16 v[180:181], v14 offset:12288
    v_rcp_f32 v201, v201
    v_mfma_f32_16x16x32_bf16 v[36:39], v[156:159], a[52:55], v[36:39]
    ds_read_b64_tr_b16 v[182:183], v14 offset:14336
    v_mfma_f32_16x16x32_bf16 v[40:43], v[152:155], a[40:43], v[40:43]
    buffer_load_dwordx4 v9, s[16:19], s45 offen offset:1024 lds
    v_rcp_f32 v202, v202
    v_mfma_f32_16x16x32_bf16 v[40:43], v[156:159], a[56:59], v[40:43]
    ds_read_b64_tr_b16 v[184:185], v14 offset:16384
    v_mfma_f32_16x16x32_bf16 v[44:47], v[152:155], a[44:47], v[44:47]
    ds_read_b64_tr_b16 v[186:187], v14 offset:18432
    v_rcp_f32 v203, v203
    v_mfma_f32_16x16x32_bf16 v[44:47], v[156:159], a[60:63], v[44:47]
    buffer_load_dwordx4 v10, s[16:19], s45 offen offset:2048 lds
    v_mfma_f32_16x16x32_bf16 v[32:35], v[160:163], a[64:67], v[32:35]
    ds_read_b64_tr_b16 v[188:189], v14 offset:20480
    v_mul_f32 v56, v200, v56
    v_mfma_f32_16x16x32_bf16 v[32:35], v[164:167], a[80:83], v[32:35]
    ds_read_b64_tr_b16 v[190:191], v14 offset:22528
    v_mfma_f32_16x16x32_bf16 v[36:39], v[160:163], a[68:71], v[36:39]
    v_mul_f32 v57, v201, v57
    v_mul_f32 v58, v202, v58
    v_mfma_f32_16x16x32_bf16 v[36:39], v[164:167], a[84:87], v[36:39]
    v_mul_f32 v59, v203, v59
    v_mfma_f32_16x16x32_bf16 v[40:43], v[160:163], a[72:75], v[40:43]
    v_mul_f32 v192, s50, v60
    v_mul_f32 v193, s50, v61
    v_mfma_f32_16x16x32_bf16 v[40:43], v[164:167], a[88:91], v[40:43]
    v_mul_f32 v194, s50, v62
    v_mfma_f32_16x16x32_bf16 v[44:47], v[160:163], a[76:79], v[44:47]
    v_mul_f32 v195, s50, v63
    v_exp_f32 v192, v192
    v_mfma_f32_16x16x32_bf16 v[44:47], v[164:167], a[92:95], v[44:47]
    v_exp_f32 v193, v193
    s_waitcnt lgkmcnt(0) vmcnt(19)
    s_barrier
    v_mfma_f32_16x16x32_bf16 v[32:35], v[168:171], a[96:99], v[32:35]
    s_add_u32 m0, s46, 0
    s_add_u32 s44, s47, 384
    buffer_load_dwordx4 v8, s[12:15], s44 offen offset:0 lds
    v_exp_f32 v194, v194
    v_mfma_f32_16x16x32_bf16 v[32:35], v[172:175], a[112:115], v[32:35]
    ds_read_b64_tr_b16 v[144:145], v15 offset:24576
    v_mfma_f32_16x16x32_bf16 v[36:39], v[168:171], a[100:103], v[36:39]
    ds_read_b64_tr_b16 v[146:147], v15 offset:26624
    v_exp_f32 v195, v195
    v_mfma_f32_16x16x32_bf16 v[36:39], v[172:175], a[116:119], v[36:39]
    buffer_load_dwordx4 v9, s[12:15], s44 offen offset:1024 lds
    v_mfma_f32_16x16x32_bf16 v[40:43], v[168:171], a[104:107], v[40:43]
    ds_read_b64_tr_b16 v[148:149], v15 offset:28672
    v_add_f32 v192, 1.0, v192
    v_mfma_f32_16x16x32_bf16 v[40:43], v[172:175], a[120:123], v[40:43]
    ds_read_b64_tr_b16 v[150:151], v15 offset:30720
    v_mfma_f32_16x16x32_bf16 v[44:47], v[168:171], a[108:111], v[44:47]
    buffer_load_dwordx4 v10, s[12:15], s44 offen offset:2048 lds
    v_mfma_f32_16x16x32_bf16 v[44:47], v[172:175], a[124:127], v[44:47]
    ds_read_b64_tr_b16 v[152:153], v15 offset:32768
    v_add_f32 v193, 1.0, v193
    v_mfma_f32_16x16x32_bf16 v[32:35], v[176:179], a[128:131], v[32:35]
    ds_read_b64_tr_b16 v[154:155], v15 offset:34816
    v_mfma_f32_16x16x32_bf16 v[32:35], v[180:183], a[144:147], v[32:35]
    s_add_u32 m0, s46, 3072
    s_add_u32 s45, s47, 221568
    buffer_load_dwordx4 v8, s[12:15], s45 offen offset:0 lds
    v_add_f32 v194, 1.0, v194
    v_mfma_f32_16x16x32_bf16 v[36:39], v[176:179], a[132:135], v[36:39]
    ds_read_b64_tr_b16 v[156:157], v15 offset:36864
    v_mfma_f32_16x16x32_bf16 v[36:39], v[180:183], a[148:151], v[36:39]
    ds_read_b64_tr_b16 v[158:159], v15 offset:38912
    v_mfma_f32_16x16x32_bf16 v[40:43], v[176:179], a[136:139], v[40:43]
    buffer_load_dwordx4 v9, s[12:15], s45 offen offset:1024 lds
    v_add_f32 v195, 1.0, v195
    v_mfma_f32_16x16x32_bf16 v[40:43], v[180:183], a[152:155], v[40:43]
    ds_read_b64_tr_b16 v[160:161], v15 offset:40960
    v_mfma_f32_16x16x32_bf16 v[44:47], v[176:179], a[140:143], v[44:47]
    ds_read_b64_tr_b16 v[162:163], v15 offset:43008
    v_rcp_f32 v192, v192
    v_mfma_f32_16x16x32_bf16 v[44:47], v[180:183], a[156:159], v[44:47]
    buffer_load_dwordx4 v10, s[12:15], s45 offen offset:2048 lds
    v_mfma_f32_16x16x32_bf16 v[32:35], v[184:187], a[160:163], v[32:35]
    ds_read_b64_tr_b16 v[164:165], v15 offset:45056
    v_rcp_f32 v193, v193
    v_mfma_f32_16x16x32_bf16 v[32:35], v[188:191], a[176:179], v[32:35]
    ds_read_b64_tr_b16 v[166:167], v15 offset:47104
    v_mfma_f32_16x16x32_bf16 v[36:39], v[184:187], a[164:167], v[36:39]
    v_rcp_f32 v194, v194
    v_mfma_f32_16x16x32_bf16 v[36:39], v[188:191], a[180:183], v[36:39]
    v_rcp_f32 v195, v195
    v_mul_f32 v60, v192, v60
    v_mfma_f32_16x16x32_bf16 v[40:43], v[184:187], a[168:171], v[40:43]
    v_mul_f32 v61, v193, v61
    v_mfma_f32_16x16x32_bf16 v[40:43], v[188:191], a[184:187], v[40:43]
    v_mul_f32 v62, v194, v62
    v_mul_f32 v63, v195, v63
    v_mfma_f32_16x16x32_bf16 v[44:47], v[184:187], a[172:175], v[44:47]
    v_mul_f32 v48, v48, v80
    v_mfma_f32_16x16x32_bf16 v[44:47], v[188:191], a[188:191], v[44:47]
    v_mul_f32 v49, v49, v81
    s_waitcnt lgkmcnt(0) vmcnt(18)
    s_barrier
    v_mfma_f32_16x16x32_bf16 v[32:35], v[144:147], a[192:195], v[32:35]
    s_add_u32 m0, s46, 73728
    s_add_u32 s44, s47, 1769856
    buffer_load_dwordx4 v8, s[12:15], s44 offen offset:0 lds
    v_mul_f32 v50, v50, v82
    v_mfma_f32_16x16x32_bf16 v[32:35], v[148:151], a[208:211], v[32:35]
    ds_read_b64_tr_b16 v[168:169], v14 offset:24576
    v_mul_f32 v51, v51, v83
    v_mfma_f32_16x16x32_bf16 v[36:39], v[144:147], a[196:199], v[36:39]
    ds_read_b64_tr_b16 v[170:171], v14 offset:26624
    v_mfma_f32_16x16x32_bf16 v[36:39], v[148:151], a[212:215], v[36:39]
    buffer_load_dwordx4 v9, s[12:15], s44 offen offset:1024 lds
    v_cvt_pk_bf16_f32 v104, v48, v49
    v_mfma_f32_16x16x32_bf16 v[40:43], v[144:147], a[200:203], v[40:43]
    ds_read_b64_tr_b16 v[172:173], v14 offset:28672
    v_cvt_pk_bf16_f32 v105, v50, v51
    v_mfma_f32_16x16x32_bf16 v[40:43], v[148:151], a[216:219], v[40:43]
    ds_read_b64_tr_b16 v[174:175], v14 offset:30720
    v_mfma_f32_16x16x32_bf16 v[44:47], v[144:147], a[204:207], v[44:47]
    buffer_load_dwordx4 v10, s[12:15], s44 offen offset:2048 lds
    v_mul_f32 v52, v52, v84
    v_mfma_f32_16x16x32_bf16 v[44:47], v[148:151], a[220:223], v[44:47]
    ds_read_b64_tr_b16 v[176:177], v14 offset:32768
    v_mul_f32 v53, v53, v85
    v_mfma_f32_16x16x32_bf16 v[32:35], v[152:155], a[224:227], v[32:35]
    ds_read_b64_tr_b16 v[178:179], v14 offset:34816
    v_mfma_f32_16x16x32_bf16 v[32:35], v[156:159], a[240:243], v[32:35]
    s_add_u32 m0, s46, 76800
    s_add_u32 s45, s47, 1991040
    buffer_load_dwordx4 v8, s[12:15], s45 offen offset:0 lds
    v_mul_f32 v54, v54, v86
    v_mfma_f32_16x16x32_bf16 v[36:39], v[152:155], a[228:231], v[36:39]
    ds_read_b64_tr_b16 v[180:181], v14 offset:36864
    v_mul_f32 v55, v55, v87
    v_mfma_f32_16x16x32_bf16 v[36:39], v[156:159], a[244:247], v[36:39]
    ds_read_b64_tr_b16 v[182:183], v14 offset:38912
    v_mfma_f32_16x16x32_bf16 v[40:43], v[152:155], a[232:235], v[40:43]
    buffer_load_dwordx4 v9, s[12:15], s45 offen offset:1024 lds
    v_cvt_pk_bf16_f32 v106, v52, v53
    v_mfma_f32_16x16x32_bf16 v[40:43], v[156:159], a[248:251], v[40:43]
    ds_read_b64_tr_b16 v[184:185], v14 offset:40960
    v_cvt_pk_bf16_f32 v107, v54, v55
    v_mfma_f32_16x16x32_bf16 v[44:47], v[152:155], a[236:239], v[44:47]
    ds_read_b64_tr_b16 v[186:187], v14 offset:43008
    v_mfma_f32_16x16x32_bf16 v[44:47], v[156:159], a[252:255], v[44:47]
    buffer_load_dwordx4 v10, s[12:15], s45 offen offset:2048 lds
    v_mul_f32 v56, v56, v88
    v_mfma_f32_16x16x32_bf16 v[32:35], v[160:163], v[224:227], v[32:35]
    ds_read_b64_tr_b16 v[188:189], v14 offset:45056
    v_mul_f32 v57, v57, v89
    v_mfma_f32_16x16x32_bf16 v[32:35], v[164:167], v[240:243], v[32:35]
    ds_read_b64_tr_b16 v[190:191], v14 offset:47104
    v_mfma_f32_16x16x32_bf16 v[36:39], v[160:163], v[228:231], v[36:39]
    v_mul_f32 v58, v58, v90
    v_mul_f32 v59, v59, v91
    v_mfma_f32_16x16x32_bf16 v[36:39], v[164:167], v[244:247], v[36:39]
    v_cvt_pk_bf16_f32 v108, v56, v57
    v_cvt_pk_bf16_f32 v109, v58, v59
    v_mfma_f32_16x16x32_bf16 v[40:43], v[160:163], v[232:235], v[40:43]
    v_mul_f32 v60, v60, v92
    v_mfma_f32_16x16x32_bf16 v[40:43], v[164:167], v[248:251], v[40:43]
    v_mul_f32 v61, v61, v93
    v_mul_f32 v62, v62, v94
    v_mfma_f32_16x16x32_bf16 v[44:47], v[160:163], v[236:239], v[44:47]
    v_mul_f32 v63, v63, v95
    v_cvt_pk_bf16_f32 v110, v60, v61
    v_mfma_f32_16x16x32_bf16 v[44:47], v[164:167], v[252:255], v[44:47]
    v_cvt_pk_bf16_f32 v111, v62, v63
    s_waitcnt lgkmcnt(0) vmcnt(18)
    s_barrier
    v_mfma_f32_16x16x32_bf16 v[64:67], v[168:171], a[0:3], 0
    s_add_u32 m0, s46, 24576
    s_add_u32 s44, s47, 3539328
    buffer_load_dwordx4 v8, s[12:15], s44 offen offset:0 lds
    v_mul_f32 v192, s50, v32
    v_mfma_f32_16x16x32_bf16 v[64:67], v[172:175], a[16:19], v[64:67]
    ds_read_b64_tr_b16 v[144:145], v16 offset:0
    v_mfma_f32_16x16x32_bf16 v[68:71], v[168:171], a[4:7], 0
    ds_read_b64_tr_b16 v[146:147], v16 offset:2048
    v_mul_f32 v193, s50, v33
    v_mfma_f32_16x16x32_bf16 v[68:71], v[172:175], a[20:23], v[68:71]
    buffer_load_dwordx4 v9, s[12:15], s44 offen offset:1024 lds
    v_mfma_f32_16x16x32_bf16 v[72:75], v[168:171], a[8:11], 0
    ds_read_b64_tr_b16 v[148:149], v16 offset:4096
    v_mul_f32 v194, s50, v34
    v_mfma_f32_16x16x32_bf16 v[72:75], v[172:175], a[24:27], v[72:75]
    ds_read_b64_tr_b16 v[150:151], v16 offset:6144
    v_mfma_f32_16x16x32_bf16 v[76:79], v[168:171], a[12:15], 0
    buffer_load_dwordx4 v10, s[12:15], s44 offen offset:2048 lds
    v_mfma_f32_16x16x32_bf16 v[76:79], v[172:175], a[28:31], v[76:79]
    ds_read_b64_tr_b16 v[152:153], v16 offset:8192
    v_mul_f32 v195, s50, v35
    v_mfma_f32_16x16x32_bf16 v[64:67], v[176:179], a[32:35], v[64:67]
    ds_read_b64_tr_b16 v[154:155], v16 offset:10240
    v_mfma_f32_16x16x32_bf16 v[64:67], v[180:183], a[48:51], v[64:67]
    s_add_u32 m0, s46, 27648
    s_add_u32 s45, s47, 3760512
    buffer_load_dwordx4 v8, s[12:15], s45 offen offset:0 lds
    v_exp_f32 v192, v192
    v_mfma_f32_16x16x32_bf16 v[68:71], v[176:179], a[36:39], v[68:71]
    ds_read_b64_tr_b16 v[156:157], v16 offset:12288
    v_mfma_f32_16x16x32_bf16 v[68:71], v[180:183], a[52:55], v[68:71]
    ds_read_b64_tr_b16 v[158:159], v16 offset:14336
    v_mfma_f32_16x16x32_bf16 v[72:75], v[176:179], a[40:43], v[72:75]
    buffer_load_dwordx4 v9, s[12:15], s45 offen offset:1024 lds
    v_exp_f32 v193, v193
    v_mfma_f32_16x16x32_bf16 v[72:75], v[180:183], a[56:59], v[72:75]
    ds_read_b64_tr_b16 v[160:161], v16 offset:16384
    v_mfma_f32_16x16x32_bf16 v[76:79], v[176:179], a[44:47], v[76:79]
    ds_read_b64_tr_b16 v[162:163], v16 offset:18432
    v_exp_f32 v194, v194
    v_mfma_f32_16x16x32_bf16 v[76:79], v[180:183], a[60:63], v[76:79]
    buffer_load_dwordx4 v10, s[12:15], s45 offen offset:2048 lds
    v_mfma_f32_16x16x32_bf16 v[64:67], v[184:187], a[64:67], v[64:67]
    ds_read_b64_tr_b16 v[164:165], v16 offset:20480
    v_exp_f32 v195, v195
    v_mfma_f32_16x16x32_bf16 v[64:67], v[188:191], a[80:83], v[64:67]
    ds_read_b64_tr_b16 v[166:167], v16 offset:22528
    v_mfma_f32_16x16x32_bf16 v[68:71], v[184:187], a[68:71], v[68:71]
    v_add_f32 v192, 1.0, v192
    v_mfma_f32_16x16x32_bf16 v[68:71], v[188:191], a[84:87], v[68:71]
    v_add_f32 v193, 1.0, v193
    v_add_f32 v194, 1.0, v194
    v_mfma_f32_16x16x32_bf16 v[72:75], v[184:187], a[72:75], v[72:75]
    v_add_f32 v195, 1.0, v195
    v_mfma_f32_16x16x32_bf16 v[72:75], v[188:191], a[88:91], v[72:75]
    v_rcp_f32 v192, v192
    v_rcp_f32 v193, v193
    v_mfma_f32_16x16x32_bf16 v[76:79], v[184:187], a[76:79], v[76:79]
    v_rcp_f32 v194, v194
    v_mfma_f32_16x16x32_bf16 v[76:79], v[188:191], a[92:95], v[76:79]
    v_rcp_f32 v195, v195
    s_waitcnt lgkmcnt(0) vmcnt(18)
    s_barrier
    v_mfma_f32_16x16x32_bf16 v[64:67], v[144:147], a[96:99], v[64:67]
    s_add_u32 m0, s46, 98304
    s_add_u32 s44, s47, 384
    buffer_load_dwordx4 v8, s[16:19], s44 offen offset:0 lds
    v_mul_f32 v32, v192, v32
    v_mfma_f32_16x16x32_bf16 v[64:67], v[148:151], a[112:115], v[64:67]
    ds_read_b64_tr_b16 v[168:169], v15 offset:0
    v_mfma_f32_16x16x32_bf16 v[68:71], v[144:147], a[100:103], v[68:71]
    ds_read_b64_tr_b16 v[170:171], v15 offset:2048
    v_mul_f32 v33, v193, v33
    v_mfma_f32_16x16x32_bf16 v[68:71], v[148:151], a[116:119], v[68:71]
    buffer_load_dwordx4 v9, s[16:19], s44 offen offset:1024 lds
    v_mfma_f32_16x16x32_bf16 v[72:75], v[144:147], a[104:107], v[72:75]
    ds_read_b64_tr_b16 v[172:173], v15 offset:4096
    v_mul_f32 v34, v194, v34
    v_mfma_f32_16x16x32_bf16 v[72:75], v[148:151], a[120:123], v[72:75]
    ds_read_b64_tr_b16 v[174:175], v15 offset:6144
    v_mfma_f32_16x16x32_bf16 v[76:79], v[144:147], a[108:111], v[76:79]
    buffer_load_dwordx4 v10, s[16:19], s44 offen offset:2048 lds
    v_mul_f32 v35, v195, v35
    v_mfma_f32_16x16x32_bf16 v[76:79], v[148:151], a[124:127], v[76:79]
    ds_read_b64_tr_b16 v[176:177], v15 offset:8192
    v_mfma_f32_16x16x32_bf16 v[64:67], v[152:155], a[128:131], v[64:67]
    ds_read_b64_tr_b16 v[178:179], v15 offset:10240
    v_mul_f32 v196, s50, v36
    v_mfma_f32_16x16x32_bf16 v[64:67], v[156:159], a[144:147], v[64:67]
    s_add_u32 m0, s46, 101376
    s_add_u32 s45, s47, 221568
    buffer_load_dwordx4 v8, s[16:19], s45 offen offset:0 lds
    v_mfma_f32_16x16x32_bf16 v[68:71], v[152:155], a[132:135], v[68:71]
    ds_read_b64_tr_b16 v[180:181], v15 offset:12288
    v_mul_f32 v197, s50, v37
    v_mfma_f32_16x16x32_bf16 v[68:71], v[156:159], a[148:151], v[68:71]
    ds_read_b64_tr_b16 v[182:183], v15 offset:14336
    v_mfma_f32_16x16x32_bf16 v[72:75], v[152:155], a[136:139], v[72:75]
    buffer_load_dwordx4 v9, s[16:19], s45 offen offset:1024 lds
    v_mfma_f32_16x16x32_bf16 v[72:75], v[156:159], a[152:155], v[72:75]
    ds_read_b64_tr_b16 v[184:185], v15 offset:16384
    v_mul_f32 v198, s50, v38
    v_mfma_f32_16x16x32_bf16 v[76:79], v[152:155], a[140:143], v[76:79]
    ds_read_b64_tr_b16 v[186:187], v15 offset:18432
    v_mfma_f32_16x16x32_bf16 v[76:79], v[156:159], a[156:159], v[76:79]
    buffer_load_dwordx4 v10, s[16:19], s45 offen offset:2048 lds
    v_mul_f32 v199, s50, v39
    v_mfma_f32_16x16x32_bf16 v[64:67], v[160:163], a[160:163], v[64:67]
    ds_read_b64_tr_b16 v[188:189], v15 offset:20480
    v_mfma_f32_16x16x32_bf16 v[64:67], v[164:167], a[176:179], v[64:67]
    ds_read_b64_tr_b16 v[190:191], v15 offset:22528
    v_exp_f32 v196, v196
    v_mfma_f32_16x16x32_bf16 v[68:71], v[160:163], a[164:167], v[68:71]
    v_exp_f32 v197, v197
    v_mfma_f32_16x16x32_bf16 v[68:71], v[164:167], a[180:183], v[68:71]
    v_exp_f32 v198, v198
    v_exp_f32 v199, v199
    v_mfma_f32_16x16x32_bf16 v[72:75], v[160:163], a[168:171], v[72:75]
    v_add_f32 v196, 1.0, v196
    v_mfma_f32_16x16x32_bf16 v[72:75], v[164:167], a[184:187], v[72:75]
    v_add_f32 v197, 1.0, v197
    v_add_f32 v198, 1.0, v198
    v_mfma_f32_16x16x32_bf16 v[76:79], v[160:163], a[172:175], v[76:79]
    v_add_f32 v199, 1.0, v199
    v_mfma_f32_16x16x32_bf16 v[76:79], v[164:167], a[188:191], v[76:79]
    v_rcp_f32 v196, v196
    s_waitcnt lgkmcnt(0) vmcnt(18)
    s_barrier
    v_mfma_f32_16x16x32_bf16 v[64:67], v[168:171], a[192:195], v[64:67]
    s_add_u32 m0, s46, 49152
    s_add_u32 s44, s47, 1769856
    buffer_load_dwordx4 v8, s[16:19], s44 offen offset:0 lds
    v_rcp_f32 v197, v197
    v_mfma_f32_16x16x32_bf16 v[64:67], v[172:175], a[208:211], v[64:67]
    ds_read_b64_tr_b16 v[144:145], v14 offset:0
    v_mfma_f32_16x16x32_bf16 v[68:71], v[168:171], a[196:199], v[68:71]
    ds_read_b64_tr_b16 v[146:147], v14 offset:2048
    v_rcp_f32 v198, v198
    v_mfma_f32_16x16x32_bf16 v[68:71], v[172:175], a[212:215], v[68:71]
    buffer_load_dwordx4 v9, s[16:19], s44 offen offset:1024 lds
    v_mfma_f32_16x16x32_bf16 v[72:75], v[168:171], a[200:203], v[72:75]
    ds_read_b64_tr_b16 v[148:149], v14 offset:4096
    v_mfma_f32_16x16x32_bf16 v[72:75], v[172:175], a[216:219], v[72:75]
    ds_read_b64_tr_b16 v[150:151], v14 offset:6144
    v_rcp_f32 v199, v199
    v_mfma_f32_16x16x32_bf16 v[76:79], v[168:171], a[204:207], v[76:79]
    buffer_load_dwordx4 v10, s[16:19], s44 offen offset:2048 lds
    v_mfma_f32_16x16x32_bf16 v[76:79], v[172:175], a[220:223], v[76:79]
    ds_read_b64_tr_b16 v[152:153], v14 offset:8192
    v_mfma_f32_16x16x32_bf16 v[64:67], v[176:179], a[224:227], v[64:67]
    ds_read_b64_tr_b16 v[154:155], v14 offset:10240
    v_mul_f32 v36, v196, v36
    v_mfma_f32_16x16x32_bf16 v[64:67], v[180:183], a[240:243], v[64:67]
    s_add_u32 m0, s46, 52224
    s_add_u32 s45, s47, 1991040
    buffer_load_dwordx4 v8, s[16:19], s45 offen offset:0 lds
    v_mfma_f32_16x16x32_bf16 v[68:71], v[176:179], a[228:231], v[68:71]
    ds_read_b64_tr_b16 v[156:157], v14 offset:12288
    v_mul_f32 v37, v197, v37
    v_mfma_f32_16x16x32_bf16 v[68:71], v[180:183], a[244:247], v[68:71]
    ds_read_b64_tr_b16 v[158:159], v14 offset:14336
    v_mfma_f32_16x16x32_bf16 v[72:75], v[176:179], a[232:235], v[72:75]
    buffer_load_dwordx4 v9, s[16:19], s45 offen offset:1024 lds
    v_mfma_f32_16x16x32_bf16 v[72:75], v[180:183], a[248:251], v[72:75]
    ds_read_b64_tr_b16 v[160:161], v14 offset:16384
    v_mul_f32 v38, v198, v38
    v_mfma_f32_16x16x32_bf16 v[76:79], v[176:179], a[236:239], v[76:79]
    ds_read_b64_tr_b16 v[162:163], v14 offset:18432
    v_mfma_f32_16x16x32_bf16 v[76:79], v[180:183], a[252:255], v[76:79]
    buffer_load_dwordx4 v10, s[16:19], s45 offen offset:2048 lds
    v_mfma_f32_16x16x32_bf16 v[64:67], v[184:187], v[224:227], v[64:67]
    ds_read_b64_tr_b16 v[164:165], v14 offset:20480
    v_mul_f32 v39, v199, v39
    v_mfma_f32_16x16x32_bf16 v[64:67], v[188:191], v[240:243], v[64:67]
    ds_read_b64_tr_b16 v[166:167], v14 offset:22528
    v_mfma_f32_16x16x32_bf16 v[68:71], v[184:187], v[228:231], v[68:71]
    v_mul_f32 v200, s50, v40
    v_mul_f32 v201, s50, v41
    v_mfma_f32_16x16x32_bf16 v[68:71], v[188:191], v[244:247], v[68:71]
    v_mul_f32 v202, s50, v42
    v_mfma_f32_16x16x32_bf16 v[72:75], v[184:187], v[232:235], v[72:75]
    v_mul_f32 v203, s50, v43
    v_mfma_f32_16x16x32_bf16 v[72:75], v[188:191], v[248:251], v[72:75]
    v_exp_f32 v200, v200
    v_exp_f32 v201, v201
    v_mfma_f32_16x16x32_bf16 v[76:79], v[184:187], v[236:239], v[76:79]
    v_exp_f32 v202, v202
    v_mfma_f32_16x16x32_bf16 v[76:79], v[188:191], v[252:255], v[76:79]
    v_exp_f32 v203, v203
    s_waitcnt lgkmcnt(0) vmcnt(18)
    s_barrier
    v_mfma_f32_16x16x32_bf16 v[48:51], v[144:147], a[0:3], 0
    s_add_u32 m0, s46, 0
    s_add_u32 s44, s47, 3539328
    buffer_load_dwordx4 v8, s[16:19], s44 offen offset:0 lds
    ds_read_b64_tr_b16 v[168:169], v15 offset:24576
    v_mfma_f32_16x16x32_bf16 v[48:51], v[148:151], a[16:19], v[48:51]
    ds_read_b64_tr_b16 v[170:171], v15 offset:26624
    v_add_f32 v200, 1.0, v200
    v_mfma_f32_16x16x32_bf16 v[52:55], v[144:147], a[4:7], 0
    buffer_load_dwordx4 v9, s[16:19], s44 offen offset:1024 lds
    v_mfma_f32_16x16x32_bf16 v[52:55], v[148:151], a[20:23], v[52:55]
    ds_read_b64_tr_b16 v[172:173], v15 offset:28672
    v_add_f32 v201, 1.0, v201
    v_mfma_f32_16x16x32_bf16 v[56:59], v[144:147], a[8:11], 0
    ds_read_b64_tr_b16 v[174:175], v15 offset:30720
    v_mfma_f32_16x16x32_bf16 v[56:59], v[148:151], a[24:27], v[56:59]
    buffer_load_dwordx4 v10, s[16:19], s44 offen offset:2048 lds
    v_add_f32 v202, 1.0, v202
    v_mfma_f32_16x16x32_bf16 v[60:63], v[144:147], a[12:15], 0
    ds_read_b64_tr_b16 v[176:177], v15 offset:32768
    v_mfma_f32_16x16x32_bf16 v[60:63], v[148:151], a[28:31], v[60:63]
    ds_read_b64_tr_b16 v[178:179], v15 offset:34816
    v_add_f32 v203, 1.0, v203
    v_mfma_f32_16x16x32_bf16 v[48:51], v[152:155], a[32:35], v[48:51]
    s_add_u32 m0, s46, 3072
    s_add_u32 s45, s47, 3760512
    buffer_load_dwordx4 v8, s[16:19], s45 offen offset:0 lds
    v_mfma_f32_16x16x32_bf16 v[48:51], v[156:159], a[48:51], v[48:51]
    ds_read_b64_tr_b16 v[180:181], v15 offset:36864
    v_rcp_f32 v200, v200
    v_mfma_f32_16x16x32_bf16 v[52:55], v[152:155], a[36:39], v[52:55]
    ds_read_b64_tr_b16 v[182:183], v15 offset:38912
    v_mfma_f32_16x16x32_bf16 v[52:55], v[156:159], a[52:55], v[52:55]
    buffer_load_dwordx4 v9, s[16:19], s45 offen offset:1024 lds
    v_rcp_f32 v201, v201
    v_mfma_f32_16x16x32_bf16 v[56:59], v[152:155], a[40:43], v[56:59]
    ds_read_b64_tr_b16 v[184:185], v15 offset:40960
    v_rcp_f32 v202, v202
    v_mfma_f32_16x16x32_bf16 v[56:59], v[156:159], a[56:59], v[56:59]
    ds_read_b64_tr_b16 v[186:187], v15 offset:43008
    v_mfma_f32_16x16x32_bf16 v[60:63], v[152:155], a[44:47], v[60:63]
    buffer_load_dwordx4 v10, s[16:19], s45 offen offset:2048 lds
    v_rcp_f32 v203, v203
    v_mfma_f32_16x16x32_bf16 v[60:63], v[156:159], a[60:63], v[60:63]
    ds_read_b64_tr_b16 v[188:189], v15 offset:45056
    v_mfma_f32_16x16x32_bf16 v[48:51], v[160:163], a[64:67], v[48:51]
    ds_read_b64_tr_b16 v[190:191], v15 offset:47104
    v_mul_f32 v40, v200, v40
    v_mfma_f32_16x16x32_bf16 v[48:51], v[164:167], a[80:83], v[48:51]
    buffer_load_dword v6, v4, s[12:15], s47 offen offset:768
    v_mfma_f32_16x16x32_bf16 v[52:55], v[160:163], a[68:71], v[52:55]
    v_mul_f32 v41, v201, v41
    v_mul_f32 v42, v202, v42
    v_mfma_f32_16x16x32_bf16 v[52:55], v[164:167], a[84:87], v[52:55]
    v_mul_f32 v43, v203, v43
    v_mfma_f32_16x16x32_bf16 v[56:59], v[160:163], a[72:75], v[56:59]
    v_mul_f32 v192, s50, v44
    v_mul_f32 v193, s50, v45
    v_mfma_f32_16x16x32_bf16 v[56:59], v[164:167], a[88:91], v[56:59]
    v_mul_f32 v194, s50, v46
    v_mfma_f32_16x16x32_bf16 v[60:63], v[160:163], a[76:79], v[60:63]
    v_mul_f32 v195, s50, v47
    v_exp_f32 v192, v192
    v_mfma_f32_16x16x32_bf16 v[60:63], v[164:167], a[92:95], v[60:63]
    v_exp_f32 v193, v193
    s_waitcnt lgkmcnt(0) vmcnt(19)
    s_barrier
    v_mfma_f32_16x16x32_bf16 v[48:51], v[168:171], a[96:99], v[48:51]
    s_add_u32 m0, s46, 73728
    s_add_u32 s44, s47, 512
    buffer_load_dwordx4 v8, s[12:15], s44 offen offset:0 lds
    v_exp_f32 v194, v194
    v_mfma_f32_16x16x32_bf16 v[48:51], v[172:175], a[112:115], v[48:51]
    ds_read_b64_tr_b16 v[144:145], v14 offset:24576
    v_mfma_f32_16x16x32_bf16 v[52:55], v[168:171], a[100:103], v[52:55]
    ds_read_b64_tr_b16 v[146:147], v14 offset:26624
    v_exp_f32 v195, v195
    v_mfma_f32_16x16x32_bf16 v[52:55], v[172:175], a[116:119], v[52:55]
    buffer_load_dwordx4 v9, s[12:15], s44 offen offset:1024 lds
    v_mfma_f32_16x16x32_bf16 v[56:59], v[168:171], a[104:107], v[56:59]
    ds_read_b64_tr_b16 v[148:149], v14 offset:28672
    v_add_f32 v192, 1.0, v192
    v_mfma_f32_16x16x32_bf16 v[56:59], v[172:175], a[120:123], v[56:59]
    ds_read_b64_tr_b16 v[150:151], v14 offset:30720
    v_mfma_f32_16x16x32_bf16 v[60:63], v[168:171], a[108:111], v[60:63]
    buffer_load_dwordx4 v10, s[12:15], s44 offen offset:2048 lds
    v_mfma_f32_16x16x32_bf16 v[60:63], v[172:175], a[124:127], v[60:63]
    ds_read_b64_tr_b16 v[152:153], v14 offset:32768
    v_add_f32 v193, 1.0, v193
    v_mfma_f32_16x16x32_bf16 v[48:51], v[176:179], a[128:131], v[48:51]
    ds_read_b64_tr_b16 v[154:155], v14 offset:34816
    v_mfma_f32_16x16x32_bf16 v[48:51], v[180:183], a[144:147], v[48:51]
    s_add_u32 m0, s46, 76800
    s_add_u32 s45, s47, 221696
    buffer_load_dwordx4 v8, s[12:15], s45 offen offset:0 lds
    v_add_f32 v194, 1.0, v194
    v_mfma_f32_16x16x32_bf16 v[52:55], v[176:179], a[132:135], v[52:55]
    ds_read_b64_tr_b16 v[156:157], v14 offset:36864
    v_mfma_f32_16x16x32_bf16 v[52:55], v[180:183], a[148:151], v[52:55]
    ds_read_b64_tr_b16 v[158:159], v14 offset:38912
    v_mfma_f32_16x16x32_bf16 v[56:59], v[176:179], a[136:139], v[56:59]
    buffer_load_dwordx4 v9, s[12:15], s45 offen offset:1024 lds
    v_add_f32 v195, 1.0, v195
    v_mfma_f32_16x16x32_bf16 v[56:59], v[180:183], a[152:155], v[56:59]
    ds_read_b64_tr_b16 v[160:161], v14 offset:40960
    v_mfma_f32_16x16x32_bf16 v[60:63], v[176:179], a[140:143], v[60:63]
    ds_read_b64_tr_b16 v[162:163], v14 offset:43008
    v_rcp_f32 v192, v192
    v_mfma_f32_16x16x32_bf16 v[60:63], v[180:183], a[156:159], v[60:63]
    buffer_load_dwordx4 v10, s[12:15], s45 offen offset:2048 lds
    v_mfma_f32_16x16x32_bf16 v[48:51], v[184:187], a[160:163], v[48:51]
    ds_read_b64_tr_b16 v[164:165], v14 offset:45056
    v_rcp_f32 v193, v193
    v_mfma_f32_16x16x32_bf16 v[48:51], v[188:191], a[176:179], v[48:51]
    ds_read_b64_tr_b16 v[166:167], v14 offset:47104
    v_mfma_f32_16x16x32_bf16 v[52:55], v[184:187], a[164:167], v[52:55]
    v_rcp_f32 v194, v194
    v_mfma_f32_16x16x32_bf16 v[52:55], v[188:191], a[180:183], v[52:55]
    v_rcp_f32 v195, v195
    v_mul_f32 v44, v192, v44
    v_mfma_f32_16x16x32_bf16 v[56:59], v[184:187], a[168:171], v[56:59]
    v_mul_f32 v45, v193, v45
    v_mfma_f32_16x16x32_bf16 v[56:59], v[188:191], a[184:187], v[56:59]
    v_mul_f32 v46, v194, v46
    v_mul_f32 v47, v195, v47
    v_mfma_f32_16x16x32_bf16 v[60:63], v[184:187], a[172:175], v[60:63]
    v_mul_f32 v32, v32, v64
    v_mfma_f32_16x16x32_bf16 v[60:63], v[188:191], a[188:191], v[60:63]
    v_mul_f32 v33, v33, v65
    s_waitcnt lgkmcnt(0) vmcnt(19)
    s_barrier
    v_mfma_f32_16x16x32_bf16 v[48:51], v[144:147], a[192:195], v[48:51]
    s_add_u32 m0, s46, 24576
    s_add_u32 s44, s47, 1769984
    buffer_load_dwordx4 v8, s[12:15], s44 offen offset:0 lds
    v_mul_f32 v34, v34, v66
    v_mfma_f32_16x16x32_bf16 v[48:51], v[148:151], a[208:211], v[48:51]
    ds_read_b64_tr_b16 v[168:169], v16 offset:0
    v_mul_f32 v35, v35, v67
    v_mfma_f32_16x16x32_bf16 v[52:55], v[144:147], a[196:199], v[52:55]
    ds_read_b64_tr_b16 v[170:171], v16 offset:2048
    v_mfma_f32_16x16x32_bf16 v[52:55], v[148:151], a[212:215], v[52:55]
    buffer_load_dwordx4 v9, s[12:15], s44 offen offset:1024 lds
    v_cvt_pk_bf16_f32 v112, v32, v33
    v_mfma_f32_16x16x32_bf16 v[56:59], v[144:147], a[200:203], v[56:59]
    ds_read_b64_tr_b16 v[172:173], v16 offset:4096
    v_cvt_pk_bf16_f32 v113, v34, v35
    v_mfma_f32_16x16x32_bf16 v[56:59], v[148:151], a[216:219], v[56:59]
    ds_read_b64_tr_b16 v[174:175], v16 offset:6144
    v_mfma_f32_16x16x32_bf16 v[60:63], v[144:147], a[204:207], v[60:63]
    buffer_load_dwordx4 v10, s[12:15], s44 offen offset:2048 lds
    v_mul_f32 v36, v36, v68
    v_mfma_f32_16x16x32_bf16 v[60:63], v[148:151], a[220:223], v[60:63]
    ds_read_b64_tr_b16 v[176:177], v16 offset:8192
    v_mul_f32 v37, v37, v69
    v_mfma_f32_16x16x32_bf16 v[48:51], v[152:155], a[224:227], v[48:51]
    ds_read_b64_tr_b16 v[178:179], v16 offset:10240
    v_mfma_f32_16x16x32_bf16 v[48:51], v[156:159], a[240:243], v[48:51]
    s_add_u32 m0, s46, 27648
    s_add_u32 s45, s47, 1991168
    buffer_load_dwordx4 v8, s[12:15], s45 offen offset:0 lds
    v_mul_f32 v38, v38, v70
    v_mfma_f32_16x16x32_bf16 v[52:55], v[152:155], a[228:231], v[52:55]
    ds_read_b64_tr_b16 v[180:181], v16 offset:12288
    v_mul_f32 v39, v39, v71
    v_mfma_f32_16x16x32_bf16 v[52:55], v[156:159], a[244:247], v[52:55]
    ds_read_b64_tr_b16 v[182:183], v16 offset:14336
    v_mfma_f32_16x16x32_bf16 v[56:59], v[152:155], a[232:235], v[56:59]
    buffer_load_dwordx4 v9, s[12:15], s45 offen offset:1024 lds
    v_cvt_pk_bf16_f32 v114, v36, v37
    v_mfma_f32_16x16x32_bf16 v[56:59], v[156:159], a[248:251], v[56:59]
    ds_read_b64_tr_b16 v[184:185], v16 offset:16384
    v_cvt_pk_bf16_f32 v115, v38, v39
    v_mfma_f32_16x16x32_bf16 v[60:63], v[152:155], a[236:239], v[60:63]
    ds_read_b64_tr_b16 v[186:187], v16 offset:18432
    v_mfma_f32_16x16x32_bf16 v[60:63], v[156:159], a[252:255], v[60:63]
    buffer_load_dwordx4 v10, s[12:15], s45 offen offset:2048 lds
    v_mul_f32 v40, v40, v72
    v_mfma_f32_16x16x32_bf16 v[48:51], v[160:163], v[224:227], v[48:51]
    ds_read_b64_tr_b16 v[188:189], v16 offset:20480
    v_mul_f32 v41, v41, v73
    v_mfma_f32_16x16x32_bf16 v[48:51], v[164:167], v[240:243], v[48:51]
    ds_read_b64_tr_b16 v[190:191], v16 offset:22528
    v_mfma_f32_16x16x32_bf16 v[52:55], v[160:163], v[228:231], v[52:55]
    v_mul_f32 v42, v42, v74
    v_mul_f32 v43, v43, v75
    v_mfma_f32_16x16x32_bf16 v[52:55], v[164:167], v[244:247], v[52:55]
    v_cvt_pk_bf16_f32 v116, v40, v41
    v_cvt_pk_bf16_f32 v117, v42, v43
    v_mfma_f32_16x16x32_bf16 v[56:59], v[160:163], v[232:235], v[56:59]
    v_mul_f32 v44, v44, v76
    v_mfma_f32_16x16x32_bf16 v[56:59], v[164:167], v[248:251], v[56:59]
    v_mul_f32 v45, v45, v77
    v_mul_f32 v46, v46, v78
    v_mfma_f32_16x16x32_bf16 v[60:63], v[160:163], v[236:239], v[60:63]
    v_mul_f32 v47, v47, v79
    v_cvt_pk_bf16_f32 v118, v44, v45
    v_mfma_f32_16x16x32_bf16 v[60:63], v[164:167], v[252:255], v[60:63]
    v_cvt_pk_bf16_f32 v119, v46, v47
    s_waitcnt lgkmcnt(0) vmcnt(19)
    s_barrier
    v_mfma_f32_16x16x32_bf16 v[80:83], v[168:171], a[0:3], 0
    s_add_u32 m0, s46, 98304
    s_add_u32 s44, s47, 3539456
    buffer_load_dwordx4 v8, s[12:15], s44 offen offset:0 lds
    v_mul_f32 v192, s50, v48
    v_mfma_f32_16x16x32_bf16 v[80:83], v[172:175], a[16:19], v[80:83]
    ds_read_b64_tr_b16 v[144:145], v15 offset:0
    v_mfma_f32_16x16x32_bf16 v[84:87], v[168:171], a[4:7], 0
    ds_read_b64_tr_b16 v[146:147], v15 offset:2048
    v_mul_f32 v193, s50, v49
    v_mfma_f32_16x16x32_bf16 v[84:87], v[172:175], a[20:23], v[84:87]
    buffer_load_dwordx4 v9, s[12:15], s44 offen offset:1024 lds
    v_mfma_f32_16x16x32_bf16 v[88:91], v[168:171], a[8:11], 0
    ds_read_b64_tr_b16 v[148:149], v15 offset:4096
    v_mul_f32 v194, s50, v50
    v_mfma_f32_16x16x32_bf16 v[88:91], v[172:175], a[24:27], v[88:91]
    ds_read_b64_tr_b16 v[150:151], v15 offset:6144
    v_mfma_f32_16x16x32_bf16 v[92:95], v[168:171], a[12:15], 0
    buffer_load_dwordx4 v10, s[12:15], s44 offen offset:2048 lds
    v_mfma_f32_16x16x32_bf16 v[92:95], v[172:175], a[28:31], v[92:95]
    ds_read_b64_tr_b16 v[152:153], v15 offset:8192
    v_mul_f32 v195, s50, v51
    v_mfma_f32_16x16x32_bf16 v[80:83], v[176:179], a[32:35], v[80:83]
    ds_read_b64_tr_b16 v[154:155], v15 offset:10240
    v_mfma_f32_16x16x32_bf16 v[80:83], v[180:183], a[48:51], v[80:83]
    s_add_u32 m0, s46, 101376
    s_add_u32 s45, s47, 3760640
    buffer_load_dwordx4 v8, s[12:15], s45 offen offset:0 lds
    v_exp_f32 v192, v192
    v_mfma_f32_16x16x32_bf16 v[84:87], v[176:179], a[36:39], v[84:87]
    ds_read_b64_tr_b16 v[156:157], v15 offset:12288
    v_mfma_f32_16x16x32_bf16 v[84:87], v[180:183], a[52:55], v[84:87]
    ds_read_b64_tr_b16 v[158:159], v15 offset:14336
    v_mfma_f32_16x16x32_bf16 v[88:91], v[176:179], a[40:43], v[88:91]
    buffer_load_dwordx4 v9, s[12:15], s45 offen offset:1024 lds
    v_exp_f32 v193, v193
    v_mfma_f32_16x16x32_bf16 v[88:91], v[180:183], a[56:59], v[88:91]
    ds_read_b64_tr_b16 v[160:161], v15 offset:16384
    v_mfma_f32_16x16x32_bf16 v[92:95], v[176:179], a[44:47], v[92:95]
    ds_read_b64_tr_b16 v[162:163], v15 offset:18432
    v_exp_f32 v194, v194
    v_mfma_f32_16x16x32_bf16 v[92:95], v[180:183], a[60:63], v[92:95]
    buffer_load_dwordx4 v10, s[12:15], s45 offen offset:2048 lds
    v_mfma_f32_16x16x32_bf16 v[80:83], v[184:187], a[64:67], v[80:83]
    ds_read_b64_tr_b16 v[164:165], v15 offset:20480
    v_exp_f32 v195, v195
    v_mfma_f32_16x16x32_bf16 v[80:83], v[188:191], a[80:83], v[80:83]
    ds_read_b64_tr_b16 v[166:167], v15 offset:22528
    v_mfma_f32_16x16x32_bf16 v[84:87], v[184:187], a[68:71], v[84:87]
    v_add_f32 v192, 1.0, v192
    v_mfma_f32_16x16x32_bf16 v[84:87], v[188:191], a[84:87], v[84:87]
    v_add_f32 v193, 1.0, v193
    v_add_f32 v194, 1.0, v194
    v_mfma_f32_16x16x32_bf16 v[88:91], v[184:187], a[72:75], v[88:91]
    v_add_f32 v195, 1.0, v195
    v_mfma_f32_16x16x32_bf16 v[88:91], v[188:191], a[88:91], v[88:91]
    v_rcp_f32 v192, v192
    v_rcp_f32 v193, v193
    v_mfma_f32_16x16x32_bf16 v[92:95], v[184:187], a[76:79], v[92:95]
    v_rcp_f32 v194, v194
    v_mfma_f32_16x16x32_bf16 v[92:95], v[188:191], a[92:95], v[92:95]
    v_rcp_f32 v195, v195
    s_waitcnt lgkmcnt(0) vmcnt(19)
    s_barrier
    v_mfma_f32_16x16x32_bf16 v[80:83], v[144:147], a[96:99], v[80:83]
    s_add_u32 m0, s46, 49152
    s_add_u32 s44, s47, 512
    buffer_load_dwordx4 v8, s[16:19], s44 offen offset:0 lds
    v_mul_f32 v48, v192, v48
    v_mfma_f32_16x16x32_bf16 v[80:83], v[148:151], a[112:115], v[80:83]
    ds_read_b64_tr_b16 v[168:169], v14 offset:0
    v_mfma_f32_16x16x32_bf16 v[84:87], v[144:147], a[100:103], v[84:87]
    ds_read_b64_tr_b16 v[170:171], v14 offset:2048
    v_mul_f32 v49, v193, v49
    v_mfma_f32_16x16x32_bf16 v[84:87], v[148:151], a[116:119], v[84:87]
    buffer_load_dwordx4 v9, s[16:19], s44 offen offset:1024 lds
    v_mfma_f32_16x16x32_bf16 v[88:91], v[144:147], a[104:107], v[88:91]
    ds_read_b64_tr_b16 v[172:173], v14 offset:4096
    v_mul_f32 v50, v194, v50
    v_mfma_f32_16x16x32_bf16 v[88:91], v[148:151], a[120:123], v[88:91]
    ds_read_b64_tr_b16 v[174:175], v14 offset:6144
    v_mfma_f32_16x16x32_bf16 v[92:95], v[144:147], a[108:111], v[92:95]
    buffer_load_dwordx4 v10, s[16:19], s44 offen offset:2048 lds
    v_mul_f32 v51, v195, v51
    v_mfma_f32_16x16x32_bf16 v[92:95], v[148:151], a[124:127], v[92:95]
    ds_read_b64_tr_b16 v[176:177], v14 offset:8192
    v_mfma_f32_16x16x32_bf16 v[80:83], v[152:155], a[128:131], v[80:83]
    ds_read_b64_tr_b16 v[178:179], v14 offset:10240
    v_mul_f32 v196, s50, v52
    v_mfma_f32_16x16x32_bf16 v[80:83], v[156:159], a[144:147], v[80:83]
    s_add_u32 m0, s46, 52224
    s_add_u32 s45, s47, 221696
    buffer_load_dwordx4 v8, s[16:19], s45 offen offset:0 lds
    v_mfma_f32_16x16x32_bf16 v[84:87], v[152:155], a[132:135], v[84:87]
    ds_read_b64_tr_b16 v[180:181], v14 offset:12288
    v_mul_f32 v197, s50, v53
    v_mfma_f32_16x16x32_bf16 v[84:87], v[156:159], a[148:151], v[84:87]
    ds_read_b64_tr_b16 v[182:183], v14 offset:14336
    v_mfma_f32_16x16x32_bf16 v[88:91], v[152:155], a[136:139], v[88:91]
    buffer_load_dwordx4 v9, s[16:19], s45 offen offset:1024 lds
    v_mfma_f32_16x16x32_bf16 v[88:91], v[156:159], a[152:155], v[88:91]
    ds_read_b64_tr_b16 v[184:185], v14 offset:16384
    v_mul_f32 v198, s50, v54
    v_mfma_f32_16x16x32_bf16 v[92:95], v[152:155], a[140:143], v[92:95]
    ds_read_b64_tr_b16 v[186:187], v14 offset:18432
    v_mfma_f32_16x16x32_bf16 v[92:95], v[156:159], a[156:159], v[92:95]
    buffer_load_dwordx4 v10, s[16:19], s45 offen offset:2048 lds
    v_mul_f32 v199, s50, v55
    v_mfma_f32_16x16x32_bf16 v[80:83], v[160:163], a[160:163], v[80:83]
    ds_read_b64_tr_b16 v[188:189], v14 offset:20480
    v_mfma_f32_16x16x32_bf16 v[80:83], v[164:167], a[176:179], v[80:83]
    ds_read_b64_tr_b16 v[190:191], v14 offset:22528
    v_exp_f32 v196, v196
    v_mfma_f32_16x16x32_bf16 v[84:87], v[160:163], a[164:167], v[84:87]
    v_exp_f32 v197, v197
    v_mfma_f32_16x16x32_bf16 v[84:87], v[164:167], a[180:183], v[84:87]
    v_exp_f32 v198, v198
    v_exp_f32 v199, v199
    v_mfma_f32_16x16x32_bf16 v[88:91], v[160:163], a[168:171], v[88:91]
    v_add_f32 v196, 1.0, v196
    v_mfma_f32_16x16x32_bf16 v[88:91], v[164:167], a[184:187], v[88:91]
    v_add_f32 v197, 1.0, v197
    v_add_f32 v198, 1.0, v198
    v_mfma_f32_16x16x32_bf16 v[92:95], v[160:163], a[172:175], v[92:95]
    v_add_f32 v199, 1.0, v199
    v_mfma_f32_16x16x32_bf16 v[92:95], v[164:167], a[188:191], v[92:95]
    v_rcp_f32 v196, v196
    s_waitcnt lgkmcnt(0) vmcnt(18)
    s_barrier
    v_mfma_f32_16x16x32_bf16 v[80:83], v[168:171], a[192:195], v[80:83]
    s_add_u32 m0, s46, 0
    s_add_u32 s44, s47, 1769984
    buffer_load_dwordx4 v8, s[16:19], s44 offen offset:0 lds
    v_rcp_f32 v197, v197
    v_mfma_f32_16x16x32_bf16 v[80:83], v[172:175], a[208:211], v[80:83]
    ds_read_b64_tr_b16 v[144:145], v15 offset:24576
    v_mfma_f32_16x16x32_bf16 v[84:87], v[168:171], a[196:199], v[84:87]
    ds_read_b64_tr_b16 v[146:147], v15 offset:26624
    v_rcp_f32 v198, v198
    v_mfma_f32_16x16x32_bf16 v[84:87], v[172:175], a[212:215], v[84:87]
    buffer_load_dwordx4 v9, s[16:19], s44 offen offset:1024 lds
    v_mfma_f32_16x16x32_bf16 v[88:91], v[168:171], a[200:203], v[88:91]
    ds_read_b64_tr_b16 v[148:149], v15 offset:28672
    v_mfma_f32_16x16x32_bf16 v[88:91], v[172:175], a[216:219], v[88:91]
    ds_read_b64_tr_b16 v[150:151], v15 offset:30720
    v_rcp_f32 v199, v199
    v_mfma_f32_16x16x32_bf16 v[92:95], v[168:171], a[204:207], v[92:95]
    buffer_load_dwordx4 v10, s[16:19], s44 offen offset:2048 lds
    v_mfma_f32_16x16x32_bf16 v[92:95], v[172:175], a[220:223], v[92:95]
    ds_read_b64_tr_b16 v[152:153], v15 offset:32768
    v_mfma_f32_16x16x32_bf16 v[80:83], v[176:179], a[224:227], v[80:83]
    ds_read_b64_tr_b16 v[154:155], v15 offset:34816
    v_mul_f32 v52, v196, v52
    v_mfma_f32_16x16x32_bf16 v[80:83], v[180:183], a[240:243], v[80:83]
    s_add_u32 m0, s46, 3072
    s_add_u32 s45, s47, 1991168
    buffer_load_dwordx4 v8, s[16:19], s45 offen offset:0 lds
    v_mfma_f32_16x16x32_bf16 v[84:87], v[176:179], a[228:231], v[84:87]
    ds_read_b64_tr_b16 v[156:157], v15 offset:36864
    v_mul_f32 v53, v197, v53
    v_mfma_f32_16x16x32_bf16 v[84:87], v[180:183], a[244:247], v[84:87]
    ds_read_b64_tr_b16 v[158:159], v15 offset:38912
    v_mfma_f32_16x16x32_bf16 v[88:91], v[176:179], a[232:235], v[88:91]
    buffer_load_dwordx4 v9, s[16:19], s45 offen offset:1024 lds
    v_mfma_f32_16x16x32_bf16 v[88:91], v[180:183], a[248:251], v[88:91]
    ds_read_b64_tr_b16 v[160:161], v15 offset:40960
    v_mul_f32 v54, v198, v54
    v_mfma_f32_16x16x32_bf16 v[92:95], v[176:179], a[236:239], v[92:95]
    ds_read_b64_tr_b16 v[162:163], v15 offset:43008
    v_mfma_f32_16x16x32_bf16 v[92:95], v[180:183], a[252:255], v[92:95]
    buffer_load_dwordx4 v10, s[16:19], s45 offen offset:2048 lds
    v_mfma_f32_16x16x32_bf16 v[80:83], v[184:187], v[224:227], v[80:83]
    ds_read_b64_tr_b16 v[164:165], v15 offset:45056
    v_mul_f32 v55, v199, v55
    v_mfma_f32_16x16x32_bf16 v[80:83], v[188:191], v[240:243], v[80:83]
    ds_read_b64_tr_b16 v[166:167], v15 offset:47104
    v_mfma_f32_16x16x32_bf16 v[84:87], v[184:187], v[228:231], v[84:87]
    v_mul_f32 v200, s50, v56
    v_mul_f32 v201, s50, v57
    v_mfma_f32_16x16x32_bf16 v[84:87], v[188:191], v[244:247], v[84:87]
    v_mul_f32 v202, s50, v58
    v_mfma_f32_16x16x32_bf16 v[88:91], v[184:187], v[232:235], v[88:91]
    v_mul_f32 v203, s50, v59
    v_mfma_f32_16x16x32_bf16 v[88:91], v[188:191], v[248:251], v[88:91]
    v_exp_f32 v200, v200
    v_exp_f32 v201, v201
    v_mfma_f32_16x16x32_bf16 v[92:95], v[184:187], v[236:239], v[92:95]
    v_exp_f32 v202, v202
    v_mfma_f32_16x16x32_bf16 v[92:95], v[188:191], v[252:255], v[92:95]
    v_exp_f32 v203, v203
    s_waitcnt lgkmcnt(0) vmcnt(18)
    s_barrier
    v_mfma_f32_16x16x32_bf16 v[32:35], v[144:147], a[0:3], 0
    s_add_u32 m0, s46, 73728
    s_add_u32 s44, s47, 3539456
    buffer_load_dwordx4 v8, s[16:19], s44 offen offset:0 lds
    v_add_f32 v200, 1.0, v200
    v_mfma_f32_16x16x32_bf16 v[32:35], v[148:151], a[16:19], v[32:35]
    ds_read_b64_tr_b16 v[168:169], v14 offset:24576
    v_mfma_f32_16x16x32_bf16 v[36:39], v[144:147], a[4:7], 0
    ds_read_b64_tr_b16 v[170:171], v14 offset:26624
    v_add_f32 v201, 1.0, v201
    v_mfma_f32_16x16x32_bf16 v[36:39], v[148:151], a[20:23], v[36:39]
    buffer_load_dwordx4 v9, s[16:19], s44 offen offset:1024 lds
    v_mfma_f32_16x16x32_bf16 v[40:43], v[144:147], a[8:11], 0
    ds_read_b64_tr_b16 v[172:173], v14 offset:28672
    v_add_f32 v202, 1.0, v202
    v_mfma_f32_16x16x32_bf16 v[40:43], v[148:151], a[24:27], v[40:43]
    ds_read_b64_tr_b16 v[174:175], v14 offset:30720
    v_mfma_f32_16x16x32_bf16 v[44:47], v[144:147], a[12:15], 0
    buffer_load_dwordx4 v10, s[16:19], s44 offen offset:2048 lds
    v_add_f32 v203, 1.0, v203
    v_mfma_f32_16x16x32_bf16 v[44:47], v[148:151], a[28:31], v[44:47]
    ds_read_b64_tr_b16 v[176:177], v14 offset:32768
    v_mfma_f32_16x16x32_bf16 v[32:35], v[152:155], a[32:35], v[32:35]
    ds_read_b64_tr_b16 v[178:179], v14 offset:34816
    v_rcp_f32 v200, v200
    v_mfma_f32_16x16x32_bf16 v[32:35], v[156:159], a[48:51], v[32:35]
    s_add_u32 m0, s46, 76800
    s_add_u32 s45, s47, 3760640
    buffer_load_dwordx4 v8, s[16:19], s45 offen offset:0 lds
    v_mfma_f32_16x16x32_bf16 v[36:39], v[152:155], a[36:39], v[36:39]
    ds_read_b64_tr_b16 v[180:181], v14 offset:36864
    v_rcp_f32 v201, v201
    v_mfma_f32_16x16x32_bf16 v[36:39], v[156:159], a[52:55], v[36:39]
    ds_read_b64_tr_b16 v[182:183], v14 offset:38912
    v_mfma_f32_16x16x32_bf16 v[40:43], v[152:155], a[40:43], v[40:43]
    buffer_load_dwordx4 v9, s[16:19], s45 offen offset:1024 lds
    v_rcp_f32 v202, v202
    v_mfma_f32_16x16x32_bf16 v[40:43], v[156:159], a[56:59], v[40:43]
    ds_read_b64_tr_b16 v[184:185], v14 offset:40960
    v_mfma_f32_16x16x32_bf16 v[44:47], v[152:155], a[44:47], v[44:47]
    ds_read_b64_tr_b16 v[186:187], v14 offset:43008
    v_rcp_f32 v203, v203
    v_mfma_f32_16x16x32_bf16 v[44:47], v[156:159], a[60:63], v[44:47]
    buffer_load_dwordx4 v10, s[16:19], s45 offen offset:2048 lds
    v_mfma_f32_16x16x32_bf16 v[32:35], v[160:163], a[64:67], v[32:35]
    ds_read_b64_tr_b16 v[188:189], v14 offset:45056
    v_mul_f32 v56, v200, v56
    v_mfma_f32_16x16x32_bf16 v[32:35], v[164:167], a[80:83], v[32:35]
    ds_read_b64_tr_b16 v[190:191], v14 offset:47104
    v_mfma_f32_16x16x32_bf16 v[36:39], v[160:163], a[68:71], v[36:39]
    v_mul_f32 v57, v201, v57
    v_mul_f32 v58, v202, v58
    v_mfma_f32_16x16x32_bf16 v[36:39], v[164:167], a[84:87], v[36:39]
    v_mul_f32 v59, v203, v59
    v_mfma_f32_16x16x32_bf16 v[40:43], v[160:163], a[72:75], v[40:43]
    v_mul_f32 v192, s50, v60
    v_mul_f32 v193, s50, v61
    v_mfma_f32_16x16x32_bf16 v[40:43], v[164:167], a[88:91], v[40:43]
    v_mul_f32 v194, s50, v62
    v_mfma_f32_16x16x32_bf16 v[44:47], v[160:163], a[76:79], v[44:47]
    v_mul_f32 v195, s50, v63
    v_exp_f32 v192, v192
    v_mfma_f32_16x16x32_bf16 v[44:47], v[164:167], a[92:95], v[44:47]
    v_exp_f32 v193, v193
    s_waitcnt lgkmcnt(0) vmcnt(18)
    s_barrier
    v_mfma_f32_16x16x32_bf16 v[32:35], v[168:171], a[96:99], v[32:35]
    s_add_u32 m0, s46, 24576
    s_add_u32 s44, s47, 640
    buffer_load_dwordx4 v8, s[12:15], s44 offen offset:0 lds
    v_exp_f32 v194, v194
    v_mfma_f32_16x16x32_bf16 v[32:35], v[172:175], a[112:115], v[32:35]
    ds_read_b64_tr_b16 v[144:145], v16 offset:0
    v_mfma_f32_16x16x32_bf16 v[36:39], v[168:171], a[100:103], v[36:39]
    ds_read_b64_tr_b16 v[146:147], v16 offset:2048
    v_exp_f32 v195, v195
    v_mfma_f32_16x16x32_bf16 v[36:39], v[172:175], a[116:119], v[36:39]
    buffer_load_dwordx4 v9, s[12:15], s44 offen offset:1024 lds
    v_mfma_f32_16x16x32_bf16 v[40:43], v[168:171], a[104:107], v[40:43]
    ds_read_b64_tr_b16 v[148:149], v16 offset:4096
    v_add_f32 v192, 1.0, v192
    v_mfma_f32_16x16x32_bf16 v[40:43], v[172:175], a[120:123], v[40:43]
    ds_read_b64_tr_b16 v[150:151], v16 offset:6144
    v_mfma_f32_16x16x32_bf16 v[44:47], v[168:171], a[108:111], v[44:47]
    buffer_load_dwordx4 v10, s[12:15], s44 offen offset:2048 lds
    v_mfma_f32_16x16x32_bf16 v[44:47], v[172:175], a[124:127], v[44:47]
    ds_read_b64_tr_b16 v[152:153], v16 offset:8192
    v_add_f32 v193, 1.0, v193
    v_mfma_f32_16x16x32_bf16 v[32:35], v[176:179], a[128:131], v[32:35]
    ds_read_b64_tr_b16 v[154:155], v16 offset:10240
    v_mfma_f32_16x16x32_bf16 v[32:35], v[180:183], a[144:147], v[32:35]
    s_add_u32 m0, s46, 27648
    s_add_u32 s45, s47, 221824
    buffer_load_dwordx4 v8, s[12:15], s45 offen offset:0 lds
    v_add_f32 v194, 1.0, v194
    v_mfma_f32_16x16x32_bf16 v[36:39], v[176:179], a[132:135], v[36:39]
    ds_read_b64_tr_b16 v[156:157], v16 offset:12288
    v_mfma_f32_16x16x32_bf16 v[36:39], v[180:183], a[148:151], v[36:39]
    ds_read_b64_tr_b16 v[158:159], v16 offset:14336
    v_mfma_f32_16x16x32_bf16 v[40:43], v[176:179], a[136:139], v[40:43]
    buffer_load_dwordx4 v9, s[12:15], s45 offen offset:1024 lds
    v_add_f32 v195, 1.0, v195
    v_mfma_f32_16x16x32_bf16 v[40:43], v[180:183], a[152:155], v[40:43]
    ds_read_b64_tr_b16 v[160:161], v16 offset:16384
    v_mfma_f32_16x16x32_bf16 v[44:47], v[176:179], a[140:143], v[44:47]
    ds_read_b64_tr_b16 v[162:163], v16 offset:18432
    v_rcp_f32 v192, v192
    v_mfma_f32_16x16x32_bf16 v[44:47], v[180:183], a[156:159], v[44:47]
    buffer_load_dwordx4 v10, s[12:15], s45 offen offset:2048 lds
    v_mfma_f32_16x16x32_bf16 v[32:35], v[184:187], a[160:163], v[32:35]
    ds_read_b64_tr_b16 v[164:165], v16 offset:20480
    v_rcp_f32 v193, v193
    v_mfma_f32_16x16x32_bf16 v[32:35], v[188:191], a[176:179], v[32:35]
    ds_read_b64_tr_b16 v[166:167], v16 offset:22528
    v_mfma_f32_16x16x32_bf16 v[36:39], v[184:187], a[164:167], v[36:39]
    v_rcp_f32 v194, v194
    v_mfma_f32_16x16x32_bf16 v[36:39], v[188:191], a[180:183], v[36:39]
    v_rcp_f32 v195, v195
    v_mul_f32 v60, v192, v60
    v_mfma_f32_16x16x32_bf16 v[40:43], v[184:187], a[168:171], v[40:43]
    v_mul_f32 v61, v193, v61
    v_mfma_f32_16x16x32_bf16 v[40:43], v[188:191], a[184:187], v[40:43]
    v_mul_f32 v62, v194, v62
    v_mul_f32 v63, v195, v63
    v_mfma_f32_16x16x32_bf16 v[44:47], v[184:187], a[172:175], v[44:47]
    v_mul_f32 v48, v48, v80
    v_mfma_f32_16x16x32_bf16 v[44:47], v[188:191], a[188:191], v[44:47]
    v_mul_f32 v49, v49, v81
    s_waitcnt lgkmcnt(0) vmcnt(18)
    s_barrier
    v_mfma_f32_16x16x32_bf16 v[32:35], v[144:147], a[192:195], v[32:35]
    s_add_u32 m0, s46, 98304
    s_add_u32 s44, s47, 1770112
    buffer_load_dwordx4 v8, s[12:15], s44 offen offset:0 lds
    v_mul_f32 v50, v50, v82
    v_mfma_f32_16x16x32_bf16 v[32:35], v[148:151], a[208:211], v[32:35]
    ds_read_b64_tr_b16 v[168:169], v15 offset:0
    v_mul_f32 v51, v51, v83
    v_mfma_f32_16x16x32_bf16 v[36:39], v[144:147], a[196:199], v[36:39]
    ds_read_b64_tr_b16 v[170:171], v15 offset:2048
    v_mfma_f32_16x16x32_bf16 v[36:39], v[148:151], a[212:215], v[36:39]
    buffer_load_dwordx4 v9, s[12:15], s44 offen offset:1024 lds
    v_cvt_pk_bf16_f32 v120, v48, v49
    v_mfma_f32_16x16x32_bf16 v[40:43], v[144:147], a[200:203], v[40:43]
    ds_read_b64_tr_b16 v[172:173], v15 offset:4096
    v_cvt_pk_bf16_f32 v121, v50, v51
    v_mfma_f32_16x16x32_bf16 v[40:43], v[148:151], a[216:219], v[40:43]
    ds_read_b64_tr_b16 v[174:175], v15 offset:6144
    v_mfma_f32_16x16x32_bf16 v[44:47], v[144:147], a[204:207], v[44:47]
    buffer_load_dwordx4 v10, s[12:15], s44 offen offset:2048 lds
    v_mul_f32 v52, v52, v84
    v_mfma_f32_16x16x32_bf16 v[44:47], v[148:151], a[220:223], v[44:47]
    ds_read_b64_tr_b16 v[176:177], v15 offset:8192
    v_mul_f32 v53, v53, v85
    v_mfma_f32_16x16x32_bf16 v[32:35], v[152:155], a[224:227], v[32:35]
    ds_read_b64_tr_b16 v[178:179], v15 offset:10240
    v_mfma_f32_16x16x32_bf16 v[32:35], v[156:159], a[240:243], v[32:35]
    s_add_u32 m0, s46, 101376
    s_add_u32 s45, s47, 1991296
    buffer_load_dwordx4 v8, s[12:15], s45 offen offset:0 lds
    v_mul_f32 v54, v54, v86
    v_mfma_f32_16x16x32_bf16 v[36:39], v[152:155], a[228:231], v[36:39]
    ds_read_b64_tr_b16 v[180:181], v15 offset:12288
    v_mul_f32 v55, v55, v87
    v_mfma_f32_16x16x32_bf16 v[36:39], v[156:159], a[244:247], v[36:39]
    ds_read_b64_tr_b16 v[182:183], v15 offset:14336
    v_mfma_f32_16x16x32_bf16 v[40:43], v[152:155], a[232:235], v[40:43]
    buffer_load_dwordx4 v9, s[12:15], s45 offen offset:1024 lds
    v_cvt_pk_bf16_f32 v122, v52, v53
    v_mfma_f32_16x16x32_bf16 v[40:43], v[156:159], a[248:251], v[40:43]
    ds_read_b64_tr_b16 v[184:185], v15 offset:16384
    v_cvt_pk_bf16_f32 v123, v54, v55
    v_mfma_f32_16x16x32_bf16 v[44:47], v[152:155], a[236:239], v[44:47]
    ds_read_b64_tr_b16 v[186:187], v15 offset:18432
    v_mfma_f32_16x16x32_bf16 v[44:47], v[156:159], a[252:255], v[44:47]
    buffer_load_dwordx4 v10, s[12:15], s45 offen offset:2048 lds
    v_mul_f32 v56, v56, v88
    v_mfma_f32_16x16x32_bf16 v[32:35], v[160:163], v[224:227], v[32:35]
    ds_read_b64_tr_b16 v[188:189], v15 offset:20480
    v_mul_f32 v57, v57, v89
    v_mfma_f32_16x16x32_bf16 v[32:35], v[164:167], v[240:243], v[32:35]
    ds_read_b64_tr_b16 v[190:191], v15 offset:22528
    v_mfma_f32_16x16x32_bf16 v[36:39], v[160:163], v[228:231], v[36:39]
    v_mul_f32 v58, v58, v90
    v_mul_f32 v59, v59, v91
    v_mfma_f32_16x16x32_bf16 v[36:39], v[164:167], v[244:247], v[36:39]
    v_cvt_pk_bf16_f32 v124, v56, v57
    v_cvt_pk_bf16_f32 v125, v58, v59
    v_mfma_f32_16x16x32_bf16 v[40:43], v[160:163], v[232:235], v[40:43]
    v_mul_f32 v60, v60, v92
    v_mfma_f32_16x16x32_bf16 v[40:43], v[164:167], v[248:251], v[40:43]
    v_mul_f32 v61, v61, v93
    v_mul_f32 v62, v62, v94
    v_mfma_f32_16x16x32_bf16 v[44:47], v[160:163], v[236:239], v[44:47]
    v_mul_f32 v63, v63, v95
    v_cvt_pk_bf16_f32 v126, v60, v61
    v_mfma_f32_16x16x32_bf16 v[44:47], v[164:167], v[252:255], v[44:47]
    v_cvt_pk_bf16_f32 v127, v62, v63
    s_waitcnt lgkmcnt(0) vmcnt(18)
    s_barrier
    v_mfma_f32_16x16x32_bf16 v[64:67], v[168:171], a[0:3], 0
    s_add_u32 m0, s46, 49152
    s_add_u32 s44, s47, 3539584
    buffer_load_dwordx4 v8, s[12:15], s44 offen offset:0 lds
    ds_read_b64_tr_b16 v[144:145], v14 offset:0
    v_mfma_f32_16x16x32_bf16 v[64:67], v[172:175], a[16:19], v[64:67]
    ds_read_b64_tr_b16 v[146:147], v14 offset:2048
    v_mfma_f32_16x16x32_bf16 v[68:71], v[168:171], a[4:7], 0
    buffer_load_dwordx4 v9, s[12:15], s44 offen offset:1024 lds
    v_mul_f32 v192, s50, v32
    v_mfma_f32_16x16x32_bf16 v[68:71], v[172:175], a[20:23], v[68:71]
    ds_read_b64_tr_b16 v[148:149], v14 offset:4096
    v_mfma_f32_16x16x32_bf16 v[72:75], v[168:171], a[8:11], 0
    ds_read_b64_tr_b16 v[150:151], v14 offset:6144
    v_mul_f32 v193, s50, v33
    v_mfma_f32_16x16x32_bf16 v[72:75], v[172:175], a[24:27], v[72:75]
    buffer_load_dwordx4 v10, s[12:15], s44 offen offset:2048 lds
    v_mfma_f32_16x16x32_bf16 v[76:79], v[168:171], a[12:15], 0
    ds_read_b64_tr_b16 v[152:153], v14 offset:8192
    v_mul_f32 v194, s50, v34
    v_mfma_f32_16x16x32_bf16 v[76:79], v[172:175], a[28:31], v[76:79]
    ds_read_b64_tr_b16 v[154:155], v14 offset:10240
    v_mfma_f32_16x16x32_bf16 v[64:67], v[176:179], a[32:35], v[64:67]
    s_add_u32 m0, s46, 52224
    s_add_u32 s45, s47, 3760768
    buffer_load_dwordx4 v8, s[12:15], s45 offen offset:0 lds
    v_mul_f32 v195, s50, v35
    v_mfma_f32_16x16x32_bf16 v[64:67], v[180:183], a[48:51], v[64:67]
    ds_read_b64_tr_b16 v[156:157], v14 offset:12288
    v_mfma_f32_16x16x32_bf16 v[68:71], v[176:179], a[36:39], v[68:71]
    ds_read_b64_tr_b16 v[158:159], v14 offset:14336
    v_exp_f32 v192, v192
    v_mfma_f32_16x16x32_bf16 v[68:71], v[180:183], a[52:55], v[68:71]
    buffer_load_dwordx4 v9, s[12:15], s45 offen offset:1024 lds
    v_mfma_f32_16x16x32_bf16 v[72:75], v[176:179], a[40:43], v[72:75]
    ds_read_b64_tr_b16 v[160:161], v14 offset:16384
    v_mfma_f32_16x16x32_bf16 v[72:75], v[180:183], a[56:59], v[72:75]
    ds_read_b64_tr_b16 v[162:163], v14 offset:18432
    v_exp_f32 v193, v193
    v_mfma_f32_16x16x32_bf16 v[76:79], v[176:179], a[44:47], v[76:79]
    buffer_load_dwordx4 v10, s[12:15], s45 offen offset:2048 lds
    v_mfma_f32_16x16x32_bf16 v[76:79], v[180:183], a[60:63], v[76:79]
    ds_read_b64_tr_b16 v[164:165], v14 offset:20480
    v_exp_f32 v194, v194
    v_mfma_f32_16x16x32_bf16 v[64:67], v[184:187], a[64:67], v[64:67]
    ds_read_b64_tr_b16 v[166:167], v14 offset:22528
    v_mfma_f32_16x16x32_bf16 v[64:67], v[188:191], a[80:83], v[64:67]
    buffer_load_dword v6, v4, s[16:19], s47 offen offset:768
    v_exp_f32 v195, v195
    v_mfma_f32_16x16x32_bf16 v[68:71], v[184:187], a[68:71], v[68:71]
    v_add_f32 v192, 1.0, v192
    v_mfma_f32_16x16x32_bf16 v[68:71], v[188:191], a[84:87], v[68:71]
    v_add_f32 v193, 1.0, v193
    v_add_f32 v194, 1.0, v194
    v_mfma_f32_16x16x32_bf16 v[72:75], v[184:187], a[72:75], v[72:75]
    v_add_f32 v195, 1.0, v195
    v_mfma_f32_16x16x32_bf16 v[72:75], v[188:191], a[88:91], v[72:75]
    v_rcp_f32 v192, v192
    v_rcp_f32 v193, v193
    v_mfma_f32_16x16x32_bf16 v[76:79], v[184:187], a[76:79], v[76:79]
    v_rcp_f32 v194, v194
    v_mfma_f32_16x16x32_bf16 v[76:79], v[188:191], a[92:95], v[76:79]
    v_rcp_f32 v195, v195
    s_waitcnt lgkmcnt(0) vmcnt(19)
    s_barrier
    v_mfma_f32_16x16x32_bf16 v[64:67], v[144:147], a[96:99], v[64:67]
    s_add_u32 m0, s46, 0
    s_add_u32 s44, s47, 640
    buffer_load_dwordx4 v8, s[16:19], s44 offen offset:0 lds
    v_mul_f32 v32, v192, v32
    v_mfma_f32_16x16x32_bf16 v[64:67], v[148:151], a[112:115], v[64:67]
    ds_read_b64_tr_b16 v[168:169], v15 offset:24576
    v_mfma_f32_16x16x32_bf16 v[68:71], v[144:147], a[100:103], v[68:71]
    ds_read_b64_tr_b16 v[170:171], v15 offset:26624
    v_mul_f32 v33, v193, v33
    v_mfma_f32_16x16x32_bf16 v[68:71], v[148:151], a[116:119], v[68:71]
    buffer_load_dwordx4 v9, s[16:19], s44 offen offset:1024 lds
    v_mfma_f32_16x16x32_bf16 v[72:75], v[144:147], a[104:107], v[72:75]
    ds_read_b64_tr_b16 v[172:173], v15 offset:28672
    v_mul_f32 v34, v194, v34
    v_mfma_f32_16x16x32_bf16 v[72:75], v[148:151], a[120:123], v[72:75]
    ds_read_b64_tr_b16 v[174:175], v15 offset:30720
    v_mfma_f32_16x16x32_bf16 v[76:79], v[144:147], a[108:111], v[76:79]
    buffer_load_dwordx4 v10, s[16:19], s44 offen offset:2048 lds
    v_mul_f32 v35, v195, v35
    v_mfma_f32_16x16x32_bf16 v[76:79], v[148:151], a[124:127], v[76:79]
    ds_read_b64_tr_b16 v[176:177], v15 offset:32768
    v_mfma_f32_16x16x32_bf16 v[64:67], v[152:155], a[128:131], v[64:67]
    ds_read_b64_tr_b16 v[178:179], v15 offset:34816
    v_mul_f32 v196, s50, v36
    v_mfma_f32_16x16x32_bf16 v[64:67], v[156:159], a[144:147], v[64:67]
    s_add_u32 m0, s46, 3072
    s_add_u32 s45, s47, 221824
    buffer_load_dwordx4 v8, s[16:19], s45 offen offset:0 lds
    v_mfma_f32_16x16x32_bf16 v[68:71], v[152:155], a[132:135], v[68:71]
    ds_read_b64_tr_b16 v[180:181], v15 offset:36864
    v_mul_f32 v197, s50, v37
    v_mfma_f32_16x16x32_bf16 v[68:71], v[156:159], a[148:151], v[68:71]
    ds_read_b64_tr_b16 v[182:183], v15 offset:38912
    v_mfma_f32_16x16x32_bf16 v[72:75], v[152:155], a[136:139], v[72:75]
    buffer_load_dwordx4 v9, s[16:19], s45 offen offset:1024 lds
    v_mfma_f32_16x16x32_bf16 v[72:75], v[156:159], a[152:155], v[72:75]
    ds_read_b64_tr_b16 v[184:185], v15 offset:40960
    v_mul_f32 v198, s50, v38
    v_mfma_f32_16x16x32_bf16 v[76:79], v[152:155], a[140:143], v[76:79]
    ds_read_b64_tr_b16 v[186:187], v15 offset:43008
    v_mfma_f32_16x16x32_bf16 v[76:79], v[156:159], a[156:159], v[76:79]
    buffer_load_dwordx4 v10, s[16:19], s45 offen offset:2048 lds
    v_mul_f32 v199, s50, v39
    v_mfma_f32_16x16x32_bf16 v[64:67], v[160:163], a[160:163], v[64:67]
    ds_read_b64_tr_b16 v[188:189], v15 offset:45056
    v_mfma_f32_16x16x32_bf16 v[64:67], v[164:167], a[176:179], v[64:67]
    ds_read_b64_tr_b16 v[190:191], v15 offset:47104
    v_exp_f32 v196, v196
    v_mfma_f32_16x16x32_bf16 v[68:71], v[160:163], a[164:167], v[68:71]
    v_exp_f32 v197, v197
    v_mfma_f32_16x16x32_bf16 v[68:71], v[164:167], a[180:183], v[68:71]
    v_exp_f32 v198, v198
    v_exp_f32 v199, v199
    v_mfma_f32_16x16x32_bf16 v[72:75], v[160:163], a[168:171], v[72:75]
    v_add_f32 v196, 1.0, v196
    v_mfma_f32_16x16x32_bf16 v[72:75], v[164:167], a[184:187], v[72:75]
    v_add_f32 v197, 1.0, v197
    v_add_f32 v198, 1.0, v198
    v_mfma_f32_16x16x32_bf16 v[76:79], v[160:163], a[172:175], v[76:79]
    v_add_f32 v199, 1.0, v199
    v_mfma_f32_16x16x32_bf16 v[76:79], v[164:167], a[188:191], v[76:79]
    v_rcp_f32 v196, v196
    s_waitcnt lgkmcnt(0) vmcnt(19)
    s_barrier
    v_mfma_f32_16x16x32_bf16 v[64:67], v[168:171], a[192:195], v[64:67]
    s_add_u32 m0, s46, 73728
    s_add_u32 s44, s47, 1770112
    buffer_load_dwordx4 v8, s[16:19], s44 offen offset:0 lds
    v_rcp_f32 v197, v197
    v_mfma_f32_16x16x32_bf16 v[64:67], v[172:175], a[208:211], v[64:67]
    ds_read_b64_tr_b16 v[144:145], v14 offset:24576
    v_mfma_f32_16x16x32_bf16 v[68:71], v[168:171], a[196:199], v[68:71]
    ds_read_b64_tr_b16 v[146:147], v14 offset:26624
    v_rcp_f32 v198, v198
    v_mfma_f32_16x16x32_bf16 v[68:71], v[172:175], a[212:215], v[68:71]
    buffer_load_dwordx4 v9, s[16:19], s44 offen offset:1024 lds
    v_mfma_f32_16x16x32_bf16 v[72:75], v[168:171], a[200:203], v[72:75]
    ds_read_b64_tr_b16 v[148:149], v14 offset:28672
    v_mfma_f32_16x16x32_bf16 v[72:75], v[172:175], a[216:219], v[72:75]
    ds_read_b64_tr_b16 v[150:151], v14 offset:30720
    v_rcp_f32 v199, v199
    v_mfma_f32_16x16x32_bf16 v[76:79], v[168:171], a[204:207], v[76:79]
    buffer_load_dwordx4 v10, s[16:19], s44 offen offset:2048 lds
    v_mfma_f32_16x16x32_bf16 v[76:79], v[172:175], a[220:223], v[76:79]
    ds_read_b64_tr_b16 v[152:153], v14 offset:32768
    v_mfma_f32_16x16x32_bf16 v[64:67], v[176:179], a[224:227], v[64:67]
    ds_read_b64_tr_b16 v[154:155], v14 offset:34816
    v_mul_f32 v36, v196, v36
    v_mfma_f32_16x16x32_bf16 v[64:67], v[180:183], a[240:243], v[64:67]
    s_add_u32 m0, s46, 76800
    s_add_u32 s45, s47, 1991296
    buffer_load_dwordx4 v8, s[16:19], s45 offen offset:0 lds
    v_mfma_f32_16x16x32_bf16 v[68:71], v[176:179], a[228:231], v[68:71]
    ds_read_b64_tr_b16 v[156:157], v14 offset:36864
    v_mul_f32 v37, v197, v37
    v_mfma_f32_16x16x32_bf16 v[68:71], v[180:183], a[244:247], v[68:71]
    ds_read_b64_tr_b16 v[158:159], v14 offset:38912
    v_mfma_f32_16x16x32_bf16 v[72:75], v[176:179], a[232:235], v[72:75]
    buffer_load_dwordx4 v9, s[16:19], s45 offen offset:1024 lds
    v_mfma_f32_16x16x32_bf16 v[72:75], v[180:183], a[248:251], v[72:75]
    ds_read_b64_tr_b16 v[160:161], v14 offset:40960
    v_mul_f32 v38, v198, v38
    v_mfma_f32_16x16x32_bf16 v[76:79], v[176:179], a[236:239], v[76:79]
    ds_read_b64_tr_b16 v[162:163], v14 offset:43008
    v_mfma_f32_16x16x32_bf16 v[76:79], v[180:183], a[252:255], v[76:79]
    buffer_load_dwordx4 v10, s[16:19], s45 offen offset:2048 lds
    v_mfma_f32_16x16x32_bf16 v[64:67], v[184:187], v[224:227], v[64:67]
    ds_read_b64_tr_b16 v[164:165], v14 offset:45056
    v_mul_f32 v39, v199, v39
    v_mfma_f32_16x16x32_bf16 v[64:67], v[188:191], v[240:243], v[64:67]
    ds_read_b64_tr_b16 v[166:167], v14 offset:47104
    v_mfma_f32_16x16x32_bf16 v[68:71], v[184:187], v[228:231], v[68:71]
    v_mul_f32 v200, s50, v40
    v_mul_f32 v201, s50, v41
    v_mfma_f32_16x16x32_bf16 v[68:71], v[188:191], v[244:247], v[68:71]
    v_mul_f32 v202, s50, v42
    v_mfma_f32_16x16x32_bf16 v[72:75], v[184:187], v[232:235], v[72:75]
    v_mul_f32 v203, s50, v43
    v_mfma_f32_16x16x32_bf16 v[72:75], v[188:191], v[248:251], v[72:75]
    v_exp_f32 v200, v200
    v_exp_f32 v201, v201
    v_mfma_f32_16x16x32_bf16 v[76:79], v[184:187], v[236:239], v[76:79]
    v_exp_f32 v202, v202
    v_mfma_f32_16x16x32_bf16 v[76:79], v[188:191], v[252:255], v[76:79]
    v_exp_f32 v203, v203
    s_waitcnt lgkmcnt(0) vmcnt(19)
    s_barrier
    v_mfma_f32_16x16x32_bf16 v[48:51], v[144:147], a[0:3], 0
    s_add_u32 m0, s46, 24576
    s_add_u32 s44, s47, 3539584
    buffer_load_dwordx4 v8, s[16:19], s44 offen offset:0 lds
    v_add_f32 v200, 1.0, v200
    v_mfma_f32_16x16x32_bf16 v[48:51], v[148:151], a[16:19], v[48:51]
    ds_read_b64_tr_b16 v[168:169], v16 offset:0
    v_mfma_f32_16x16x32_bf16 v[52:55], v[144:147], a[4:7], 0
    ds_read_b64_tr_b16 v[170:171], v16 offset:2048
    v_add_f32 v201, 1.0, v201
    v_mfma_f32_16x16x32_bf16 v[52:55], v[148:151], a[20:23], v[52:55]
    buffer_load_dwordx4 v9, s[16:19], s44 offen offset:1024 lds
    v_mfma_f32_16x16x32_bf16 v[56:59], v[144:147], a[8:11], 0
    ds_read_b64_tr_b16 v[172:173], v16 offset:4096
    v_add_f32 v202, 1.0, v202
    v_mfma_f32_16x16x32_bf16 v[56:59], v[148:151], a[24:27], v[56:59]
    ds_read_b64_tr_b16 v[174:175], v16 offset:6144
    v_mfma_f32_16x16x32_bf16 v[60:63], v[144:147], a[12:15], 0
    buffer_load_dwordx4 v10, s[16:19], s44 offen offset:2048 lds
    v_add_f32 v203, 1.0, v203
    v_mfma_f32_16x16x32_bf16 v[60:63], v[148:151], a[28:31], v[60:63]
    ds_read_b64_tr_b16 v[176:177], v16 offset:8192
    v_mfma_f32_16x16x32_bf16 v[48:51], v[152:155], a[32:35], v[48:51]
    ds_read_b64_tr_b16 v[178:179], v16 offset:10240
    v_rcp_f32 v200, v200
    v_mfma_f32_16x16x32_bf16 v[48:51], v[156:159], a[48:51], v[48:51]
    s_add_u32 m0, s46, 27648
    s_add_u32 s45, s47, 3760768
    buffer_load_dwordx4 v8, s[16:19], s45 offen offset:0 lds
    v_mfma_f32_16x16x32_bf16 v[52:55], v[152:155], a[36:39], v[52:55]
    ds_read_b64_tr_b16 v[180:181], v16 offset:12288
    v_rcp_f32 v201, v201
    v_mfma_f32_16x16x32_bf16 v[52:55], v[156:159], a[52:55], v[52:55]
    ds_read_b64_tr_b16 v[182:183], v16 offset:14336
    v_mfma_f32_16x16x32_bf16 v[56:59], v[152:155], a[40:43], v[56:59]
    buffer_load_dwordx4 v9, s[16:19], s45 offen offset:1024 lds
    v_rcp_f32 v202, v202
    v_mfma_f32_16x16x32_bf16 v[56:59], v[156:159], a[56:59], v[56:59]
    ds_read_b64_tr_b16 v[184:185], v16 offset:16384
    v_mfma_f32_16x16x32_bf16 v[60:63], v[152:155], a[44:47], v[60:63]
    ds_read_b64_tr_b16 v[186:187], v16 offset:18432
    v_rcp_f32 v203, v203
    v_mfma_f32_16x16x32_bf16 v[60:63], v[156:159], a[60:63], v[60:63]
    buffer_load_dwordx4 v10, s[16:19], s45 offen offset:2048 lds
    v_mfma_f32_16x16x32_bf16 v[48:51], v[160:163], a[64:67], v[48:51]
    ds_read_b64_tr_b16 v[188:189], v16 offset:20480
    v_mul_f32 v40, v200, v40
    v_mfma_f32_16x16x32_bf16 v[48:51], v[164:167], a[80:83], v[48:51]
    ds_read_b64_tr_b16 v[190:191], v16 offset:22528
    v_mfma_f32_16x16x32_bf16 v[52:55], v[160:163], a[68:71], v[52:55]
    v_mul_f32 v41, v201, v41
    v_mul_f32 v42, v202, v42
    v_mfma_f32_16x16x32_bf16 v[52:55], v[164:167], a[84:87], v[52:55]
    v_mul_f32 v43, v203, v43
    v_mfma_f32_16x16x32_bf16 v[56:59], v[160:163], a[72:75], v[56:59]
    v_mul_f32 v192, s50, v44
    v_mul_f32 v193, s50, v45
    v_mfma_f32_16x16x32_bf16 v[56:59], v[164:167], a[88:91], v[56:59]
    v_mul_f32 v194, s50, v46
    v_mfma_f32_16x16x32_bf16 v[60:63], v[160:163], a[76:79], v[60:63]
    v_mul_f32 v195, s50, v47
    v_exp_f32 v192, v192
    v_mfma_f32_16x16x32_bf16 v[60:63], v[164:167], a[92:95], v[60:63]
    v_exp_f32 v193, v193
    s_waitcnt lgkmcnt(0) vmcnt(19)
    s_barrier
    v_mfma_f32_16x16x32_bf16 v[48:51], v[168:171], a[96:99], v[48:51]
    s_add_u32 m0, s46, 98304
    s_add_u32 s44, s47, 768
    buffer_load_dwordx4 v8, s[12:15], s44 offen offset:0 lds
    v_exp_f32 v194, v194
    v_mfma_f32_16x16x32_bf16 v[48:51], v[172:175], a[112:115], v[48:51]
    ds_read_b64_tr_b16 v[144:145], v15 offset:0
    v_mfma_f32_16x16x32_bf16 v[52:55], v[168:171], a[100:103], v[52:55]
    ds_read_b64_tr_b16 v[146:147], v15 offset:2048
    v_exp_f32 v195, v195
    v_mfma_f32_16x16x32_bf16 v[52:55], v[172:175], a[116:119], v[52:55]
    buffer_load_dwordx4 v9, s[12:15], s44 offen offset:1024 lds
    v_mfma_f32_16x16x32_bf16 v[56:59], v[168:171], a[104:107], v[56:59]
    ds_read_b64_tr_b16 v[148:149], v15 offset:4096
    v_add_f32 v192, 1.0, v192
    v_mfma_f32_16x16x32_bf16 v[56:59], v[172:175], a[120:123], v[56:59]
    ds_read_b64_tr_b16 v[150:151], v15 offset:6144
    v_mfma_f32_16x16x32_bf16 v[60:63], v[168:171], a[108:111], v[60:63]
    buffer_load_dwordx4 v10, s[12:15], s44 offen offset:2048 lds
    v_mfma_f32_16x16x32_bf16 v[60:63], v[172:175], a[124:127], v[60:63]
    ds_read_b64_tr_b16 v[152:153], v15 offset:8192
    v_add_f32 v193, 1.0, v193
    v_mfma_f32_16x16x32_bf16 v[48:51], v[176:179], a[128:131], v[48:51]
    ds_read_b64_tr_b16 v[154:155], v15 offset:10240
    v_mfma_f32_16x16x32_bf16 v[48:51], v[180:183], a[144:147], v[48:51]
    s_add_u32 m0, s46, 101376
    s_add_u32 s45, s47, 221952
    buffer_load_dwordx4 v8, s[12:15], s45 offen offset:0 lds
    v_add_f32 v194, 1.0, v194
    v_mfma_f32_16x16x32_bf16 v[52:55], v[176:179], a[132:135], v[52:55]
    ds_read_b64_tr_b16 v[156:157], v15 offset:12288
    v_mfma_f32_16x16x32_bf16 v[52:55], v[180:183], a[148:151], v[52:55]
    ds_read_b64_tr_b16 v[158:159], v15 offset:14336
    v_mfma_f32_16x16x32_bf16 v[56:59], v[176:179], a[136:139], v[56:59]
    buffer_load_dwordx4 v9, s[12:15], s45 offen offset:1024 lds
    v_add_f32 v195, 1.0, v195
    v_mfma_f32_16x16x32_bf16 v[56:59], v[180:183], a[152:155], v[56:59]
    ds_read_b64_tr_b16 v[160:161], v15 offset:16384
    v_mfma_f32_16x16x32_bf16 v[60:63], v[176:179], a[140:143], v[60:63]
    ds_read_b64_tr_b16 v[162:163], v15 offset:18432
    v_rcp_f32 v192, v192
    v_mfma_f32_16x16x32_bf16 v[60:63], v[180:183], a[156:159], v[60:63]
    buffer_load_dwordx4 v10, s[12:15], s45 offen offset:2048 lds
    v_mfma_f32_16x16x32_bf16 v[48:51], v[184:187], a[160:163], v[48:51]
    ds_read_b64_tr_b16 v[164:165], v15 offset:20480
    v_rcp_f32 v193, v193
    v_mfma_f32_16x16x32_bf16 v[48:51], v[188:191], a[176:179], v[48:51]
    ds_read_b64_tr_b16 v[166:167], v15 offset:22528
    v_mfma_f32_16x16x32_bf16 v[52:55], v[184:187], a[164:167], v[52:55]
    v_rcp_f32 v194, v194
    v_mfma_f32_16x16x32_bf16 v[52:55], v[188:191], a[180:183], v[52:55]
    v_rcp_f32 v195, v195
    v_mul_f32 v44, v192, v44
    v_mfma_f32_16x16x32_bf16 v[56:59], v[184:187], a[168:171], v[56:59]
    v_mul_f32 v45, v193, v45
    v_mfma_f32_16x16x32_bf16 v[56:59], v[188:191], a[184:187], v[56:59]
    v_mul_f32 v46, v194, v46
    v_mul_f32 v47, v195, v47
    v_mfma_f32_16x16x32_bf16 v[60:63], v[184:187], a[172:175], v[60:63]
    v_mul_f32 v32, v32, v64
    v_mfma_f32_16x16x32_bf16 v[60:63], v[188:191], a[188:191], v[60:63]
    v_mul_f32 v33, v33, v65
    s_waitcnt lgkmcnt(0) vmcnt(18)
    s_barrier
    v_mfma_f32_16x16x32_bf16 v[48:51], v[144:147], a[192:195], v[48:51]
    s_add_u32 m0, s46, 49152
    s_add_u32 s44, s47, 1770240
    buffer_load_dwordx4 v8, s[12:15], s44 offen offset:0 lds
    v_mul_f32 v34, v34, v66
    v_mfma_f32_16x16x32_bf16 v[48:51], v[148:151], a[208:211], v[48:51]
    ds_read_b64_tr_b16 v[168:169], v14 offset:0
    v_mul_f32 v35, v35, v67
    v_mfma_f32_16x16x32_bf16 v[52:55], v[144:147], a[196:199], v[52:55]
    ds_read_b64_tr_b16 v[170:171], v14 offset:2048
    v_mfma_f32_16x16x32_bf16 v[52:55], v[148:151], a[212:215], v[52:55]
    buffer_load_dwordx4 v9, s[12:15], s44 offen offset:1024 lds
    v_cvt_pk_bf16_f32 v128, v32, v33
    v_mfma_f32_16x16x32_bf16 v[56:59], v[144:147], a[200:203], v[56:59]
    ds_read_b64_tr_b16 v[172:173], v14 offset:4096
    v_cvt_pk_bf16_f32 v129, v34, v35
    v_mfma_f32_16x16x32_bf16 v[56:59], v[148:151], a[216:219], v[56:59]
    ds_read_b64_tr_b16 v[174:175], v14 offset:6144
    v_mfma_f32_16x16x32_bf16 v[60:63], v[144:147], a[204:207], v[60:63]
    buffer_load_dwordx4 v10, s[12:15], s44 offen offset:2048 lds
    v_mul_f32 v36, v36, v68
    v_mfma_f32_16x16x32_bf16 v[60:63], v[148:151], a[220:223], v[60:63]
    ds_read_b64_tr_b16 v[176:177], v14 offset:8192
    v_mul_f32 v37, v37, v69
    v_mfma_f32_16x16x32_bf16 v[48:51], v[152:155], a[224:227], v[48:51]
    ds_read_b64_tr_b16 v[178:179], v14 offset:10240
    v_mfma_f32_16x16x32_bf16 v[48:51], v[156:159], a[240:243], v[48:51]
    s_add_u32 m0, s46, 52224
    s_add_u32 s45, s47, 1991424
    buffer_load_dwordx4 v8, s[12:15], s45 offen offset:0 lds
    v_mul_f32 v38, v38, v70
    v_mfma_f32_16x16x32_bf16 v[52:55], v[152:155], a[228:231], v[52:55]
    ds_read_b64_tr_b16 v[180:181], v14 offset:12288
    v_mul_f32 v39, v39, v71
    v_mfma_f32_16x16x32_bf16 v[52:55], v[156:159], a[244:247], v[52:55]
    ds_read_b64_tr_b16 v[182:183], v14 offset:14336
    v_mfma_f32_16x16x32_bf16 v[56:59], v[152:155], a[232:235], v[56:59]
    buffer_load_dwordx4 v9, s[12:15], s45 offen offset:1024 lds
    v_cvt_pk_bf16_f32 v130, v36, v37
    v_mfma_f32_16x16x32_bf16 v[56:59], v[156:159], a[248:251], v[56:59]
    ds_read_b64_tr_b16 v[184:185], v14 offset:16384
    v_cvt_pk_bf16_f32 v131, v38, v39
    v_mfma_f32_16x16x32_bf16 v[60:63], v[152:155], a[236:239], v[60:63]
    ds_read_b64_tr_b16 v[186:187], v14 offset:18432
    v_mfma_f32_16x16x32_bf16 v[60:63], v[156:159], a[252:255], v[60:63]
    buffer_load_dwordx4 v10, s[12:15], s45 offen offset:2048 lds
    v_mul_f32 v40, v40, v72
    v_mfma_f32_16x16x32_bf16 v[48:51], v[160:163], v[224:227], v[48:51]
    ds_read_b64_tr_b16 v[188:189], v14 offset:20480
    v_mul_f32 v41, v41, v73
    v_mfma_f32_16x16x32_bf16 v[48:51], v[164:167], v[240:243], v[48:51]
    ds_read_b64_tr_b16 v[190:191], v14 offset:22528
    v_mfma_f32_16x16x32_bf16 v[52:55], v[160:163], v[228:231], v[52:55]
    v_mul_f32 v42, v42, v74
    v_mul_f32 v43, v43, v75
    v_mfma_f32_16x16x32_bf16 v[52:55], v[164:167], v[244:247], v[52:55]
    v_cvt_pk_bf16_f32 v132, v40, v41
    v_cvt_pk_bf16_f32 v133, v42, v43
    v_mfma_f32_16x16x32_bf16 v[56:59], v[160:163], v[232:235], v[56:59]
    v_mul_f32 v44, v44, v76
    v_mfma_f32_16x16x32_bf16 v[56:59], v[164:167], v[248:251], v[56:59]
    v_mul_f32 v45, v45, v77
    v_mul_f32 v46, v46, v78
    v_mfma_f32_16x16x32_bf16 v[60:63], v[160:163], v[236:239], v[60:63]
    v_mul_f32 v47, v47, v79
    v_cvt_pk_bf16_f32 v134, v44, v45
    v_mfma_f32_16x16x32_bf16 v[60:63], v[164:167], v[252:255], v[60:63]
    v_cvt_pk_bf16_f32 v135, v46, v47
    s_waitcnt lgkmcnt(0) vmcnt(18)
    s_barrier
    v_mfma_f32_16x16x32_bf16 v[80:83], v[168:171], a[0:3], 0
    s_add_u32 m0, s46, 0
    s_add_u32 s44, s47, 3539712
    buffer_load_dwordx4 v8, s[12:15], s44 offen offset:0 lds
    v_mul_f32 v192, s50, v48
    v_mfma_f32_16x16x32_bf16 v[80:83], v[172:175], a[16:19], v[80:83]
    ds_read_b64_tr_b16 v[144:145], v15 offset:24576
    v_mfma_f32_16x16x32_bf16 v[84:87], v[168:171], a[4:7], 0
    ds_read_b64_tr_b16 v[146:147], v15 offset:26624
    v_mul_f32 v193, s50, v49
    v_mfma_f32_16x16x32_bf16 v[84:87], v[172:175], a[20:23], v[84:87]
    buffer_load_dwordx4 v9, s[12:15], s44 offen offset:1024 lds
    v_mfma_f32_16x16x32_bf16 v[88:91], v[168:171], a[8:11], 0
    ds_read_b64_tr_b16 v[148:149], v15 offset:28672
    v_mul_f32 v194, s50, v50
    v_mfma_f32_16x16x32_bf16 v[88:91], v[172:175], a[24:27], v[88:91]
    ds_read_b64_tr_b16 v[150:151], v15 offset:30720
    v_mfma_f32_16x16x32_bf16 v[92:95], v[168:171], a[12:15], 0
    buffer_load_dwordx4 v10, s[12:15], s44 offen offset:2048 lds
    v_mfma_f32_16x16x32_bf16 v[92:95], v[172:175], a[28:31], v[92:95]
    ds_read_b64_tr_b16 v[152:153], v15 offset:32768
    v_mul_f32 v195, s50, v51
    v_mfma_f32_16x16x32_bf16 v[80:83], v[176:179], a[32:35], v[80:83]
    ds_read_b64_tr_b16 v[154:155], v15 offset:34816
    v_mfma_f32_16x16x32_bf16 v[80:83], v[180:183], a[48:51], v[80:83]
    s_add_u32 m0, s46, 3072
    s_add_u32 s45, s47, 3760896
    buffer_load_dwordx4 v8, s[12:15], s45 offen offset:0 lds
    v_exp_f32 v192, v192
    v_mfma_f32_16x16x32_bf16 v[84:87], v[176:179], a[36:39], v[84:87]
    ds_read_b64_tr_b16 v[156:157], v15 offset:36864
    v_mfma_f32_16x16x32_bf16 v[84:87], v[180:183], a[52:55], v[84:87]
    ds_read_b64_tr_b16 v[158:159], v15 offset:38912
    v_mfma_f32_16x16x32_bf16 v[88:91], v[176:179], a[40:43], v[88:91]
    buffer_load_dwordx4 v9, s[12:15], s45 offen offset:1024 lds
    v_exp_f32 v193, v193
    v_mfma_f32_16x16x32_bf16 v[88:91], v[180:183], a[56:59], v[88:91]
    ds_read_b64_tr_b16 v[160:161], v15 offset:40960
    v_mfma_f32_16x16x32_bf16 v[92:95], v[176:179], a[44:47], v[92:95]
    ds_read_b64_tr_b16 v[162:163], v15 offset:43008
    v_exp_f32 v194, v194
    v_mfma_f32_16x16x32_bf16 v[92:95], v[180:183], a[60:63], v[92:95]
    buffer_load_dwordx4 v10, s[12:15], s45 offen offset:2048 lds
    v_mfma_f32_16x16x32_bf16 v[80:83], v[184:187], a[64:67], v[80:83]
    ds_read_b64_tr_b16 v[164:165], v15 offset:45056
    v_exp_f32 v195, v195
    v_mfma_f32_16x16x32_bf16 v[80:83], v[188:191], a[80:83], v[80:83]
    ds_read_b64_tr_b16 v[166:167], v15 offset:47104
    v_mfma_f32_16x16x32_bf16 v[84:87], v[184:187], a[68:71], v[84:87]
    v_add_f32 v192, 1.0, v192
    v_mfma_f32_16x16x32_bf16 v[84:87], v[188:191], a[84:87], v[84:87]
    v_add_f32 v193, 1.0, v193
    v_add_f32 v194, 1.0, v194
    v_mfma_f32_16x16x32_bf16 v[88:91], v[184:187], a[72:75], v[88:91]
    v_add_f32 v195, 1.0, v195
    v_mfma_f32_16x16x32_bf16 v[88:91], v[188:191], a[88:91], v[88:91]
    v_rcp_f32 v192, v192
    v_rcp_f32 v193, v193
    v_mfma_f32_16x16x32_bf16 v[92:95], v[184:187], a[76:79], v[92:95]
    v_rcp_f32 v194, v194
    v_mfma_f32_16x16x32_bf16 v[92:95], v[188:191], a[92:95], v[92:95]
    v_rcp_f32 v195, v195
    s_waitcnt lgkmcnt(0) vmcnt(18)
    s_barrier
    v_mfma_f32_16x16x32_bf16 v[80:83], v[144:147], a[96:99], v[80:83]
    s_add_u32 m0, s46, 73728
    s_add_u32 s44, s47, 768
    buffer_load_dwordx4 v8, s[16:19], s44 offen offset:0 lds
    v_mul_f32 v48, v192, v48
    v_mfma_f32_16x16x32_bf16 v[80:83], v[148:151], a[112:115], v[80:83]
    ds_read_b64_tr_b16 v[168:169], v14 offset:24576
    v_mfma_f32_16x16x32_bf16 v[84:87], v[144:147], a[100:103], v[84:87]
    ds_read_b64_tr_b16 v[170:171], v14 offset:26624
    v_mul_f32 v49, v193, v49
    v_mfma_f32_16x16x32_bf16 v[84:87], v[148:151], a[116:119], v[84:87]
    buffer_load_dwordx4 v9, s[16:19], s44 offen offset:1024 lds
    v_mfma_f32_16x16x32_bf16 v[88:91], v[144:147], a[104:107], v[88:91]
    ds_read_b64_tr_b16 v[172:173], v14 offset:28672
    v_mul_f32 v50, v194, v50
    v_mfma_f32_16x16x32_bf16 v[88:91], v[148:151], a[120:123], v[88:91]
    ds_read_b64_tr_b16 v[174:175], v14 offset:30720
    v_mfma_f32_16x16x32_bf16 v[92:95], v[144:147], a[108:111], v[92:95]
    buffer_load_dwordx4 v10, s[16:19], s44 offen offset:2048 lds
    v_mul_f32 v51, v195, v51
    v_mfma_f32_16x16x32_bf16 v[92:95], v[148:151], a[124:127], v[92:95]
    ds_read_b64_tr_b16 v[176:177], v14 offset:32768
    v_mfma_f32_16x16x32_bf16 v[80:83], v[152:155], a[128:131], v[80:83]
    ds_read_b64_tr_b16 v[178:179], v14 offset:34816
    v_mul_f32 v196, s50, v52
    v_mfma_f32_16x16x32_bf16 v[80:83], v[156:159], a[144:147], v[80:83]
    s_add_u32 m0, s46, 76800
    s_add_u32 s45, s47, 221952
    buffer_load_dwordx4 v8, s[16:19], s45 offen offset:0 lds
    v_mfma_f32_16x16x32_bf16 v[84:87], v[152:155], a[132:135], v[84:87]
    ds_read_b64_tr_b16 v[180:181], v14 offset:36864
    v_mul_f32 v197, s50, v53
    v_mfma_f32_16x16x32_bf16 v[84:87], v[156:159], a[148:151], v[84:87]
    ds_read_b64_tr_b16 v[182:183], v14 offset:38912
    v_mfma_f32_16x16x32_bf16 v[88:91], v[152:155], a[136:139], v[88:91]
    buffer_load_dwordx4 v9, s[16:19], s45 offen offset:1024 lds
    v_mfma_f32_16x16x32_bf16 v[88:91], v[156:159], a[152:155], v[88:91]
    ds_read_b64_tr_b16 v[184:185], v14 offset:40960
    v_mul_f32 v198, s50, v54
    v_mfma_f32_16x16x32_bf16 v[92:95], v[152:155], a[140:143], v[92:95]
    ds_read_b64_tr_b16 v[186:187], v14 offset:43008
    v_mfma_f32_16x16x32_bf16 v[92:95], v[156:159], a[156:159], v[92:95]
    buffer_load_dwordx4 v10, s[16:19], s45 offen offset:2048 lds
    v_mul_f32 v199, s50, v55
    v_mfma_f32_16x16x32_bf16 v[80:83], v[160:163], a[160:163], v[80:83]
    ds_read_b64_tr_b16 v[188:189], v14 offset:45056
    v_mfma_f32_16x16x32_bf16 v[80:83], v[164:167], a[176:179], v[80:83]
    ds_read_b64_tr_b16 v[190:191], v14 offset:47104
    v_exp_f32 v196, v196
    v_mfma_f32_16x16x32_bf16 v[84:87], v[160:163], a[164:167], v[84:87]
    v_exp_f32 v197, v197
    v_mfma_f32_16x16x32_bf16 v[84:87], v[164:167], a[180:183], v[84:87]
    v_exp_f32 v198, v198
    v_exp_f32 v199, v199
    v_mfma_f32_16x16x32_bf16 v[88:91], v[160:163], a[168:171], v[88:91]
    v_add_f32 v196, 1.0, v196
    v_mfma_f32_16x16x32_bf16 v[88:91], v[164:167], a[184:187], v[88:91]
    v_add_f32 v197, 1.0, v197
    v_add_f32 v198, 1.0, v198
    v_mfma_f32_16x16x32_bf16 v[92:95], v[160:163], a[172:175], v[92:95]
    v_add_f32 v199, 1.0, v199
    v_mfma_f32_16x16x32_bf16 v[92:95], v[164:167], a[188:191], v[92:95]
    v_rcp_f32 v196, v196
    s_waitcnt lgkmcnt(0) vmcnt(18)
    s_barrier
    v_mfma_f32_16x16x32_bf16 v[80:83], v[168:171], a[192:195], v[80:83]
    s_add_u32 m0, s46, 24576
    s_add_u32 s44, s47, 1770240
    buffer_load_dwordx4 v8, s[16:19], s44 offen offset:0 lds
    v_rcp_f32 v197, v197
    v_mfma_f32_16x16x32_bf16 v[80:83], v[172:175], a[208:211], v[80:83]
    ds_read_b64_tr_b16 v[144:145], v16 offset:0
    v_mfma_f32_16x16x32_bf16 v[84:87], v[168:171], a[196:199], v[84:87]
    ds_read_b64_tr_b16 v[146:147], v16 offset:2048
    v_rcp_f32 v198, v198
    v_mfma_f32_16x16x32_bf16 v[84:87], v[172:175], a[212:215], v[84:87]
    buffer_load_dwordx4 v9, s[16:19], s44 offen offset:1024 lds
    v_mfma_f32_16x16x32_bf16 v[88:91], v[168:171], a[200:203], v[88:91]
    ds_read_b64_tr_b16 v[148:149], v16 offset:4096
    v_mfma_f32_16x16x32_bf16 v[88:91], v[172:175], a[216:219], v[88:91]
    ds_read_b64_tr_b16 v[150:151], v16 offset:6144
    v_rcp_f32 v199, v199
    v_mfma_f32_16x16x32_bf16 v[92:95], v[168:171], a[204:207], v[92:95]
    buffer_load_dwordx4 v10, s[16:19], s44 offen offset:2048 lds
    v_mfma_f32_16x16x32_bf16 v[92:95], v[172:175], a[220:223], v[92:95]
    ds_read_b64_tr_b16 v[152:153], v16 offset:8192
    v_mfma_f32_16x16x32_bf16 v[80:83], v[176:179], a[224:227], v[80:83]
    ds_read_b64_tr_b16 v[154:155], v16 offset:10240
    v_mul_f32 v52, v196, v52
    v_mfma_f32_16x16x32_bf16 v[80:83], v[180:183], a[240:243], v[80:83]
    s_add_u32 m0, s46, 27648
    s_add_u32 s45, s47, 1991424
    buffer_load_dwordx4 v8, s[16:19], s45 offen offset:0 lds
    v_mfma_f32_16x16x32_bf16 v[84:87], v[176:179], a[228:231], v[84:87]
    ds_read_b64_tr_b16 v[156:157], v16 offset:12288
    v_mul_f32 v53, v197, v53
    v_mfma_f32_16x16x32_bf16 v[84:87], v[180:183], a[244:247], v[84:87]
    ds_read_b64_tr_b16 v[158:159], v16 offset:14336
    v_mfma_f32_16x16x32_bf16 v[88:91], v[176:179], a[232:235], v[88:91]
    buffer_load_dwordx4 v9, s[16:19], s45 offen offset:1024 lds
    v_mfma_f32_16x16x32_bf16 v[88:91], v[180:183], a[248:251], v[88:91]
    ds_read_b64_tr_b16 v[160:161], v16 offset:16384
    v_mul_f32 v54, v198, v54
    v_mfma_f32_16x16x32_bf16 v[92:95], v[176:179], a[236:239], v[92:95]
    ds_read_b64_tr_b16 v[162:163], v16 offset:18432
    v_mfma_f32_16x16x32_bf16 v[92:95], v[180:183], a[252:255], v[92:95]
    buffer_load_dwordx4 v10, s[16:19], s45 offen offset:2048 lds
    v_mfma_f32_16x16x32_bf16 v[80:83], v[184:187], v[224:227], v[80:83]
    ds_read_b64_tr_b16 v[164:165], v16 offset:20480
    v_mul_f32 v55, v199, v55
    v_mfma_f32_16x16x32_bf16 v[80:83], v[188:191], v[240:243], v[80:83]
    ds_read_b64_tr_b16 v[166:167], v16 offset:22528
    v_mfma_f32_16x16x32_bf16 v[84:87], v[184:187], v[228:231], v[84:87]
    v_mul_f32 v200, s50, v56
    v_mul_f32 v201, s50, v57
    v_mfma_f32_16x16x32_bf16 v[84:87], v[188:191], v[244:247], v[84:87]
    v_mul_f32 v202, s50, v58
    v_mfma_f32_16x16x32_bf16 v[88:91], v[184:187], v[232:235], v[88:91]
    v_mul_f32 v203, s50, v59
    v_mfma_f32_16x16x32_bf16 v[88:91], v[188:191], v[248:251], v[88:91]
    v_exp_f32 v200, v200
    v_exp_f32 v201, v201
    v_mfma_f32_16x16x32_bf16 v[92:95], v[184:187], v[236:239], v[92:95]
    v_exp_f32 v202, v202
    v_mfma_f32_16x16x32_bf16 v[92:95], v[188:191], v[252:255], v[92:95]
    v_exp_f32 v203, v203
    s_waitcnt lgkmcnt(0) vmcnt(18)
    s_barrier
    v_mfma_f32_16x16x32_bf16 v[32:35], v[144:147], a[0:3], 0
    s_add_u32 m0, s46, 98304
    s_add_u32 s44, s47, 3539712
    buffer_load_dwordx4 v8, s[16:19], s44 offen offset:0 lds
    ds_read_b64_tr_b16 v[168:169], v15 offset:0
    v_mfma_f32_16x16x32_bf16 v[32:35], v[148:151], a[16:19], v[32:35]
    ds_read_b64_tr_b16 v[170:171], v15 offset:2048
    v_add_f32 v200, 1.0, v200
    v_mfma_f32_16x16x32_bf16 v[36:39], v[144:147], a[4:7], 0
    buffer_load_dwordx4 v9, s[16:19], s44 offen offset:1024 lds
    v_mfma_f32_16x16x32_bf16 v[36:39], v[148:151], a[20:23], v[36:39]
    ds_read_b64_tr_b16 v[172:173], v15 offset:4096
    v_add_f32 v201, 1.0, v201
    v_mfma_f32_16x16x32_bf16 v[40:43], v[144:147], a[8:11], 0
    ds_read_b64_tr_b16 v[174:175], v15 offset:6144
    v_mfma_f32_16x16x32_bf16 v[40:43], v[148:151], a[24:27], v[40:43]
    buffer_load_dwordx4 v10, s[16:19], s44 offen offset:2048 lds
    v_add_f32 v202, 1.0, v202
    v_mfma_f32_16x16x32_bf16 v[44:47], v[144:147], a[12:15], 0
    ds_read_b64_tr_b16 v[176:177], v15 offset:8192
    v_mfma_f32_16x16x32_bf16 v[44:47], v[148:151], a[28:31], v[44:47]
    ds_read_b64_tr_b16 v[178:179], v15 offset:10240
    v_add_f32 v203, 1.0, v203
    v_mfma_f32_16x16x32_bf16 v[32:35], v[152:155], a[32:35], v[32:35]
    s_add_u32 m0, s46, 101376
    s_add_u32 s45, s47, 3760896
    buffer_load_dwordx4 v8, s[16:19], s45 offen offset:0 lds
    v_mfma_f32_16x16x32_bf16 v[32:35], v[156:159], a[48:51], v[32:35]
    ds_read_b64_tr_b16 v[180:181], v15 offset:12288
    v_rcp_f32 v200, v200
    v_mfma_f32_16x16x32_bf16 v[36:39], v[152:155], a[36:39], v[36:39]
    ds_read_b64_tr_b16 v[182:183], v15 offset:14336
    v_mfma_f32_16x16x32_bf16 v[36:39], v[156:159], a[52:55], v[36:39]
    buffer_load_dwordx4 v9, s[16:19], s45 offen offset:1024 lds
    v_rcp_f32 v201, v201
    v_mfma_f32_16x16x32_bf16 v[40:43], v[152:155], a[40:43], v[40:43]
    ds_read_b64_tr_b16 v[184:185], v15 offset:16384
    v_rcp_f32 v202, v202
    v_mfma_f32_16x16x32_bf16 v[40:43], v[156:159], a[56:59], v[40:43]
    ds_read_b64_tr_b16 v[186:187], v15 offset:18432
    v_mfma_f32_16x16x32_bf16 v[44:47], v[152:155], a[44:47], v[44:47]
    buffer_load_dwordx4 v10, s[16:19], s45 offen offset:2048 lds
    v_rcp_f32 v203, v203
    v_mfma_f32_16x16x32_bf16 v[44:47], v[156:159], a[60:63], v[44:47]
    ds_read_b64_tr_b16 v[188:189], v15 offset:20480
    v_mfma_f32_16x16x32_bf16 v[32:35], v[160:163], a[64:67], v[32:35]
    ds_read_b64_tr_b16 v[190:191], v15 offset:22528
    v_mul_f32 v56, v200, v56
    v_mfma_f32_16x16x32_bf16 v[32:35], v[164:167], a[80:83], v[32:35]
    buffer_load_dword v6, v5, s[28:31], s48 offen offset:0
    v_mfma_f32_16x16x32_bf16 v[36:39], v[160:163], a[68:71], v[36:39]
    v_mul_f32 v57, v201, v57
    v_mul_f32 v58, v202, v58
    v_mfma_f32_16x16x32_bf16 v[36:39], v[164:167], a[84:87], v[36:39]
    v_mul_f32 v59, v203, v59
    v_mfma_f32_16x16x32_bf16 v[40:43], v[160:163], a[72:75], v[40:43]
    v_mul_f32 v192, s50, v60
    v_mul_f32 v193, s50, v61
    v_mfma_f32_16x16x32_bf16 v[40:43], v[164:167], a[88:91], v[40:43]
    v_mul_f32 v194, s50, v62
    v_mfma_f32_16x16x32_bf16 v[44:47], v[160:163], a[76:79], v[44:47]
    v_mul_f32 v195, s50, v63
    v_exp_f32 v192, v192
    v_mfma_f32_16x16x32_bf16 v[44:47], v[164:167], a[92:95], v[44:47]
    v_exp_f32 v193, v193
    s_waitcnt lgkmcnt(0) vmcnt(19)
    s_barrier
    v_mfma_f32_16x16x32_bf16 v[32:35], v[168:171], a[96:99], v[32:35]
    s_add_u32 m0, s46, 49152
    s_add_u32 s44, s47, 896
    buffer_load_dwordx4 v8, s[12:15], s44 offen offset:0 lds
    v_exp_f32 v194, v194
    v_mfma_f32_16x16x32_bf16 v[32:35], v[172:175], a[112:115], v[32:35]
    ds_read_b64_tr_b16 v[144:145], v14 offset:0
    v_mfma_f32_16x16x32_bf16 v[36:39], v[168:171], a[100:103], v[36:39]
    ds_read_b64_tr_b16 v[146:147], v14 offset:2048
    v_exp_f32 v195, v195
    v_mfma_f32_16x16x32_bf16 v[36:39], v[172:175], a[116:119], v[36:39]
    buffer_load_dwordx4 v9, s[12:15], s44 offen offset:1024 lds
    v_mfma_f32_16x16x32_bf16 v[40:43], v[168:171], a[104:107], v[40:43]
    ds_read_b64_tr_b16 v[148:149], v14 offset:4096
    v_add_f32 v192, 1.0, v192
    v_mfma_f32_16x16x32_bf16 v[40:43], v[172:175], a[120:123], v[40:43]
    ds_read_b64_tr_b16 v[150:151], v14 offset:6144
    v_mfma_f32_16x16x32_bf16 v[44:47], v[168:171], a[108:111], v[44:47]
    buffer_load_dwordx4 v10, s[12:15], s44 offen offset:2048 lds
    v_mfma_f32_16x16x32_bf16 v[44:47], v[172:175], a[124:127], v[44:47]
    ds_read_b64_tr_b16 v[152:153], v14 offset:8192
    v_add_f32 v193, 1.0, v193
    v_mfma_f32_16x16x32_bf16 v[32:35], v[176:179], a[128:131], v[32:35]
    ds_read_b64_tr_b16 v[154:155], v14 offset:10240
    v_mfma_f32_16x16x32_bf16 v[32:35], v[180:183], a[144:147], v[32:35]
    s_add_u32 m0, s46, 52224
    s_add_u32 s45, s47, 222080
    buffer_load_dwordx4 v8, s[12:15], s45 offen offset:0 lds
    v_add_f32 v194, 1.0, v194
    v_mfma_f32_16x16x32_bf16 v[36:39], v[176:179], a[132:135], v[36:39]
    ds_read_b64_tr_b16 v[156:157], v14 offset:12288
    v_mfma_f32_16x16x32_bf16 v[36:39], v[180:183], a[148:151], v[36:39]
    ds_read_b64_tr_b16 v[158:159], v14 offset:14336
    v_mfma_f32_16x16x32_bf16 v[40:43], v[176:179], a[136:139], v[40:43]
    buffer_load_dwordx4 v9, s[12:15], s45 offen offset:1024 lds
    v_add_f32 v195, 1.0, v195
    v_mfma_f32_16x16x32_bf16 v[40:43], v[180:183], a[152:155], v[40:43]
    ds_read_b64_tr_b16 v[160:161], v14 offset:16384
    v_mfma_f32_16x16x32_bf16 v[44:47], v[176:179], a[140:143], v[44:47]
    ds_read_b64_tr_b16 v[162:163], v14 offset:18432
    v_rcp_f32 v192, v192
    v_mfma_f32_16x16x32_bf16 v[44:47], v[180:183], a[156:159], v[44:47]
    buffer_load_dwordx4 v10, s[12:15], s45 offen offset:2048 lds
    v_mfma_f32_16x16x32_bf16 v[32:35], v[184:187], a[160:163], v[32:35]
    ds_read_b64_tr_b16 v[164:165], v14 offset:20480
    v_rcp_f32 v193, v193
    v_mfma_f32_16x16x32_bf16 v[32:35], v[188:191], a[176:179], v[32:35]
    ds_read_b64_tr_b16 v[166:167], v14 offset:22528
    v_mfma_f32_16x16x32_bf16 v[36:39], v[184:187], a[164:167], v[36:39]
    v_rcp_f32 v194, v194
    v_mfma_f32_16x16x32_bf16 v[36:39], v[188:191], a[180:183], v[36:39]
    v_rcp_f32 v195, v195
    v_mul_f32 v60, v192, v60
    v_mfma_f32_16x16x32_bf16 v[40:43], v[184:187], a[168:171], v[40:43]
    v_mul_f32 v61, v193, v61
    v_mfma_f32_16x16x32_bf16 v[40:43], v[188:191], a[184:187], v[40:43]
    v_mul_f32 v62, v194, v62
    v_mul_f32 v63, v195, v63
    v_mfma_f32_16x16x32_bf16 v[44:47], v[184:187], a[172:175], v[44:47]
    v_mul_f32 v48, v48, v80
    v_mfma_f32_16x16x32_bf16 v[44:47], v[188:191], a[188:191], v[44:47]
    v_mul_f32 v49, v49, v81
    s_waitcnt lgkmcnt(0) vmcnt(19)
    s_barrier
    v_mfma_f32_16x16x32_bf16 v[32:35], v[144:147], a[192:195], v[32:35]
    s_add_u32 m0, s46, 0
    s_add_u32 s44, s47, 1770368
    buffer_load_dwordx4 v8, s[12:15], s44 offen offset:0 lds
    v_mul_f32 v50, v50, v82
    v_mfma_f32_16x16x32_bf16 v[32:35], v[148:151], a[208:211], v[32:35]
    ds_read_b64_tr_b16 v[168:169], v15 offset:24576
    v_mul_f32 v51, v51, v83
    v_mfma_f32_16x16x32_bf16 v[36:39], v[144:147], a[196:199], v[36:39]
    ds_read_b64_tr_b16 v[170:171], v15 offset:26624
    v_mfma_f32_16x16x32_bf16 v[36:39], v[148:151], a[212:215], v[36:39]
    buffer_load_dwordx4 v9, s[12:15], s44 offen offset:1024 lds
    v_cvt_pk_bf16_f32 v136, v48, v49
    v_mfma_f32_16x16x32_bf16 v[40:43], v[144:147], a[200:203], v[40:43]
    ds_read_b64_tr_b16 v[172:173], v15 offset:28672
    v_cvt_pk_bf16_f32 v137, v50, v51
    v_mfma_f32_16x16x32_bf16 v[40:43], v[148:151], a[216:219], v[40:43]
    ds_read_b64_tr_b16 v[174:175], v15 offset:30720
    v_mfma_f32_16x16x32_bf16 v[44:47], v[144:147], a[204:207], v[44:47]
    buffer_load_dwordx4 v10, s[12:15], s44 offen offset:2048 lds
    v_mul_f32 v52, v52, v84
    v_mfma_f32_16x16x32_bf16 v[44:47], v[148:151], a[220:223], v[44:47]
    ds_read_b64_tr_b16 v[176:177], v15 offset:32768
    v_mul_f32 v53, v53, v85
    v_mfma_f32_16x16x32_bf16 v[32:35], v[152:155], a[224:227], v[32:35]
    ds_read_b64_tr_b16 v[178:179], v15 offset:34816
    v_mfma_f32_16x16x32_bf16 v[32:35], v[156:159], a[240:243], v[32:35]
    s_add_u32 m0, s46, 3072
    s_add_u32 s45, s47, 1991552
    buffer_load_dwordx4 v8, s[12:15], s45 offen offset:0 lds
    v_mul_f32 v54, v54, v86
    v_mfma_f32_16x16x32_bf16 v[36:39], v[152:155], a[228:231], v[36:39]
    ds_read_b64_tr_b16 v[180:181], v15 offset:36864
    v_mul_f32 v55, v55, v87
    v_mfma_f32_16x16x32_bf16 v[36:39], v[156:159], a[244:247], v[36:39]
    ds_read_b64_tr_b16 v[182:183], v15 offset:38912
    v_mfma_f32_16x16x32_bf16 v[40:43], v[152:155], a[232:235], v[40:43]
    buffer_load_dwordx4 v9, s[12:15], s45 offen offset:1024 lds
    v_cvt_pk_bf16_f32 v138, v52, v53
    v_mfma_f32_16x16x32_bf16 v[40:43], v[156:159], a[248:251], v[40:43]
    ds_read_b64_tr_b16 v[184:185], v15 offset:40960
    v_cvt_pk_bf16_f32 v139, v54, v55
    v_mfma_f32_16x16x32_bf16 v[44:47], v[152:155], a[236:239], v[44:47]
    ds_read_b64_tr_b16 v[186:187], v15 offset:43008
    v_mfma_f32_16x16x32_bf16 v[44:47], v[156:159], a[252:255], v[44:47]
    buffer_load_dwordx4 v10, s[12:15], s45 offen offset:2048 lds
    v_mul_f32 v56, v56, v88
    v_mfma_f32_16x16x32_bf16 v[32:35], v[160:163], v[224:227], v[32:35]
    ds_read_b64_tr_b16 v[188:189], v15 offset:45056
    v_mul_f32 v57, v57, v89
    v_mfma_f32_16x16x32_bf16 v[32:35], v[164:167], v[240:243], v[32:35]
    ds_read_b64_tr_b16 v[190:191], v15 offset:47104
    v_mfma_f32_16x16x32_bf16 v[36:39], v[160:163], v[228:231], v[36:39]
    v_mul_f32 v58, v58, v90
    v_mul_f32 v59, v59, v91
    v_mfma_f32_16x16x32_bf16 v[36:39], v[164:167], v[244:247], v[36:39]
    v_cvt_pk_bf16_f32 v140, v56, v57
    v_cvt_pk_bf16_f32 v141, v58, v59
    v_mfma_f32_16x16x32_bf16 v[40:43], v[160:163], v[232:235], v[40:43]
    v_mul_f32 v60, v60, v92
    v_mfma_f32_16x16x32_bf16 v[40:43], v[164:167], v[248:251], v[40:43]
    v_mul_f32 v61, v61, v93
    v_mul_f32 v62, v62, v94
    v_mfma_f32_16x16x32_bf16 v[44:47], v[160:163], v[236:239], v[44:47]
    v_mul_f32 v63, v63, v95
    v_cvt_pk_bf16_f32 v142, v60, v61
    v_mfma_f32_16x16x32_bf16 v[44:47], v[164:167], v[252:255], v[44:47]
    v_cvt_pk_bf16_f32 v143, v62, v63
    s_waitcnt lgkmcnt(0) vmcnt(19)
    s_barrier
    v_mfma_f32_16x16x32_bf16 v[64:67], v[168:171], a[0:3], 0
    s_add_u32 m0, s46, 122880
    s_add_u32 s44, s47, 3539840
    buffer_load_dwordx4 v8, s[12:15], s44 offen offset:0 lds
    v_mul_f32 v192, s50, v32
    v_mfma_f32_16x16x32_bf16 v[64:67], v[172:175], a[16:19], v[64:67]
    ds_read_b64_tr_b16 v[144:145], v14 offset:24576
    v_mfma_f32_16x16x32_bf16 v[68:71], v[168:171], a[4:7], 0
    ds_read_b64_tr_b16 v[146:147], v14 offset:26624
    v_mul_f32 v193, s50, v33
    v_mfma_f32_16x16x32_bf16 v[68:71], v[172:175], a[20:23], v[68:71]
    buffer_load_dwordx4 v9, s[12:15], s44 offen offset:1024 lds
    v_mfma_f32_16x16x32_bf16 v[72:75], v[168:171], a[8:11], 0
    ds_read_b64_tr_b16 v[148:149], v14 offset:28672
    v_mul_f32 v194, s50, v34
    v_mfma_f32_16x16x32_bf16 v[72:75], v[172:175], a[24:27], v[72:75]
    ds_read_b64_tr_b16 v[150:151], v14 offset:30720
    v_mfma_f32_16x16x32_bf16 v[76:79], v[168:171], a[12:15], 0
    buffer_load_dwordx4 v10, s[12:15], s44 offen offset:2048 lds
    v_mfma_f32_16x16x32_bf16 v[76:79], v[172:175], a[28:31], v[76:79]
    ds_read_b64_tr_b16 v[152:153], v14 offset:32768
    v_mul_f32 v195, s50, v35
    v_mfma_f32_16x16x32_bf16 v[64:67], v[176:179], a[32:35], v[64:67]
    ds_read_b64_tr_b16 v[154:155], v14 offset:34816
    v_mfma_f32_16x16x32_bf16 v[64:67], v[180:183], a[48:51], v[64:67]
    s_add_u32 m0, s46, 125952
    s_add_u32 s45, s47, 3761024
    buffer_load_dwordx4 v8, s[12:15], s45 offen offset:0 lds
    v_exp_f32 v192, v192
    v_mfma_f32_16x16x32_bf16 v[68:71], v[176:179], a[36:39], v[68:71]
    ds_read_b64_tr_b16 v[156:157], v14 offset:36864
    v_mfma_f32_16x16x32_bf16 v[68:71], v[180:183], a[52:55], v[68:71]
    ds_read_b64_tr_b16 v[158:159], v14 offset:38912
    v_mfma_f32_16x16x32_bf16 v[72:75], v[176:179], a[40:43], v[72:75]
    buffer_load_dwordx4 v9, s[12:15], s45 offen offset:1024 lds
    v_exp_f32 v193, v193
    v_mfma_f32_16x16x32_bf16 v[72:75], v[180:183], a[56:59], v[72:75]
    ds_read_b64_tr_b16 v[160:161], v14 offset:40960
    v_mfma_f32_16x16x32_bf16 v[76:79], v[176:179], a[44:47], v[76:79]
    ds_read_b64_tr_b16 v[162:163], v14 offset:43008
    v_exp_f32 v194, v194
    v_mfma_f32_16x16x32_bf16 v[76:79], v[180:183], a[60:63], v[76:79]
    buffer_load_dwordx4 v10, s[12:15], s45 offen offset:2048 lds
    v_mfma_f32_16x16x32_bf16 v[64:67], v[184:187], a[64:67], v[64:67]
    ds_read_b64_tr_b16 v[164:165], v14 offset:45056
    v_exp_f32 v195, v195
    v_mfma_f32_16x16x32_bf16 v[64:67], v[188:191], a[80:83], v[64:67]
    ds_read_b64_tr_b16 v[166:167], v14 offset:47104
    v_mfma_f32_16x16x32_bf16 v[68:71], v[184:187], a[68:71], v[68:71]
    v_add_f32 v192, 1.0, v192
    v_mfma_f32_16x16x32_bf16 v[68:71], v[188:191], a[84:87], v[68:71]
    v_add_f32 v193, 1.0, v193
    v_add_f32 v194, 1.0, v194
    v_mfma_f32_16x16x32_bf16 v[72:75], v[184:187], a[72:75], v[72:75]
    v_add_f32 v195, 1.0, v195
    v_mfma_f32_16x16x32_bf16 v[72:75], v[188:191], a[88:91], v[72:75]
    v_rcp_f32 v192, v192
    v_rcp_f32 v193, v193
    v_mfma_f32_16x16x32_bf16 v[76:79], v[184:187], a[76:79], v[76:79]
    v_rcp_f32 v194, v194
    v_mfma_f32_16x16x32_bf16 v[76:79], v[188:191], a[92:95], v[76:79]
    v_rcp_f32 v195, v195
    s_waitcnt lgkmcnt(0) vmcnt(19)
    s_barrier
    v_mfma_f32_16x16x32_bf16 v[64:67], v[144:147], a[96:99], v[64:67]
    s_add_u32 m0, s46, 24576
    s_add_u32 s44, s47, 896
    buffer_load_dwordx4 v8, s[16:19], s44 offen offset:0 lds
    v_mul_f32 v32, v192, v32
    v_mfma_f32_16x16x32_bf16 v[64:67], v[148:151], a[112:115], v[64:67]
    ds_read_b64_tr_b16 v[168:169], v16 offset:0
    v_mfma_f32_16x16x32_bf16 v[68:71], v[144:147], a[100:103], v[68:71]
    ds_read_b64_tr_b16 v[170:171], v16 offset:2048
    v_mul_f32 v33, v193, v33
    v_mfma_f32_16x16x32_bf16 v[68:71], v[148:151], a[116:119], v[68:71]
    buffer_load_dwordx4 v9, s[16:19], s44 offen offset:1024 lds
    v_mfma_f32_16x16x32_bf16 v[72:75], v[144:147], a[104:107], v[72:75]
    ds_read_b64_tr_b16 v[172:173], v16 offset:4096
    v_mul_f32 v34, v194, v34
    v_mfma_f32_16x16x32_bf16 v[72:75], v[148:151], a[120:123], v[72:75]
    ds_read_b64_tr_b16 v[174:175], v16 offset:6144
    v_mfma_f32_16x16x32_bf16 v[76:79], v[144:147], a[108:111], v[76:79]
    buffer_load_dwordx4 v10, s[16:19], s44 offen offset:2048 lds
    v_mul_f32 v35, v195, v35
    v_mfma_f32_16x16x32_bf16 v[76:79], v[148:151], a[124:127], v[76:79]
    ds_read_b64_tr_b16 v[176:177], v16 offset:8192
    v_mfma_f32_16x16x32_bf16 v[64:67], v[152:155], a[128:131], v[64:67]
    ds_read_b64_tr_b16 v[178:179], v16 offset:10240
    v_mul_f32 v196, s50, v36
    v_mfma_f32_16x16x32_bf16 v[64:67], v[156:159], a[144:147], v[64:67]
    s_add_u32 m0, s46, 27648
    s_add_u32 s45, s47, 222080
    buffer_load_dwordx4 v8, s[16:19], s45 offen offset:0 lds
    v_mfma_f32_16x16x32_bf16 v[68:71], v[152:155], a[132:135], v[68:71]
    ds_read_b64_tr_b16 v[180:181], v16 offset:12288
    v_mul_f32 v197, s50, v37
    v_mfma_f32_16x16x32_bf16 v[68:71], v[156:159], a[148:151], v[68:71]
    ds_read_b64_tr_b16 v[182:183], v16 offset:14336
    v_mfma_f32_16x16x32_bf16 v[72:75], v[152:155], a[136:139], v[72:75]
    buffer_load_dwordx4 v9, s[16:19], s45 offen offset:1024 lds
    v_mfma_f32_16x16x32_bf16 v[72:75], v[156:159], a[152:155], v[72:75]
    ds_read_b64_tr_b16 v[184:185], v16 offset:16384
    v_mul_f32 v198, s50, v38
    v_mfma_f32_16x16x32_bf16 v[76:79], v[152:155], a[140:143], v[76:79]
    ds_read_b64_tr_b16 v[186:187], v16 offset:18432
    v_mfma_f32_16x16x32_bf16 v[76:79], v[156:159], a[156:159], v[76:79]
    buffer_load_dwordx4 v10, s[16:19], s45 offen offset:2048 lds
    v_mul_f32 v199, s50, v39
    v_mfma_f32_16x16x32_bf16 v[64:67], v[160:163], a[160:163], v[64:67]
    ds_read_b64_tr_b16 v[188:189], v16 offset:20480
    v_mfma_f32_16x16x32_bf16 v[64:67], v[164:167], a[176:179], v[64:67]
    ds_read_b64_tr_b16 v[190:191], v16 offset:22528
    v_exp_f32 v196, v196
    v_mfma_f32_16x16x32_bf16 v[68:71], v[160:163], a[164:167], v[68:71]
    v_exp_f32 v197, v197
    v_mfma_f32_16x16x32_bf16 v[68:71], v[164:167], a[180:183], v[68:71]
    v_exp_f32 v198, v198
    v_exp_f32 v199, v199
    v_mfma_f32_16x16x32_bf16 v[72:75], v[160:163], a[168:171], v[72:75]
    v_add_f32 v196, 1.0, v196
    v_mfma_f32_16x16x32_bf16 v[72:75], v[164:167], a[184:187], v[72:75]
    v_add_f32 v197, 1.0, v197
    v_add_f32 v198, 1.0, v198
    v_mfma_f32_16x16x32_bf16 v[76:79], v[160:163], a[172:175], v[76:79]
    v_add_f32 v199, 1.0, v199
    v_mfma_f32_16x16x32_bf16 v[76:79], v[164:167], a[188:191], v[76:79]
    v_rcp_f32 v196, v196
    s_waitcnt lgkmcnt(0) vmcnt(18)
    s_barrier
    v_mfma_f32_16x16x32_bf16 v[64:67], v[168:171], a[192:195], v[64:67]
    ds_read_b64_tr_b16 v[144:145], v15 offset:0
    v_rcp_f32 v197, v197
    v_mfma_f32_16x16x32_bf16 v[64:67], v[172:175], a[208:211], v[64:67]
    ds_read_b64_tr_b16 v[146:147], v15 offset:2048
    v_mfma_f32_16x16x32_bf16 v[68:71], v[168:171], a[196:199], v[68:71]
    v_rcp_f32 v198, v198
    v_mfma_f32_16x16x32_bf16 v[68:71], v[172:175], a[212:215], v[68:71]
    ds_read_b64_tr_b16 v[148:149], v15 offset:4096
    v_mfma_f32_16x16x32_bf16 v[72:75], v[168:171], a[200:203], v[72:75]
    ds_read_b64_tr_b16 v[150:151], v15 offset:6144
    v_mfma_f32_16x16x32_bf16 v[72:75], v[172:175], a[216:219], v[72:75]
    v_rcp_f32 v199, v199
    v_mfma_f32_16x16x32_bf16 v[76:79], v[168:171], a[204:207], v[76:79]
    ds_read_b64_tr_b16 v[152:153], v15 offset:8192
    v_mfma_f32_16x16x32_bf16 v[76:79], v[172:175], a[220:223], v[76:79]
    ds_read_b64_tr_b16 v[154:155], v15 offset:10240
    v_mfma_f32_16x16x32_bf16 v[64:67], v[176:179], a[224:227], v[64:67]
    v_mul_f32 v36, v196, v36
    v_mul_f32 v37, v197, v37
    v_mfma_f32_16x16x32_bf16 v[64:67], v[180:183], a[240:243], v[64:67]
    ds_read_b64_tr_b16 v[156:157], v15 offset:12288
    v_mfma_f32_16x16x32_bf16 v[68:71], v[176:179], a[228:231], v[68:71]
    ds_read_b64_tr_b16 v[158:159], v15 offset:14336
    v_mfma_f32_16x16x32_bf16 v[68:71], v[180:183], a[244:247], v[68:71]
    v_mul_f32 v38, v198, v38
    v_mfma_f32_16x16x32_bf16 v[72:75], v[176:179], a[232:235], v[72:75]
    ds_read_b64_tr_b16 v[160:161], v15 offset:16384
    v_mfma_f32_16x16x32_bf16 v[72:75], v[180:183], a[248:251], v[72:75]
    ds_read_b64_tr_b16 v[162:163], v15 offset:18432
    v_mfma_f32_16x16x32_bf16 v[76:79], v[176:179], a[236:239], v[76:79]
    v_mul_f32 v39, v199, v39
    v_mfma_f32_16x16x32_bf16 v[76:79], v[180:183], a[252:255], v[76:79]
    ds_read_b64_tr_b16 v[164:165], v15 offset:20480
    v_mfma_f32_16x16x32_bf16 v[64:67], v[184:187], v[224:227], v[64:67]
    ds_read_b64_tr_b16 v[166:167], v15 offset:22528
    v_mul_f32 v200, s50, v40
    v_mfma_f32_16x16x32_bf16 v[64:67], v[188:191], v[240:243], v[64:67]
    v_mul_f32 v201, s50, v41
    v_mfma_f32_16x16x32_bf16 v[68:71], v[184:187], v[228:231], v[68:71]
    v_mul_f32 v202, s50, v42
    v_mfma_f32_16x16x32_bf16 v[68:71], v[188:191], v[244:247], v[68:71]
    v_mul_f32 v203, s50, v43
    v_mfma_f32_16x16x32_bf16 v[72:75], v[184:187], v[232:235], v[72:75]
    v_exp_f32 v200, v200
    v_mfma_f32_16x16x32_bf16 v[72:75], v[188:191], v[248:251], v[72:75]
    v_exp_f32 v201, v201
    v_mfma_f32_16x16x32_bf16 v[76:79], v[184:187], v[236:239], v[76:79]
    v_exp_f32 v202, v202
    v_mfma_f32_16x16x32_bf16 v[76:79], v[188:191], v[252:255], v[76:79]
    v_exp_f32 v203, v203
    s_waitcnt lgkmcnt(0) vmcnt(12)
    s_barrier
    ds_write_b64 v24, v[96:97] offset:0
    ds_write_b64 v24, v[98:99] offset:1024
    ds_write_b64 v24, v[100:101] offset:2048
    ds_write_b64 v24, v[102:103] offset:3072
    ds_write_b64 v24, v[104:105] offset:8192
    ds_write_b64 v24, v[106:107] offset:9216
    ds_write_b64 v24, v[108:109] offset:10240
    ds_write_b64 v24, v[110:111] offset:11264
    ds_write_b64 v24, v[112:113] offset:16384
    ds_write_b64 v24, v[114:115] offset:17408
    ds_write_b64 v24, v[116:117] offset:18432
    ds_write_b64 v24, v[118:119] offset:19456
    ds_write_b64 v24, v[120:121] offset:24576
    ds_write_b64 v24, v[122:123] offset:25600
    ds_write_b64 v24, v[124:125] offset:26624
    ds_write_b64 v24, v[126:127] offset:27648
    ds_write_b64 v24, v[128:129] offset:32768
    ds_write_b64 v24, v[130:131] offset:33792
    ds_write_b64 v24, v[132:133] offset:34816
    ds_write_b64 v24, v[134:135] offset:35840
    ds_write_b64 v24, v[136:137] offset:40960
    ds_write_b64 v24, v[138:139] offset:41984
    ds_write_b64 v24, v[140:141] offset:43008
    ds_write_b64 v24, v[142:143] offset:44032
    v_mfma_f32_16x16x32_bf16 v[48:51], v[144:147], a[0:3], 0
    s_add_u32 m0, s46, 49152
    s_add_u32 s44, s47, 1770368
    buffer_load_dwordx4 v8, s[16:19], s44 offen offset:0 lds
    v_add_f32 v200, 1.0, v200
    v_mfma_f32_16x16x32_bf16 v[48:51], v[148:151], a[16:19], v[48:51]
    ds_read_b64_tr_b16 v[168:169], v14 offset:0
    v_mfma_f32_16x16x32_bf16 v[52:55], v[144:147], a[4:7], 0
    ds_read_b64_tr_b16 v[170:171], v14 offset:2048
    v_add_f32 v201, 1.0, v201
    v_mfma_f32_16x16x32_bf16 v[52:55], v[148:151], a[20:23], v[52:55]
    buffer_load_dwordx4 v9, s[16:19], s44 offen offset:1024 lds
    v_mfma_f32_16x16x32_bf16 v[56:59], v[144:147], a[8:11], 0
    ds_read_b64_tr_b16 v[172:173], v14 offset:4096
    v_add_f32 v202, 1.0, v202
    v_mfma_f32_16x16x32_bf16 v[56:59], v[148:151], a[24:27], v[56:59]
    ds_read_b64_tr_b16 v[174:175], v14 offset:6144
    v_mfma_f32_16x16x32_bf16 v[60:63], v[144:147], a[12:15], 0
    buffer_load_dwordx4 v10, s[16:19], s44 offen offset:2048 lds
    v_add_f32 v203, 1.0, v203
    v_mfma_f32_16x16x32_bf16 v[60:63], v[148:151], a[28:31], v[60:63]
    ds_read_b64_tr_b16 v[176:177], v14 offset:8192
    v_mfma_f32_16x16x32_bf16 v[48:51], v[152:155], a[32:35], v[48:51]
    ds_read_b64_tr_b16 v[178:179], v14 offset:10240
    v_rcp_f32 v200, v200
    v_mfma_f32_16x16x32_bf16 v[48:51], v[156:159], a[48:51], v[48:51]
    s_add_u32 m0, s46, 52224
    s_add_u32 s45, s47, 1991552
    buffer_load_dwordx4 v8, s[16:19], s45 offen offset:0 lds
    v_mfma_f32_16x16x32_bf16 v[52:55], v[152:155], a[36:39], v[52:55]
    ds_read_b64_tr_b16 v[180:181], v14 offset:12288
    v_rcp_f32 v201, v201
    v_mfma_f32_16x16x32_bf16 v[52:55], v[156:159], a[52:55], v[52:55]
    ds_read_b64_tr_b16 v[182:183], v14 offset:14336
    v_mfma_f32_16x16x32_bf16 v[56:59], v[152:155], a[40:43], v[56:59]
    buffer_load_dwordx4 v9, s[16:19], s45 offen offset:1024 lds
    v_rcp_f32 v202, v202
    v_mfma_f32_16x16x32_bf16 v[56:59], v[156:159], a[56:59], v[56:59]
    ds_read_b64_tr_b16 v[184:185], v14 offset:16384
    v_mfma_f32_16x16x32_bf16 v[60:63], v[152:155], a[44:47], v[60:63]
    ds_read_b64_tr_b16 v[186:187], v14 offset:18432
    v_rcp_f32 v203, v203
    v_mfma_f32_16x16x32_bf16 v[60:63], v[156:159], a[60:63], v[60:63]
    buffer_load_dwordx4 v10, s[16:19], s45 offen offset:2048 lds
    v_mfma_f32_16x16x32_bf16 v[48:51], v[160:163], a[64:67], v[48:51]
    ds_read_b64_tr_b16 v[188:189], v14 offset:20480
    v_mul_f32 v40, v200, v40
    v_mfma_f32_16x16x32_bf16 v[48:51], v[164:167], a[80:83], v[48:51]
    ds_read_b64_tr_b16 v[190:191], v14 offset:22528
    v_mfma_f32_16x16x32_bf16 v[52:55], v[160:163], a[68:71], v[52:55]
    v_mul_f32 v41, v201, v41
    v_mul_f32 v42, v202, v42
    v_mfma_f32_16x16x32_bf16 v[52:55], v[164:167], a[84:87], v[52:55]
    v_mul_f32 v43, v203, v43
    v_mfma_f32_16x16x32_bf16 v[56:59], v[160:163], a[72:75], v[56:59]
    v_mul_f32 v192, s50, v44
    v_mul_f32 v193, s50, v45
    v_mfma_f32_16x16x32_bf16 v[56:59], v[164:167], a[88:91], v[56:59]
    v_mul_f32 v194, s50, v46
    v_mfma_f32_16x16x32_bf16 v[60:63], v[160:163], a[76:79], v[60:63]
    v_mul_f32 v195, s50, v47
    v_exp_f32 v192, v192
    v_mfma_f32_16x16x32_bf16 v[60:63], v[164:167], a[92:95], v[60:63]
    v_exp_f32 v193, v193
    s_waitcnt lgkmcnt(0) vmcnt(12)
    s_barrier
    v_mfma_f32_16x16x32_bf16 v[48:51], v[168:171], a[96:99], v[48:51]
    s_add_u32 m0, s46, 0
    s_add_u32 s44, s47, 3539840
    buffer_load_dwordx4 v8, s[16:19], s44 offen offset:0 lds
    v_exp_f32 v194, v194
    v_mfma_f32_16x16x32_bf16 v[48:51], v[172:175], a[112:115], v[48:51]
    ds_read_b64_tr_b16 v[144:145], v16 offset:24576
    v_mfma_f32_16x16x32_bf16 v[52:55], v[168:171], a[100:103], v[52:55]
    ds_read_b64_tr_b16 v[146:147], v16 offset:26624
    v_exp_f32 v195, v195
    v_mfma_f32_16x16x32_bf16 v[52:55], v[172:175], a[116:119], v[52:55]
    buffer_load_dwordx4 v9, s[16:19], s44 offen offset:1024 lds
    v_mfma_f32_16x16x32_bf16 v[56:59], v[168:171], a[104:107], v[56:59]
    ds_read_b64_tr_b16 v[148:149], v16 offset:28672
    v_add_f32 v192, 1.0, v192
    v_mfma_f32_16x16x32_bf16 v[56:59], v[172:175], a[120:123], v[56:59]
    ds_read_b64_tr_b16 v[150:151], v16 offset:30720
    v_mfma_f32_16x16x32_bf16 v[60:63], v[168:171], a[108:111], v[60:63]
    buffer_load_dwordx4 v10, s[16:19], s44 offen offset:2048 lds
    v_mfma_f32_16x16x32_bf16 v[60:63], v[172:175], a[124:127], v[60:63]
    ds_read_b64_tr_b16 v[152:153], v16 offset:32768
    v_add_f32 v193, 1.0, v193
    v_mfma_f32_16x16x32_bf16 v[48:51], v[176:179], a[128:131], v[48:51]
    ds_read_b64_tr_b16 v[154:155], v16 offset:34816
    v_mfma_f32_16x16x32_bf16 v[48:51], v[180:183], a[144:147], v[48:51]
    s_add_u32 m0, s46, 3072
    s_add_u32 s45, s47, 3761024
    buffer_load_dwordx4 v8, s[16:19], s45 offen offset:0 lds
    v_add_f32 v194, 1.0, v194
    v_mfma_f32_16x16x32_bf16 v[52:55], v[176:179], a[132:135], v[52:55]
    ds_read_b64_tr_b16 v[156:157], v16 offset:36864
    v_mfma_f32_16x16x32_bf16 v[52:55], v[180:183], a[148:151], v[52:55]
    ds_read_b64_tr_b16 v[158:159], v16 offset:38912
    v_mfma_f32_16x16x32_bf16 v[56:59], v[176:179], a[136:139], v[56:59]
    buffer_load_dwordx4 v9, s[16:19], s45 offen offset:1024 lds
    v_add_f32 v195, 1.0, v195
    v_mfma_f32_16x16x32_bf16 v[56:59], v[180:183], a[152:155], v[56:59]
    ds_read_b64_tr_b16 v[160:161], v16 offset:40960
    v_mfma_f32_16x16x32_bf16 v[60:63], v[176:179], a[140:143], v[60:63]
    ds_read_b64_tr_b16 v[162:163], v16 offset:43008
    v_rcp_f32 v192, v192
    v_mfma_f32_16x16x32_bf16 v[60:63], v[180:183], a[156:159], v[60:63]
    buffer_load_dwordx4 v10, s[16:19], s45 offen offset:2048 lds
    v_mfma_f32_16x16x32_bf16 v[48:51], v[184:187], a[160:163], v[48:51]
    ds_read_b64_tr_b16 v[164:165], v16 offset:45056
    v_rcp_f32 v193, v193
    v_mfma_f32_16x16x32_bf16 v[48:51], v[188:191], a[176:179], v[48:51]
    ds_read_b64_tr_b16 v[166:167], v16 offset:47104
    v_mfma_f32_16x16x32_bf16 v[52:55], v[184:187], a[164:167], v[52:55]
    v_rcp_f32 v194, v194
    v_mfma_f32_16x16x32_bf16 v[52:55], v[188:191], a[180:183], v[52:55]
    v_rcp_f32 v195, v195
    v_mul_f32 v44, v192, v44
    v_mfma_f32_16x16x32_bf16 v[56:59], v[184:187], a[168:171], v[56:59]
    v_mul_f32 v45, v193, v45
    v_mfma_f32_16x16x32_bf16 v[56:59], v[188:191], a[184:187], v[56:59]
    v_mul_f32 v46, v194, v46
    v_mul_f32 v47, v195, v47
    v_mfma_f32_16x16x32_bf16 v[60:63], v[184:187], a[172:175], v[60:63]
    v_mul_f32 v32, v32, v64
    v_mfma_f32_16x16x32_bf16 v[60:63], v[188:191], a[188:191], v[60:63]
    v_mul_f32 v33, v33, v65
    s_waitcnt lgkmcnt(0) vmcnt(12)
    s_barrier
    v_mfma_f32_16x16x32_bf16 v[48:51], v[144:147], a[192:195], v[48:51]
    s_add_u32 m0, s46, 122880
    s_add_u32 s44, s47, 1024
    buffer_load_dwordx4 v8, s[12:15], s44 offen offset:0 lds
    v_mul_f32 v34, v34, v66
    v_mfma_f32_16x16x32_bf16 v[48:51], v[148:151], a[208:211], v[48:51]
    ds_read_b64_tr_b16 v[168:169], v14 offset:24576
    v_mul_f32 v35, v35, v67
    v_mfma_f32_16x16x32_bf16 v[52:55], v[144:147], a[196:199], v[52:55]
    ds_read_b64_tr_b16 v[170:171], v14 offset:26624
    v_mfma_f32_16x16x32_bf16 v[52:55], v[148:151], a[212:215], v[52:55]
    buffer_load_dwordx4 v9, s[12:15], s44 offen offset:1024 lds
    v_cvt_pk_bf16_f32 v96, v32, v33
    v_mfma_f32_16x16x32_bf16 v[56:59], v[144:147], a[200:203], v[56:59]
    ds_read_b64_tr_b16 v[172:173], v14 offset:28672
    v_cvt_pk_bf16_f32 v97, v34, v35
    v_mfma_f32_16x16x32_bf16 v[56:59], v[148:151], a[216:219], v[56:59]
    ds_read_b64_tr_b16 v[174:175], v14 offset:30720
    v_mfma_f32_16x16x32_bf16 v[60:63], v[144:147], a[204:207], v[60:63]
    buffer_load_dwordx4 v10, s[12:15], s44 offen offset:2048 lds
    v_mul_f32 v36, v36, v68
    v_mfma_f32_16x16x32_bf16 v[60:63], v[148:151], a[220:223], v[60:63]
    ds_read_b64_tr_b16 v[176:177], v14 offset:32768
    v_mul_f32 v37, v37, v69
    v_mfma_f32_16x16x32_bf16 v[48:51], v[152:155], a[224:227], v[48:51]
    ds_read_b64_tr_b16 v[178:179], v14 offset:34816
    v_mfma_f32_16x16x32_bf16 v[48:51], v[156:159], a[240:243], v[48:51]
    s_add_u32 m0, s46, 125952
    s_add_u32 s45, s47, 222208
    buffer_load_dwordx4 v8, s[12:15], s45 offen offset:0 lds
    v_mul_f32 v38, v38, v70
    v_mfma_f32_16x16x32_bf16 v[52:55], v[152:155], a[228:231], v[52:55]
    ds_read_b64_tr_b16 v[180:181], v14 offset:36864
    v_mul_f32 v39, v39, v71
    v_mfma_f32_16x16x32_bf16 v[52:55], v[156:159], a[244:247], v[52:55]
    ds_read_b64_tr_b16 v[182:183], v14 offset:38912
    v_mfma_f32_16x16x32_bf16 v[56:59], v[152:155], a[232:235], v[56:59]
    buffer_load_dwordx4 v9, s[12:15], s45 offen offset:1024 lds
    v_cvt_pk_bf16_f32 v98, v36, v37
    v_mfma_f32_16x16x32_bf16 v[56:59], v[156:159], a[248:251], v[56:59]
    ds_read_b64_tr_b16 v[184:185], v14 offset:40960
    v_cvt_pk_bf16_f32 v99, v38, v39
    v_mfma_f32_16x16x32_bf16 v[60:63], v[152:155], a[236:239], v[60:63]
    ds_read_b64_tr_b16 v[186:187], v14 offset:43008
    v_mfma_f32_16x16x32_bf16 v[60:63], v[156:159], a[252:255], v[60:63]
    buffer_load_dwordx4 v10, s[12:15], s45 offen offset:2048 lds
    v_mul_f32 v40, v40, v72
    v_mfma_f32_16x16x32_bf16 v[48:51], v[160:163], v[224:227], v[48:51]
    ds_read_b64_tr_b16 v[188:189], v14 offset:45056
    v_mul_f32 v41, v41, v73
    v_mfma_f32_16x16x32_bf16 v[48:51], v[164:167], v[240:243], v[48:51]
    ds_read_b64_tr_b16 v[190:191], v14 offset:47104
    v_mfma_f32_16x16x32_bf16 v[52:55], v[160:163], v[228:231], v[52:55]
    v_mul_f32 v42, v42, v74
    v_mul_f32 v43, v43, v75
    v_mfma_f32_16x16x32_bf16 v[52:55], v[164:167], v[244:247], v[52:55]
    v_cvt_pk_bf16_f32 v100, v40, v41
    v_cvt_pk_bf16_f32 v101, v42, v43
    v_mfma_f32_16x16x32_bf16 v[56:59], v[160:163], v[232:235], v[56:59]
    v_mul_f32 v44, v44, v76
    v_mfma_f32_16x16x32_bf16 v[56:59], v[164:167], v[248:251], v[56:59]
    v_mul_f32 v45, v45, v77
    v_mul_f32 v46, v46, v78
    v_mfma_f32_16x16x32_bf16 v[60:63], v[160:163], v[236:239], v[60:63]
    v_mul_f32 v47, v47, v79
    v_cvt_pk_bf16_f32 v102, v44, v45
    v_mfma_f32_16x16x32_bf16 v[60:63], v[164:167], v[252:255], v[60:63]
    v_cvt_pk_bf16_f32 v103, v46, v47
    s_waitcnt lgkmcnt(0) vmcnt(12)
    s_barrier
    v_mfma_f32_16x16x32_bf16 v[80:83], v[168:171], a[0:3], 0
    s_add_u32 m0, s46, 24576
    s_add_u32 s44, s47, 1770496
    buffer_load_dwordx4 v8, s[12:15], s44 offen offset:0 lds
    ds_read_b64_tr_b16 v[144:145], v15 offset:0
    v_mfma_f32_16x16x32_bf16 v[80:83], v[172:175], a[16:19], v[80:83]
    ds_read_b64_tr_b16 v[146:147], v15 offset:2048
    v_mfma_f32_16x16x32_bf16 v[84:87], v[168:171], a[4:7], 0
    buffer_load_dwordx4 v9, s[12:15], s44 offen offset:1024 lds
    v_mul_f32 v192, s50, v48
    v_mfma_f32_16x16x32_bf16 v[84:87], v[172:175], a[20:23], v[84:87]
    ds_read_b64_tr_b16 v[148:149], v15 offset:4096
    v_mfma_f32_16x16x32_bf16 v[88:91], v[168:171], a[8:11], 0
    ds_read_b64_tr_b16 v[150:151], v15 offset:6144
    v_mul_f32 v193, s50, v49
    v_mfma_f32_16x16x32_bf16 v[88:91], v[172:175], a[24:27], v[88:91]
    buffer_load_dwordx4 v10, s[12:15], s44 offen offset:2048 lds
    v_mfma_f32_16x16x32_bf16 v[92:95], v[168:171], a[12:15], 0
    ds_read_b64_tr_b16 v[152:153], v15 offset:8192
    v_mul_f32 v194, s50, v50
    v_mfma_f32_16x16x32_bf16 v[92:95], v[172:175], a[28:31], v[92:95]
    ds_read_b64_tr_b16 v[154:155], v15 offset:10240
    v_mfma_f32_16x16x32_bf16 v[80:83], v[176:179], a[32:35], v[80:83]
    s_add_u32 m0, s46, 27648
    s_add_u32 s45, s47, 1991680
    buffer_load_dwordx4 v8, s[12:15], s45 offen offset:0 lds
    v_mul_f32 v195, s50, v51
    v_mfma_f32_16x16x32_bf16 v[80:83], v[180:183], a[48:51], v[80:83]
    ds_read_b64_tr_b16 v[156:157], v15 offset:12288
    v_mfma_f32_16x16x32_bf16 v[84:87], v[176:179], a[36:39], v[84:87]
    ds_read_b64_tr_b16 v[158:159], v15 offset:14336
    v_exp_f32 v192, v192
    v_mfma_f32_16x16x32_bf16 v[84:87], v[180:183], a[52:55], v[84:87]
    buffer_load_dwordx4 v9, s[12:15], s45 offen offset:1024 lds
    v_mfma_f32_16x16x32_bf16 v[88:91], v[176:179], a[40:43], v[88:91]
    ds_read_b64_tr_b16 v[160:161], v15 offset:16384
    v_mfma_f32_16x16x32_bf16 v[88:91], v[180:183], a[56:59], v[88:91]
    ds_read_b64_tr_b16 v[162:163], v15 offset:18432
    v_exp_f32 v193, v193
    v_mfma_f32_16x16x32_bf16 v[92:95], v[176:179], a[44:47], v[92:95]
    buffer_load_dwordx4 v10, s[12:15], s45 offen offset:2048 lds
    v_mfma_f32_16x16x32_bf16 v[92:95], v[180:183], a[60:63], v[92:95]
    ds_read_b64_tr_b16 v[164:165], v15 offset:20480
    v_exp_f32 v194, v194
    v_mfma_f32_16x16x32_bf16 v[80:83], v[184:187], a[64:67], v[80:83]
    ds_read_b64_tr_b16 v[166:167], v15 offset:22528
    v_mfma_f32_16x16x32_bf16 v[80:83], v[188:191], a[80:83], v[80:83]
    buffer_load_dword v6, v5, s[28:31], s48 offen offset:384
    v_exp_f32 v195, v195
    v_mfma_f32_16x16x32_bf16 v[84:87], v[184:187], a[68:71], v[84:87]
    v_add_f32 v192, 1.0, v192
    v_mfma_f32_16x16x32_bf16 v[84:87], v[188:191], a[84:87], v[84:87]
    v_add_f32 v193, 1.0, v193
    v_add_f32 v194, 1.0, v194
    v_mfma_f32_16x16x32_bf16 v[88:91], v[184:187], a[72:75], v[88:91]
    v_add_f32 v195, 1.0, v195
    v_mfma_f32_16x16x32_bf16 v[88:91], v[188:191], a[88:91], v[88:91]
    v_rcp_f32 v192, v192
    v_rcp_f32 v193, v193
    v_mfma_f32_16x16x32_bf16 v[92:95], v[184:187], a[76:79], v[92:95]
    v_rcp_f32 v194, v194
    v_mfma_f32_16x16x32_bf16 v[92:95], v[188:191], a[92:95], v[92:95]
    v_rcp_f32 v195, v195
    s_waitcnt lgkmcnt(0) vmcnt(13)
    s_barrier
    v_mfma_f32_16x16x32_bf16 v[80:83], v[144:147], a[96:99], v[80:83]
    s_add_u32 m0, s46, 49152
    s_add_u32 s44, s47, 3539968
    buffer_load_dwordx4 v8, s[12:15], s44 offen offset:0 lds
    v_mul_f32 v48, v192, v48
    v_mfma_f32_16x16x32_bf16 v[80:83], v[148:151], a[112:115], v[80:83]
    ds_read_b64_tr_b16 v[168:169], v14 offset:0
    v_mfma_f32_16x16x32_bf16 v[84:87], v[144:147], a[100:103], v[84:87]
    ds_read_b64_tr_b16 v[170:171], v14 offset:2048
    v_mul_f32 v49, v193, v49
    v_mfma_f32_16x16x32_bf16 v[84:87], v[148:151], a[116:119], v[84:87]
    buffer_load_dwordx4 v9, s[12:15], s44 offen offset:1024 lds
    v_mfma_f32_16x16x32_bf16 v[88:91], v[144:147], a[104:107], v[88:91]
    ds_read_b64_tr_b16 v[172:173], v14 offset:4096
    v_mul_f32 v50, v194, v50
    v_mfma_f32_16x16x32_bf16 v[88:91], v[148:151], a[120:123], v[88:91]
    ds_read_b64_tr_b16 v[174:175], v14 offset:6144
    v_mfma_f32_16x16x32_bf16 v[92:95], v[144:147], a[108:111], v[92:95]
    buffer_load_dwordx4 v10, s[12:15], s44 offen offset:2048 lds
    v_mul_f32 v51, v195, v51
    v_mfma_f32_16x16x32_bf16 v[92:95], v[148:151], a[124:127], v[92:95]
    ds_read_b64_tr_b16 v[176:177], v14 offset:8192
    v_mfma_f32_16x16x32_bf16 v[80:83], v[152:155], a[128:131], v[80:83]
    ds_read_b64_tr_b16 v[178:179], v14 offset:10240
    v_mul_f32 v196, s50, v52
    v_mfma_f32_16x16x32_bf16 v[80:83], v[156:159], a[144:147], v[80:83]
    s_add_u32 m0, s46, 52224
    s_add_u32 s45, s47, 3761152
    buffer_load_dwordx4 v8, s[12:15], s45 offen offset:0 lds
    v_mfma_f32_16x16x32_bf16 v[84:87], v[152:155], a[132:135], v[84:87]
    ds_read_b64_tr_b16 v[180:181], v14 offset:12288
    v_mul_f32 v197, s50, v53
    v_mfma_f32_16x16x32_bf16 v[84:87], v[156:159], a[148:151], v[84:87]
    ds_read_b64_tr_b16 v[182:183], v14 offset:14336
    v_mfma_f32_16x16x32_bf16 v[88:91], v[152:155], a[136:139], v[88:91]
    buffer_load_dwordx4 v9, s[12:15], s45 offen offset:1024 lds
    v_mfma_f32_16x16x32_bf16 v[88:91], v[156:159], a[152:155], v[88:91]
    ds_read_b64_tr_b16 v[184:185], v14 offset:16384
    v_mul_f32 v198, s50, v54
    v_mfma_f32_16x16x32_bf16 v[92:95], v[152:155], a[140:143], v[92:95]
    ds_read_b64_tr_b16 v[186:187], v14 offset:18432
    v_mfma_f32_16x16x32_bf16 v[92:95], v[156:159], a[156:159], v[92:95]
    buffer_load_dwordx4 v10, s[12:15], s45 offen offset:2048 lds
    v_mul_f32 v199, s50, v55
    v_mfma_f32_16x16x32_bf16 v[80:83], v[160:163], a[160:163], v[80:83]
    ds_read_b64_tr_b16 v[188:189], v14 offset:20480
    v_mfma_f32_16x16x32_bf16 v[80:83], v[164:167], a[176:179], v[80:83]
    ds_read_b64_tr_b16 v[190:191], v14 offset:22528
    v_exp_f32 v196, v196
    v_mfma_f32_16x16x32_bf16 v[84:87], v[160:163], a[164:167], v[84:87]
    v_exp_f32 v197, v197
    v_mfma_f32_16x16x32_bf16 v[84:87], v[164:167], a[180:183], v[84:87]
    v_exp_f32 v198, v198
    v_exp_f32 v199, v199
    v_mfma_f32_16x16x32_bf16 v[88:91], v[160:163], a[168:171], v[88:91]
    v_add_f32 v196, 1.0, v196
    v_mfma_f32_16x16x32_bf16 v[88:91], v[164:167], a[184:187], v[88:91]
    v_add_f32 v197, 1.0, v197
    v_add_f32 v198, 1.0, v198
    v_mfma_f32_16x16x32_bf16 v[92:95], v[160:163], a[172:175], v[92:95]
    v_add_f32 v199, 1.0, v199
    v_mfma_f32_16x16x32_bf16 v[92:95], v[164:167], a[188:191], v[92:95]
    v_rcp_f32 v196, v196
    s_waitcnt lgkmcnt(0) vmcnt(13)
    s_barrier
    v_mfma_f32_16x16x32_bf16 v[80:83], v[168:171], a[192:195], v[80:83]
    s_add_u32 m0, s46, 0
    s_add_u32 s44, s47, 1024
    buffer_load_dwordx4 v8, s[16:19], s44 offen offset:0 lds
    v_rcp_f32 v197, v197
    v_mfma_f32_16x16x32_bf16 v[80:83], v[172:175], a[208:211], v[80:83]
    ds_read_b64_tr_b16 v[144:145], v16 offset:24576
    v_mfma_f32_16x16x32_bf16 v[84:87], v[168:171], a[196:199], v[84:87]
    ds_read_b64_tr_b16 v[146:147], v16 offset:26624
    v_rcp_f32 v198, v198
    v_mfma_f32_16x16x32_bf16 v[84:87], v[172:175], a[212:215], v[84:87]
    buffer_load_dwordx4 v9, s[16:19], s44 offen offset:1024 lds
    v_mfma_f32_16x16x32_bf16 v[88:91], v[168:171], a[200:203], v[88:91]
    ds_read_b64_tr_b16 v[148:149], v16 offset:28672
    v_mfma_f32_16x16x32_bf16 v[88:91], v[172:175], a[216:219], v[88:91]
    ds_read_b64_tr_b16 v[150:151], v16 offset:30720
    v_rcp_f32 v199, v199
    v_mfma_f32_16x16x32_bf16 v[92:95], v[168:171], a[204:207], v[92:95]
    buffer_load_dwordx4 v10, s[16:19], s44 offen offset:2048 lds
    v_mfma_f32_16x16x32_bf16 v[92:95], v[172:175], a[220:223], v[92:95]
    ds_read_b64_tr_b16 v[152:153], v16 offset:32768
    v_mfma_f32_16x16x32_bf16 v[80:83], v[176:179], a[224:227], v[80:83]
    ds_read_b64_tr_b16 v[154:155], v16 offset:34816
    v_mul_f32 v52, v196, v52
    v_mfma_f32_16x16x32_bf16 v[80:83], v[180:183], a[240:243], v[80:83]
    s_add_u32 m0, s46, 3072
    s_add_u32 s45, s47, 222208
    buffer_load_dwordx4 v8, s[16:19], s45 offen offset:0 lds
    v_mfma_f32_16x16x32_bf16 v[84:87], v[176:179], a[228:231], v[84:87]
    ds_read_b64_tr_b16 v[156:157], v16 offset:36864
    v_mul_f32 v53, v197, v53
    v_mfma_f32_16x16x32_bf16 v[84:87], v[180:183], a[244:247], v[84:87]
    ds_read_b64_tr_b16 v[158:159], v16 offset:38912
    v_mfma_f32_16x16x32_bf16 v[88:91], v[176:179], a[232:235], v[88:91]
    buffer_load_dwordx4 v9, s[16:19], s45 offen offset:1024 lds
    v_mfma_f32_16x16x32_bf16 v[88:91], v[180:183], a[248:251], v[88:91]
    ds_read_b64_tr_b16 v[160:161], v16 offset:40960
    v_mul_f32 v54, v198, v54
    v_mfma_f32_16x16x32_bf16 v[92:95], v[176:179], a[236:239], v[92:95]
    ds_read_b64_tr_b16 v[162:163], v16 offset:43008
    v_mfma_f32_16x16x32_bf16 v[92:95], v[180:183], a[252:255], v[92:95]
    buffer_load_dwordx4 v10, s[16:19], s45 offen offset:2048 lds
    v_mfma_f32_16x16x32_bf16 v[80:83], v[184:187], v[224:227], v[80:83]
    ds_read_b64_tr_b16 v[164:165], v16 offset:45056
    v_mul_f32 v55, v199, v55
    v_mfma_f32_16x16x32_bf16 v[80:83], v[188:191], v[240:243], v[80:83]
    ds_read_b64_tr_b16 v[166:167], v16 offset:47104
    v_mfma_f32_16x16x32_bf16 v[84:87], v[184:187], v[228:231], v[84:87]
    v_mul_f32 v200, s50, v56
    v_mul_f32 v201, s50, v57
    v_mfma_f32_16x16x32_bf16 v[84:87], v[188:191], v[244:247], v[84:87]
    v_mul_f32 v202, s50, v58
    v_mfma_f32_16x16x32_bf16 v[88:91], v[184:187], v[232:235], v[88:91]
    v_mul_f32 v203, s50, v59
    v_mfma_f32_16x16x32_bf16 v[88:91], v[188:191], v[248:251], v[88:91]
    v_exp_f32 v200, v200
    v_exp_f32 v201, v201
    v_mfma_f32_16x16x32_bf16 v[92:95], v[184:187], v[236:239], v[92:95]
    v_exp_f32 v202, v202
    v_mfma_f32_16x16x32_bf16 v[92:95], v[188:191], v[252:255], v[92:95]
    v_exp_f32 v203, v203
    s_waitcnt lgkmcnt(0) vmcnt(13)
    s_barrier
    v_mfma_f32_16x16x32_bf16 v[32:35], v[144:147], a[0:3], 0
    s_add_u32 m0, s46, 122880
    s_add_u32 s44, s47, 1770496
    buffer_load_dwordx4 v8, s[16:19], s44 offen offset:0 lds
    v_add_f32 v200, 1.0, v200
    v_mfma_f32_16x16x32_bf16 v[32:35], v[148:151], a[16:19], v[32:35]
    ds_read_b64_tr_b16 v[168:169], v14 offset:24576
    v_mfma_f32_16x16x32_bf16 v[36:39], v[144:147], a[4:7], 0
    ds_read_b64_tr_b16 v[170:171], v14 offset:26624
    v_add_f32 v201, 1.0, v201
    v_mfma_f32_16x16x32_bf16 v[36:39], v[148:151], a[20:23], v[36:39]
    buffer_load_dwordx4 v9, s[16:19], s44 offen offset:1024 lds
    v_mfma_f32_16x16x32_bf16 v[40:43], v[144:147], a[8:11], 0
    ds_read_b64_tr_b16 v[172:173], v14 offset:28672
    v_add_f32 v202, 1.0, v202
    v_mfma_f32_16x16x32_bf16 v[40:43], v[148:151], a[24:27], v[40:43]
    ds_read_b64_tr_b16 v[174:175], v14 offset:30720
    v_mfma_f32_16x16x32_bf16 v[44:47], v[144:147], a[12:15], 0
    buffer_load_dwordx4 v10, s[16:19], s44 offen offset:2048 lds
    v_add_f32 v203, 1.0, v203
    v_mfma_f32_16x16x32_bf16 v[44:47], v[148:151], a[28:31], v[44:47]
    ds_read_b64_tr_b16 v[176:177], v14 offset:32768
    v_mfma_f32_16x16x32_bf16 v[32:35], v[152:155], a[32:35], v[32:35]
    ds_read_b64_tr_b16 v[178:179], v14 offset:34816
    v_rcp_f32 v200, v200
    v_mfma_f32_16x16x32_bf16 v[32:35], v[156:159], a[48:51], v[32:35]
    s_add_u32 m0, s46, 125952
    s_add_u32 s45, s47, 1991680
    buffer_load_dwordx4 v8, s[16:19], s45 offen offset:0 lds
    v_mfma_f32_16x16x32_bf16 v[36:39], v[152:155], a[36:39], v[36:39]
    ds_read_b64_tr_b16 v[180:181], v14 offset:36864
    v_rcp_f32 v201, v201
    v_mfma_f32_16x16x32_bf16 v[36:39], v[156:159], a[52:55], v[36:39]
    ds_read_b64_tr_b16 v[182:183], v14 offset:38912
    v_mfma_f32_16x16x32_bf16 v[40:43], v[152:155], a[40:43], v[40:43]
    buffer_load_dwordx4 v9, s[16:19], s45 offen offset:1024 lds
    v_rcp_f32 v202, v202
    v_mfma_f32_16x16x32_bf16 v[40:43], v[156:159], a[56:59], v[40:43]
    ds_read_b64_tr_b16 v[184:185], v14 offset:40960
    v_mfma_f32_16x16x32_bf16 v[44:47], v[152:155], a[44:47], v[44:47]
    ds_read_b64_tr_b16 v[186:187], v14 offset:43008
    v_rcp_f32 v203, v203
    v_mfma_f32_16x16x32_bf16 v[44:47], v[156:159], a[60:63], v[44:47]
    buffer_load_dwordx4 v10, s[16:19], s45 offen offset:2048 lds
    v_mfma_f32_16x16x32_bf16 v[32:35], v[160:163], a[64:67], v[32:35]
    ds_read_b64_tr_b16 v[188:189], v14 offset:45056
    v_mul_f32 v56, v200, v56
    v_mfma_f32_16x16x32_bf16 v[32:35], v[164:167], a[80:83], v[32:35]
    ds_read_b64_tr_b16 v[190:191], v14 offset:47104
    v_mfma_f32_16x16x32_bf16 v[36:39], v[160:163], a[68:71], v[36:39]
    v_mul_f32 v57, v201, v57
    v_mul_f32 v58, v202, v58
    v_mfma_f32_16x16x32_bf16 v[36:39], v[164:167], a[84:87], v[36:39]
    v_mul_f32 v59, v203, v59
    v_mfma_f32_16x16x32_bf16 v[40:43], v[160:163], a[72:75], v[40:43]
    v_mul_f32 v192, s50, v60
    v_mul_f32 v193, s50, v61
    v_mfma_f32_16x16x32_bf16 v[40:43], v[164:167], a[88:91], v[40:43]
    v_mul_f32 v194, s50, v62
    v_mfma_f32_16x16x32_bf16 v[44:47], v[160:163], a[76:79], v[44:47]
    v_mul_f32 v195, s50, v63
    v_exp_f32 v192, v192
    v_mfma_f32_16x16x32_bf16 v[44:47], v[164:167], a[92:95], v[44:47]
    v_exp_f32 v193, v193
    s_waitcnt lgkmcnt(0) vmcnt(12)
    s_barrier
    v_mfma_f32_16x16x32_bf16 v[32:35], v[168:171], a[96:99], v[32:35]
    s_add_u32 m0, s46, 24576
    s_add_u32 s44, s47, 3539968
    buffer_load_dwordx4 v8, s[16:19], s44 offen offset:0 lds
    v_exp_f32 v194, v194
    v_mfma_f32_16x16x32_bf16 v[32:35], v[172:175], a[112:115], v[32:35]
    ds_read_b64_tr_b16 v[144:145], v15 offset:0
    v_mfma_f32_16x16x32_bf16 v[36:39], v[168:171], a[100:103], v[36:39]
    ds_read_b64_tr_b16 v[146:147], v15 offset:2048
    v_exp_f32 v195, v195
    v_mfma_f32_16x16x32_bf16 v[36:39], v[172:175], a[116:119], v[36:39]
    buffer_load_dwordx4 v9, s[16:19], s44 offen offset:1024 lds
    v_mfma_f32_16x16x32_bf16 v[40:43], v[168:171], a[104:107], v[40:43]
    ds_read_b64_tr_b16 v[148:149], v15 offset:4096
    v_add_f32 v192, 1.0, v192
    v_mfma_f32_16x16x32_bf16 v[40:43], v[172:175], a[120:123], v[40:43]
    ds_read_b64_tr_b16 v[150:151], v15 offset:6144
    v_mfma_f32_16x16x32_bf16 v[44:47], v[168:171], a[108:111], v[44:47]
    buffer_load_dwordx4 v10, s[16:19], s44 offen offset:2048 lds
    v_mfma_f32_16x16x32_bf16 v[44:47], v[172:175], a[124:127], v[44:47]
    ds_read_b64_tr_b16 v[152:153], v15 offset:8192
    v_add_f32 v193, 1.0, v193
    v_mfma_f32_16x16x32_bf16 v[32:35], v[176:179], a[128:131], v[32:35]
    ds_read_b64_tr_b16 v[154:155], v15 offset:10240
    v_mfma_f32_16x16x32_bf16 v[32:35], v[180:183], a[144:147], v[32:35]
    s_add_u32 m0, s46, 27648
    s_add_u32 s45, s47, 3761152
    buffer_load_dwordx4 v8, s[16:19], s45 offen offset:0 lds
    v_add_f32 v194, 1.0, v194
    v_mfma_f32_16x16x32_bf16 v[36:39], v[176:179], a[132:135], v[36:39]
    ds_read_b64_tr_b16 v[156:157], v15 offset:12288
    v_mfma_f32_16x16x32_bf16 v[36:39], v[180:183], a[148:151], v[36:39]
    ds_read_b64_tr_b16 v[158:159], v15 offset:14336
    v_mfma_f32_16x16x32_bf16 v[40:43], v[176:179], a[136:139], v[40:43]
    buffer_load_dwordx4 v9, s[16:19], s45 offen offset:1024 lds
    v_add_f32 v195, 1.0, v195
    v_mfma_f32_16x16x32_bf16 v[40:43], v[180:183], a[152:155], v[40:43]
    ds_read_b64_tr_b16 v[160:161], v15 offset:16384
    v_mfma_f32_16x16x32_bf16 v[44:47], v[176:179], a[140:143], v[44:47]
    ds_read_b64_tr_b16 v[162:163], v15 offset:18432
    v_rcp_f32 v192, v192
    v_mfma_f32_16x16x32_bf16 v[44:47], v[180:183], a[156:159], v[44:47]
    buffer_load_dwordx4 v10, s[16:19], s45 offen offset:2048 lds
    v_mfma_f32_16x16x32_bf16 v[32:35], v[184:187], a[160:163], v[32:35]
    ds_read_b64_tr_b16 v[164:165], v15 offset:20480
    v_rcp_f32 v193, v193
    v_mfma_f32_16x16x32_bf16 v[32:35], v[188:191], a[176:179], v[32:35]
    ds_read_b64_tr_b16 v[166:167], v15 offset:22528
    v_mfma_f32_16x16x32_bf16 v[36:39], v[184:187], a[164:167], v[36:39]
    v_rcp_f32 v194, v194
    v_mfma_f32_16x16x32_bf16 v[36:39], v[188:191], a[180:183], v[36:39]
    v_rcp_f32 v195, v195
    v_mul_f32 v60, v192, v60
    v_mfma_f32_16x16x32_bf16 v[40:43], v[184:187], a[168:171], v[40:43]
    v_mul_f32 v61, v193, v61
    v_mfma_f32_16x16x32_bf16 v[40:43], v[188:191], a[184:187], v[40:43]
    v_mul_f32 v62, v194, v62
    v_mul_f32 v63, v195, v63
    v_mfma_f32_16x16x32_bf16 v[44:47], v[184:187], a[172:175], v[44:47]
    v_mul_f32 v48, v48, v80
    v_mfma_f32_16x16x32_bf16 v[44:47], v[188:191], a[188:191], v[44:47]
    v_mul_f32 v49, v49, v81
    s_waitcnt lgkmcnt(0) vmcnt(12)
    s_barrier
    v_mfma_f32_16x16x32_bf16 v[32:35], v[144:147], a[192:195], v[32:35]
    s_add_u32 m0, s46, 49152
    s_add_u32 s44, s48, 0
    buffer_load_dwordx4 v11, s[28:31], s44 offen offset:0 lds
    v_mul_f32 v50, v50, v82
    v_mfma_f32_16x16x32_bf16 v[32:35], v[148:151], a[208:211], v[32:35]
    ds_read_b64_tr_b16 v[168:169], v14 offset:0
    v_mul_f32 v51, v51, v83
    v_mfma_f32_16x16x32_bf16 v[36:39], v[144:147], a[196:199], v[36:39]
    ds_read_b64_tr_b16 v[170:171], v14 offset:2048
    v_mfma_f32_16x16x32_bf16 v[36:39], v[148:151], a[212:215], v[36:39]
    buffer_load_dwordx4 v12, s[28:31], s44 offen offset:1024 lds
    v_cvt_pk_bf16_f32 v104, v48, v49
    v_mfma_f32_16x16x32_bf16 v[40:43], v[144:147], a[200:203], v[40:43]
    ds_read_b64_tr_b16 v[172:173], v14 offset:4096
    v_cvt_pk_bf16_f32 v105, v50, v51
    v_mfma_f32_16x16x32_bf16 v[40:43], v[148:151], a[216:219], v[40:43]
    ds_read_b64_tr_b16 v[174:175], v14 offset:6144
    v_mfma_f32_16x16x32_bf16 v[44:47], v[144:147], a[204:207], v[44:47]
    buffer_load_dwordx4 v13, s[28:31], s44 offen offset:2048 lds
    v_mul_f32 v52, v52, v84
    v_mfma_f32_16x16x32_bf16 v[44:47], v[148:151], a[220:223], v[44:47]
    ds_read_b64_tr_b16 v[176:177], v14 offset:8192
    v_mul_f32 v53, v53, v85
    v_mfma_f32_16x16x32_bf16 v[32:35], v[152:155], a[224:227], v[32:35]
    ds_read_b64_tr_b16 v[178:179], v14 offset:10240
    v_mfma_f32_16x16x32_bf16 v[32:35], v[156:159], a[240:243], v[32:35]
    s_add_u32 m0, s46, 52224
    s_add_u32 s45, s48, 27648
    buffer_load_dwordx4 v11, s[28:31], s45 offen offset:0 lds
    v_mul_f32 v54, v54, v86
    v_mfma_f32_16x16x32_bf16 v[36:39], v[152:155], a[228:231], v[36:39]
    ds_read_b64_tr_b16 v[180:181], v14 offset:12288
    v_mul_f32 v55, v55, v87
    v_mfma_f32_16x16x32_bf16 v[36:39], v[156:159], a[244:247], v[36:39]
    ds_read_b64_tr_b16 v[182:183], v14 offset:14336
    v_mfma_f32_16x16x32_bf16 v[40:43], v[152:155], a[232:235], v[40:43]
    buffer_load_dwordx4 v12, s[28:31], s45 offen offset:1024 lds
    v_cvt_pk_bf16_f32 v106, v52, v53
    v_mfma_f32_16x16x32_bf16 v[40:43], v[156:159], a[248:251], v[40:43]
    ds_read_b64_tr_b16 v[184:185], v14 offset:16384
    v_cvt_pk_bf16_f32 v107, v54, v55
    v_mfma_f32_16x16x32_bf16 v[44:47], v[152:155], a[236:239], v[44:47]
    ds_read_b64_tr_b16 v[186:187], v14 offset:18432
    v_mfma_f32_16x16x32_bf16 v[44:47], v[156:159], a[252:255], v[44:47]
    buffer_load_dwordx4 v13, s[28:31], s45 offen offset:2048 lds
    v_mul_f32 v56, v56, v88
    v_mfma_f32_16x16x32_bf16 v[32:35], v[160:163], v[224:227], v[32:35]
    ds_read_b64_tr_b16 v[188:189], v14 offset:20480
    v_mul_f32 v57, v57, v89
    v_mfma_f32_16x16x32_bf16 v[32:35], v[164:167], v[240:243], v[32:35]
    ds_read_b64_tr_b16 v[190:191], v14 offset:22528
    v_mfma_f32_16x16x32_bf16 v[36:39], v[160:163], v[228:231], v[36:39]
    v_mul_f32 v58, v58, v90
    v_mul_f32 v59, v59, v91
    v_mfma_f32_16x16x32_bf16 v[36:39], v[164:167], v[244:247], v[36:39]
    v_cvt_pk_bf16_f32 v108, v56, v57
    v_cvt_pk_bf16_f32 v109, v58, v59
    v_mfma_f32_16x16x32_bf16 v[40:43], v[160:163], v[232:235], v[40:43]
    v_mul_f32 v60, v60, v92
    v_mfma_f32_16x16x32_bf16 v[40:43], v[164:167], v[248:251], v[40:43]
    v_mul_f32 v61, v61, v93
    v_mul_f32 v62, v62, v94
    v_mfma_f32_16x16x32_bf16 v[44:47], v[160:163], v[236:239], v[44:47]
    v_mul_f32 v63, v63, v95
    v_cvt_pk_bf16_f32 v110, v60, v61
    v_mfma_f32_16x16x32_bf16 v[44:47], v[164:167], v[252:255], v[44:47]
    v_cvt_pk_bf16_f32 v111, v62, v63
    s_waitcnt lgkmcnt(0) vmcnt(12)
    s_barrier
    v_mfma_f32_16x16x32_bf16 v[64:67], v[168:171], a[0:3], 0
    s_add_u32 m0, s46, 0
    s_add_u32 s44, s48, 221184
    buffer_load_dwordx4 v11, s[28:31], s44 offen offset:0 lds
    v_mul_f32 v192, s50, v32
    v_mfma_f32_16x16x32_bf16 v[64:67], v[172:175], a[16:19], v[64:67]
    ds_read_b64_tr_b16 v[144:145], v16 offset:24576
    v_mfma_f32_16x16x32_bf16 v[68:71], v[168:171], a[4:7], 0
    ds_read_b64_tr_b16 v[146:147], v16 offset:26624
    v_mul_f32 v193, s50, v33
    v_mfma_f32_16x16x32_bf16 v[68:71], v[172:175], a[20:23], v[68:71]
    buffer_load_dwordx4 v12, s[28:31], s44 offen offset:1024 lds
    v_mfma_f32_16x16x32_bf16 v[72:75], v[168:171], a[8:11], 0
    ds_read_b64_tr_b16 v[148:149], v16 offset:28672
    v_mul_f32 v194, s50, v34
    v_mfma_f32_16x16x32_bf16 v[72:75], v[172:175], a[24:27], v[72:75]
    ds_read_b64_tr_b16 v[150:151], v16 offset:30720
    v_mfma_f32_16x16x32_bf16 v[76:79], v[168:171], a[12:15], 0
    buffer_load_dwordx4 v13, s[28:31], s44 offen offset:2048 lds
    v_mfma_f32_16x16x32_bf16 v[76:79], v[172:175], a[28:31], v[76:79]
    ds_read_b64_tr_b16 v[152:153], v16 offset:32768
    v_mul_f32 v195, s50, v35
    v_mfma_f32_16x16x32_bf16 v[64:67], v[176:179], a[32:35], v[64:67]
    ds_read_b64_tr_b16 v[154:155], v16 offset:34816
    v_mfma_f32_16x16x32_bf16 v[64:67], v[180:183], a[48:51], v[64:67]
    s_add_u32 m0, s46, 3072
    s_add_u32 s45, s48, 248832
    buffer_load_dwordx4 v11, s[28:31], s45 offen offset:0 lds
    v_exp_f32 v192, v192
    v_mfma_f32_16x16x32_bf16 v[68:71], v[176:179], a[36:39], v[68:71]
    ds_read_b64_tr_b16 v[156:157], v16 offset:36864
    v_mfma_f32_16x16x32_bf16 v[68:71], v[180:183], a[52:55], v[68:71]
    ds_read_b64_tr_b16 v[158:159], v16 offset:38912
    v_mfma_f32_16x16x32_bf16 v[72:75], v[176:179], a[40:43], v[72:75]
    buffer_load_dwordx4 v12, s[28:31], s45 offen offset:1024 lds
    v_exp_f32 v193, v193
    v_mfma_f32_16x16x32_bf16 v[72:75], v[180:183], a[56:59], v[72:75]
    ds_read_b64_tr_b16 v[160:161], v16 offset:40960
    v_mfma_f32_16x16x32_bf16 v[76:79], v[176:179], a[44:47], v[76:79]
    ds_read_b64_tr_b16 v[162:163], v16 offset:43008
    v_exp_f32 v194, v194
    v_mfma_f32_16x16x32_bf16 v[76:79], v[180:183], a[60:63], v[76:79]
    buffer_load_dwordx4 v13, s[28:31], s45 offen offset:2048 lds
    v_mfma_f32_16x16x32_bf16 v[64:67], v[184:187], a[64:67], v[64:67]
    ds_read_b64_tr_b16 v[164:165], v16 offset:45056
    v_exp_f32 v195, v195
    v_mfma_f32_16x16x32_bf16 v[64:67], v[188:191], a[80:83], v[64:67]
    ds_read_b64_tr_b16 v[166:167], v16 offset:47104
    v_mfma_f32_16x16x32_bf16 v[68:71], v[184:187], a[68:71], v[68:71]
    v_add_f32 v192, 1.0, v192
    v_mfma_f32_16x16x32_bf16 v[68:71], v[188:191], a[84:87], v[68:71]
    v_add_f32 v193, 1.0, v193
    v_add_f32 v194, 1.0, v194
    v_mfma_f32_16x16x32_bf16 v[72:75], v[184:187], a[72:75], v[72:75]
    v_add_f32 v195, 1.0, v195
    v_mfma_f32_16x16x32_bf16 v[72:75], v[188:191], a[88:91], v[72:75]
    v_rcp_f32 v192, v192
    v_rcp_f32 v193, v193
    v_mfma_f32_16x16x32_bf16 v[76:79], v[184:187], a[76:79], v[76:79]
    v_rcp_f32 v194, v194
    v_mfma_f32_16x16x32_bf16 v[76:79], v[188:191], a[92:95], v[76:79]
    v_rcp_f32 v195, v195
    s_waitcnt lgkmcnt(0) vmcnt(12)
    s_barrier
    v_mfma_f32_16x16x32_bf16 v[64:67], v[144:147], a[96:99], v[64:67]
    s_add_u32 m0, s46, 122880
    s_add_u32 s44, s48, 128
    buffer_load_dwordx4 v11, s[28:31], s44 offen offset:0 lds
    ds_read_b64_tr_b16 v[168:169], v14 offset:24576
    v_mul_f32 v32, v192, v32
    v_mfma_f32_16x16x32_bf16 v[64:67], v[148:151], a[112:115], v[64:67]
    ds_read_b64_tr_b16 v[170:171], v14 offset:26624
    buffer_load_dwordx4 v12, s[28:31], s44 offen offset:1024 lds
    v_mfma_f32_16x16x32_bf16 v[68:71], v[144:147], a[100:103], v[68:71]
    ds_read_b64_tr_b16 v[172:173], v14 offset:28672
    ds_read_b64_tr_b16 v[174:175], v14 offset:30720
    v_mfma_f32_16x16x32_bf16 v[68:71], v[148:151], a[116:119], v[68:71]
    buffer_load_dwordx4 v13, s[28:31], s44 offen offset:2048 lds
    ds_read_b64_tr_b16 v[176:177], v14 offset:32768
    v_mfma_f32_16x16x32_bf16 v[72:75], v[144:147], a[104:107], v[72:75]
    ds_read_b64_tr_b16 v[178:179], v14 offset:34816
    s_add_u32 m0, s46, 125952
    s_add_u32 s45, s48, 27776
    buffer_load_dwordx4 v11, s[28:31], s45 offen offset:0 lds
    v_mfma_f32_16x16x32_bf16 v[72:75], v[148:151], a[120:123], v[72:75]
    ds_read_b64_tr_b16 v[180:181], v14 offset:36864
    ds_read_b64_tr_b16 v[182:183], v14 offset:38912
    v_mfma_f32_16x16x32_bf16 v[76:79], v[144:147], a[108:111], v[76:79]
    buffer_load_dwordx4 v12, s[28:31], s45 offen offset:1024 lds
    ds_read_b64_tr_b16 v[184:185], v14 offset:40960
    v_mfma_f32_16x16x32_bf16 v[76:79], v[148:151], a[124:127], v[76:79]
    ds_read_b64_tr_b16 v[186:187], v14 offset:43008
    buffer_load_dwordx4 v13, s[28:31], s45 offen offset:2048 lds
    v_mfma_f32_16x16x32_bf16 v[64:67], v[152:155], a[128:131], v[64:67]
    ds_read_b64_tr_b16 v[188:189], v14 offset:45056
    v_mul_f32 v33, v193, v33
    v_mul_f32 v34, v194, v34
    v_mfma_f32_16x16x32_bf16 v[64:67], v[156:159], a[144:147], v[64:67]
    ds_read_b64_tr_b16 v[190:191], v14 offset:47104
    ds_read_b128 a[0:3], v22 offset:0
    v_mfma_f32_16x16x32_bf16 v[68:71], v[152:155], a[132:135], v[68:71]
    ds_read_b128 a[4:7], v22 offset:1024
    ds_read_b128 a[8:11], v22 offset:2048
    v_mfma_f32_16x16x32_bf16 v[68:71], v[156:159], a[148:151], v[68:71]
    ds_read_b128 a[12:15], v22 offset:3072
    ds_read_b128 a[16:19], v22 offset:4096
    v_mfma_f32_16x16x32_bf16 v[72:75], v[152:155], a[136:139], v[72:75]
    ds_read_b128 a[20:23], v22 offset:5120
    ds_read_b128 a[24:27], v22 offset:6144
    v_mfma_f32_16x16x32_bf16 v[72:75], v[156:159], a[152:155], v[72:75]
    ds_read_b128 a[28:31], v22 offset:7168
    ds_read_b128 a[32:35], v22 offset:8192
    v_mfma_f32_16x16x32_bf16 v[76:79], v[152:155], a[140:143], v[76:79]
    ds_read_b128 a[36:39], v22 offset:9216
    ds_read_b128 a[40:43], v22 offset:10240
    v_mfma_f32_16x16x32_bf16 v[76:79], v[156:159], a[156:159], v[76:79]
    ds_read_b128 a[44:47], v22 offset:11264
    ds_read_b128 a[48:51], v22 offset:12288
    v_mfma_f32_16x16x32_bf16 v[64:67], v[160:163], a[160:163], v[64:67]
    ds_read_b128 a[52:55], v22 offset:13312
    ds_read_b128 a[56:59], v22 offset:14336
    v_mul_f32 v35, v195, v35
    v_mfma_f32_16x16x32_bf16 v[64:67], v[164:167], a[176:179], v[64:67]
    ds_read_b128 a[60:63], v22 offset:15360
    v_mul_f32 v196, s50, v36
    v_mfma_f32_16x16x32_bf16 v[68:71], v[160:163], a[164:167], v[68:71]
    v_mul_f32 v197, s50, v37
    v_mul_f32 v198, s50, v38
    v_mfma_f32_16x16x32_bf16 v[68:71], v[164:167], a[180:183], v[68:71]
    v_mul_f32 v199, s50, v39
    v_exp_f32 v196, v196
    v_mfma_f32_16x16x32_bf16 v[72:75], v[160:163], a[168:171], v[72:75]
    v_exp_f32 v197, v197
    v_exp_f32 v198, v198
    v_mfma_f32_16x16x32_bf16 v[72:75], v[164:167], a[184:187], v[72:75]
    v_exp_f32 v199, v199
    v_add_f32 v196, 1.0, v196
    v_mfma_f32_16x16x32_bf16 v[76:79], v[160:163], a[172:175], v[76:79]
    v_add_f32 v197, 1.0, v197
    v_add_f32 v198, 1.0, v198
    v_mfma_f32_16x16x32_bf16 v[76:79], v[164:167], a[188:191], v[76:79]
    v_add_f32 v199, 1.0, v199
    v_rcp_f32 v196, v196
    s_waitcnt lgkmcnt(0) vmcnt(12)
    s_barrier
    v_mfma_f32_16x16x32_bf16 v[64:67], v[168:171], a[192:195], v[64:67]
    s_add_u32 m0, s46, 24576
    s_add_u32 s44, s48, 221312
    buffer_load_dwordx4 v11, s[28:31], s44 offen offset:0 lds
    ds_read_b64_tr_b16 v[144:145], v15 offset:0
    v_rcp_f32 v197, v197
    v_mfma_f32_16x16x32_bf16 v[64:67], v[172:175], a[208:211], v[64:67]
    ds_read_b64_tr_b16 v[146:147], v15 offset:2048
    buffer_load_dwordx4 v12, s[28:31], s44 offen offset:1024 lds
    v_mfma_f32_16x16x32_bf16 v[68:71], v[168:171], a[196:199], v[68:71]
    ds_read_b64_tr_b16 v[148:149], v15 offset:4096
    ds_read_b64_tr_b16 v[150:151], v15 offset:6144
    v_mfma_f32_16x16x32_bf16 v[68:71], v[172:175], a[212:215], v[68:71]
    buffer_load_dwordx4 v13, s[28:31], s44 offen offset:2048 lds
    ds_read_b64_tr_b16 v[152:153], v15 offset:8192
    v_mfma_f32_16x16x32_bf16 v[72:75], v[168:171], a[200:203], v[72:75]
    ds_read_b64_tr_b16 v[154:155], v15 offset:10240
    s_add_u32 m0, s46, 27648
    s_add_u32 s45, s48, 248960
    buffer_load_dwordx4 v11, s[28:31], s45 offen offset:0 lds
    v_mfma_f32_16x16x32_bf16 v[72:75], v[172:175], a[216:219], v[72:75]
    ds_read_b64_tr_b16 v[156:157], v15 offset:12288
    ds_read_b64_tr_b16 v[158:159], v15 offset:14336
    v_mfma_f32_16x16x32_bf16 v[76:79], v[168:171], a[204:207], v[76:79]
    buffer_load_dwordx4 v12, s[28:31], s45 offen offset:1024 lds
    ds_read_b64_tr_b16 v[160:161], v15 offset:16384
    v_mfma_f32_16x16x32_bf16 v[76:79], v[172:175], a[220:223], v[76:79]
    ds_read_b64_tr_b16 v[162:163], v15 offset:18432
    buffer_load_dwordx4 v13, s[28:31], s45 offen offset:2048 lds
    v_mfma_f32_16x16x32_bf16 v[64:67], v[176:179], a[224:227], v[64:67]
    ds_read_b64_tr_b16 v[164:165], v15 offset:20480
    v_rcp_f32 v198, v198
    v_mfma_f32_16x16x32_bf16 v[64:67], v[180:183], a[240:243], v[64:67]
    ds_read_b64_tr_b16 v[166:167], v15 offset:22528
    ds_read_b128 a[64:67], v22 offset:16384
    v_mfma_f32_16x16x32_bf16 v[68:71], v[176:179], a[228:231], v[68:71]
    ds_read_b128 a[68:71], v22 offset:17408
    ds_read_b128 a[72:75], v22 offset:18432
    v_mfma_f32_16x16x32_bf16 v[68:71], v[180:183], a[244:247], v[68:71]
    ds_read_b128 a[76:79], v22 offset:19456
    ds_read_b128 a[80:83], v22 offset:20480
    v_mfma_f32_16x16x32_bf16 v[72:75], v[176:179], a[232:235], v[72:75]
    ds_read_b128 a[84:87], v22 offset:21504
    ds_read_b128 a[88:91], v22 offset:22528
    v_mfma_f32_16x16x32_bf16 v[72:75], v[180:183], a[248:251], v[72:75]
    ds_read_b128 a[92:95], v22 offset:23552
    ds_read_b128 a[96:99], v22 offset:24576
    v_mfma_f32_16x16x32_bf16 v[76:79], v[176:179], a[236:239], v[76:79]
    ds_read_b128 a[100:103], v22 offset:25600
    ds_read_b128 a[104:107], v22 offset:26624
    v_mfma_f32_16x16x32_bf16 v[76:79], v[180:183], a[252:255], v[76:79]
    ds_read_b128 a[108:111], v22 offset:27648
    ds_read_b128 a[112:115], v22 offset:28672
    v_mfma_f32_16x16x32_bf16 v[64:67], v[184:187], v[224:227], v[64:67]
    ds_read_b128 a[116:119], v22 offset:29696
    ds_read_b128 a[120:123], v22 offset:30720
    v_mfma_f32_16x16x32_bf16 v[64:67], v[188:191], v[240:243], v[64:67]
    ds_read_b128 a[124:127], v22 offset:31744
    v_rcp_f32 v199, v199
    v_mfma_f32_16x16x32_bf16 v[68:71], v[184:187], v[228:231], v[68:71]
    v_mul_f32 v36, v196, v36
    v_mul_f32 v37, v197, v37
    v_mfma_f32_16x16x32_bf16 v[68:71], v[188:191], v[244:247], v[68:71]
    v_mul_f32 v38, v198, v38
    v_mul_f32 v39, v199, v39
    v_mfma_f32_16x16x32_bf16 v[72:75], v[184:187], v[232:235], v[72:75]
    v_mul_f32 v200, s50, v40
    v_mul_f32 v201, s50, v41
    v_mfma_f32_16x16x32_bf16 v[72:75], v[188:191], v[248:251], v[72:75]
    v_mul_f32 v202, s50, v42
    v_mul_f32 v203, s50, v43
    v_mfma_f32_16x16x32_bf16 v[76:79], v[184:187], v[236:239], v[76:79]
    v_exp_f32 v200, v200
    v_exp_f32 v201, v201
    v_mfma_f32_16x16x32_bf16 v[76:79], v[188:191], v[252:255], v[76:79]
    v_exp_f32 v202, v202
    v_exp_f32 v203, v203
    s_waitcnt lgkmcnt(0) vmcnt(12)
    s_barrier
    v_mfma_f32_16x16x32_bf16 v[48:51], v[144:147], a[0:3], 0
    s_add_u32 m0, s46, 49152
    s_add_u32 s44, s48, 256
    buffer_load_dwordx4 v11, s[28:31], s44 offen offset:0 lds
    ds_read_b64_tr_b16 v[168:169], v14 offset:0
    ds_read_b64_tr_b16 v[170:171], v14 offset:2048
    v_mfma_f32_16x16x32_bf16 v[48:51], v[148:151], a[16:19], v[48:51]
    buffer_load_dwordx4 v12, s[28:31], s44 offen offset:1024 lds
    ds_read_b64_tr_b16 v[172:173], v14 offset:4096
    v_mfma_f32_16x16x32_bf16 v[52:55], v[144:147], a[4:7], 0
    ds_read_b64_tr_b16 v[174:175], v14 offset:6144
    buffer_load_dwordx4 v13, s[28:31], s44 offen offset:2048 lds
    v_add_f32 v200, 1.0, v200
    v_mfma_f32_16x16x32_bf16 v[52:55], v[148:151], a[20:23], v[52:55]
    ds_read_b64_tr_b16 v[176:177], v14 offset:8192
    ds_read_b64_tr_b16 v[178:179], v14 offset:10240
    s_add_u32 m0, s46, 52224
    s_add_u32 s45, s48, 27904
    buffer_load_dwordx4 v11, s[28:31], s45 offen offset:0 lds
    v_mfma_f32_16x16x32_bf16 v[56:59], v[144:147], a[8:11], 0
    ds_read_b64_tr_b16 v[180:181], v14 offset:12288
    ds_read_b64_tr_b16 v[182:183], v14 offset:14336
    v_mfma_f32_16x16x32_bf16 v[56:59], v[148:151], a[24:27], v[56:59]
    buffer_load_dwordx4 v12, s[28:31], s45 offen offset:1024 lds
    ds_read_b64_tr_b16 v[184:185], v14 offset:16384
    v_mfma_f32_16x16x32_bf16 v[60:63], v[144:147], a[12:15], 0
    ds_read_b64_tr_b16 v[186:187], v14 offset:18432
    buffer_load_dwordx4 v13, s[28:31], s45 offen offset:2048 lds
    v_add_f32 v201, 1.0, v201
    v_mfma_f32_16x16x32_bf16 v[60:63], v[148:151], a[28:31], v[60:63]
    ds_read_b64_tr_b16 v[188:189], v14 offset:20480
    ds_read_b64_tr_b16 v[190:191], v14 offset:22528
    s_add_u32 m0, s46, 73728
    s_add_u32 s44, s48, 221440
    buffer_load_dwordx4 v11, s[28:31], s44 offen offset:0 lds
    v_mfma_f32_16x16x32_bf16 v[48:51], v[152:155], a[32:35], v[48:51]
    ds_read_b128 a[128:131], v22 offset:32768
    ds_read_b128 a[132:135], v22 offset:33792
    v_mfma_f32_16x16x32_bf16 v[48:51], v[156:159], a[48:51], v[48:51]
    buffer_load_dwordx4 v12, s[28:31], s44 offen offset:1024 lds
    ds_read_b128 a[136:139], v22 offset:34816
    v_mfma_f32_16x16x32_bf16 v[52:55], v[152:155], a[36:39], v[52:55]
    ds_read_b128 a[140:143], v22 offset:35840
    buffer_load_dwordx4 v13, s[28:31], s44 offen offset:2048 lds
    ds_read_b128 a[144:147], v23 offset:0
    v_mfma_f32_16x16x32_bf16 v[52:55], v[156:159], a[52:55], v[52:55]
    ds_read_b128 a[148:151], v23 offset:1024
    s_add_u32 m0, s46, 76800
    s_add_u32 s45, s48, 249088
    buffer_load_dwordx4 v11, s[28:31], s45 offen offset:0 lds
    v_mfma_f32_16x16x32_bf16 v[56:59], v[152:155], a[40:43], v[56:59]
    ds_read_b128 a[152:155], v23 offset:2048
    ds_read_b128 a[156:159], v23 offset:3072
    v_mfma_f32_16x16x32_bf16 v[56:59], v[156:159], a[56:59], v[56:59]
    buffer_load_dwordx4 v12, s[28:31], s45 offen offset:1024 lds
    ds_read_b128 a[160:163], v23 offset:4096
    v_add_f32 v202, 1.0, v202
    v_mfma_f32_16x16x32_bf16 v[60:63], v[152:155], a[44:47], v[60:63]
    ds_read_b128 a[164:167], v23 offset:5120
    buffer_load_dwordx4 v13, s[28:31], s45 offen offset:2048 lds
    ds_read_b128 a[168:171], v23 offset:6144
    v_mfma_f32_16x16x32_bf16 v[60:63], v[156:159], a[60:63], v[60:63]
    ds_read_b128 a[172:175], v23 offset:7168
    buffer_load_dword v6, v5, s[28:31], s48 offen offset:768
    v_mfma_f32_16x16x32_bf16 v[48:51], v[160:163], a[64:67], v[48:51]
    ds_read_b128 a[176:179], v23 offset:8192
    ds_read_b128 a[180:183], v23 offset:9216
    v_mfma_f32_16x16x32_bf16 v[48:51], v[164:167], a[80:83], v[48:51]
    ds_read_b128 a[184:187], v23 offset:10240
    ds_read_b128 a[188:191], v23 offset:11264
    v_add_f32 v203, 1.0, v203
    v_mfma_f32_16x16x32_bf16 v[52:55], v[160:163], a[68:71], v[52:55]
    v_rcp_f32 v200, v200
    v_rcp_f32 v201, v201
    v_mfma_f32_16x16x32_bf16 v[52:55], v[164:167], a[84:87], v[52:55]
    v_rcp_f32 v202, v202
    v_rcp_f32 v203, v203
    v_mul_f32 v40, v200, v40
    v_mfma_f32_16x16x32_bf16 v[56:59], v[160:163], a[72:75], v[56:59]
    v_mul_f32 v41, v201, v41
    v_mul_f32 v42, v202, v42
    v_mfma_f32_16x16x32_bf16 v[56:59], v[164:167], a[88:91], v[56:59]
    v_mul_f32 v43, v203, v43
    v_mul_f32 v192, s50, v44
    v_mul_f32 v193, s50, v45
    v_mfma_f32_16x16x32_bf16 v[60:63], v[160:163], a[76:79], v[60:63]
    v_mul_f32 v194, s50, v46
    v_mul_f32 v195, s50, v47
    v_mfma_f32_16x16x32_bf16 v[60:63], v[164:167], a[92:95], v[60:63]
    v_exp_f32 v192, v192
    v_exp_f32 v193, v193
    s_waitcnt lgkmcnt(0) vmcnt(19)
    s_barrier
    v_mfma_f32_16x16x32_bf16 v[48:51], v[168:171], a[96:99], v[48:51]
    s_add_u32 m0, s46, 0
    s_add_u32 s44, s48, 442368
    buffer_load_dwordx4 v11, s[28:31], s44 offen offset:0 lds
    v_exp_f32 v194, v194
    v_mfma_f32_16x16x32_bf16 v[48:51], v[172:175], a[112:115], v[48:51]
    ds_read_b64_tr_b16 v[144:145], v16 offset:24576
    v_mfma_f32_16x16x32_bf16 v[52:55], v[168:171], a[100:103], v[52:55]
    ds_read_b64_tr_b16 v[146:147], v16 offset:26624
    v_exp_f32 v195, v195
    v_mfma_f32_16x16x32_bf16 v[52:55], v[172:175], a[116:119], v[52:55]
    buffer_load_dwordx4 v12, s[28:31], s44 offen offset:1024 lds
    v_mfma_f32_16x16x32_bf16 v[56:59], v[168:171], a[104:107], v[56:59]
    ds_read_b64_tr_b16 v[148:149], v16 offset:28672
    v_add_f32 v192, 1.0, v192
    v_mfma_f32_16x16x32_bf16 v[56:59], v[172:175], a[120:123], v[56:59]
    ds_read_b64_tr_b16 v[150:151], v16 offset:30720
    v_mfma_f32_16x16x32_bf16 v[60:63], v[168:171], a[108:111], v[60:63]
    buffer_load_dwordx4 v13, s[28:31], s44 offen offset:2048 lds
    v_mfma_f32_16x16x32_bf16 v[60:63], v[172:175], a[124:127], v[60:63]
    ds_read_b64_tr_b16 v[152:153], v16 offset:32768
    v_add_f32 v193, 1.0, v193
    v_mfma_f32_16x16x32_bf16 v[48:51], v[176:179], a[128:131], v[48:51]
    ds_read_b64_tr_b16 v[154:155], v16 offset:34816
    v_mfma_f32_16x16x32_bf16 v[48:51], v[180:183], a[144:147], v[48:51]
    s_add_u32 m0, s46, 3072
    s_add_u32 s45, s48, 470016
    buffer_load_dwordx4 v11, s[28:31], s45 offen offset:0 lds
    v_add_f32 v194, 1.0, v194
    v_mfma_f32_16x16x32_bf16 v[52:55], v[176:179], a[132:135], v[52:55]
    ds_read_b64_tr_b16 v[156:157], v16 offset:36864
    v_mfma_f32_16x16x32_bf16 v[52:55], v[180:183], a[148:151], v[52:55]
    ds_read_b64_tr_b16 v[158:159], v16 offset:38912
    v_mfma_f32_16x16x32_bf16 v[56:59], v[176:179], a[136:139], v[56:59]
    buffer_load_dwordx4 v12, s[28:31], s45 offen offset:1024 lds
    v_add_f32 v195, 1.0, v195
    v_mfma_f32_16x16x32_bf16 v[56:59], v[180:183], a[152:155], v[56:59]
    ds_read_b64_tr_b16 v[160:161], v16 offset:40960
    v_mfma_f32_16x16x32_bf16 v[60:63], v[176:179], a[140:143], v[60:63]
    ds_read_b64_tr_b16 v[162:163], v16 offset:43008
    v_rcp_f32 v192, v192
    v_mfma_f32_16x16x32_bf16 v[60:63], v[180:183], a[156:159], v[60:63]
    buffer_load_dwordx4 v13, s[28:31], s45 offen offset:2048 lds
    v_mfma_f32_16x16x32_bf16 v[48:51], v[184:187], a[160:163], v[48:51]
    ds_read_b64_tr_b16 v[164:165], v16 offset:45056
    v_rcp_f32 v193, v193
    v_mfma_f32_16x16x32_bf16 v[48:51], v[188:191], a[176:179], v[48:51]
    ds_read_b64_tr_b16 v[166:167], v16 offset:47104
    v_mfma_f32_16x16x32_bf16 v[52:55], v[184:187], a[164:167], v[52:55]
    v_rcp_f32 v194, v194
    v_mfma_f32_16x16x32_bf16 v[52:55], v[188:191], a[180:183], v[52:55]
    v_rcp_f32 v195, v195
    v_mul_f32 v44, v192, v44
    v_mfma_f32_16x16x32_bf16 v[56:59], v[184:187], a[168:171], v[56:59]
    v_mul_f32 v45, v193, v45
    v_mfma_f32_16x16x32_bf16 v[56:59], v[188:191], a[184:187], v[56:59]
    v_mul_f32 v46, v194, v46
    v_mul_f32 v47, v195, v47
    v_mfma_f32_16x16x32_bf16 v[60:63], v[184:187], a[172:175], v[60:63]
    v_mul_f32 v32, v32, v64
    v_mfma_f32_16x16x32_bf16 v[60:63], v[188:191], a[188:191], v[60:63]
    v_mul_f32 v33, v33, v65
    s_waitcnt lgkmcnt(0) vmcnt(19)
    s_barrier
    v_mfma_f32_16x16x32_bf16 v[80:83], v[144:147], a[0:3], 0
    s_add_u32 m0, s46, 98304
    s_add_u32 s44, s48, 442496
    buffer_load_dwordx4 v11, s[28:31], s44 offen offset:0 lds
    v_mul_f32 v34, v34, v66
    v_mfma_f32_16x16x32_bf16 v[80:83], v[148:151], a[16:19], v[80:83]
    ds_read_b64_tr_b16 v[168:169], v14 offset:24576
    v_mul_f32 v35, v35, v67
    v_mfma_f32_16x16x32_bf16 v[84:87], v[144:147], a[4:7], 0
    ds_read_b64_tr_b16 v[170:171], v14 offset:26624
    v_mfma_f32_16x16x32_bf16 v[84:87], v[148:151], a[20:23], v[84:87]
    buffer_load_dwordx4 v12, s[28:31], s44 offen offset:1024 lds
    v_cvt_pk_bf16_f32 v112, v32, v33
    v_mfma_f32_16x16x32_bf16 v[88:91], v[144:147], a[8:11], 0
    ds_read_b64_tr_b16 v[172:173], v14 offset:28672
    v_cvt_pk_bf16_f32 v113, v34, v35
    v_mfma_f32_16x16x32_bf16 v[88:91], v[148:151], a[24:27], v[88:91]
    ds_read_b64_tr_b16 v[174:175], v14 offset:30720
    v_mfma_f32_16x16x32_bf16 v[92:95], v[144:147], a[12:15], 0
    buffer_load_dwordx4 v13, s[28:31], s44 offen offset:2048 lds
    v_mul_f32 v36, v36, v68
    v_mfma_f32_16x16x32_bf16 v[92:95], v[148:151], a[28:31], v[92:95]
    ds_read_b64_tr_b16 v[176:177], v14 offset:32768
    v_mul_f32 v37, v37, v69
    v_mfma_f32_16x16x32_bf16 v[80:83], v[152:155], a[32:35], v[80:83]
    ds_read_b64_tr_b16 v[178:179], v14 offset:34816
    v_mfma_f32_16x16x32_bf16 v[80:83], v[156:159], a[48:51], v[80:83]
    s_add_u32 m0, s46, 101376
    s_add_u32 s45, s48, 470144
    buffer_load_dwordx4 v11, s[28:31], s45 offen offset:0 lds
    v_mul_f32 v38, v38, v70
    v_mfma_f32_16x16x32_bf16 v[84:87], v[152:155], a[36:39], v[84:87]
    ds_read_b64_tr_b16 v[180:181], v14 offset:36864
    v_mul_f32 v39, v39, v71
    v_mfma_f32_16x16x32_bf16 v[84:87], v[156:159], a[52:55], v[84:87]
    ds_read_b64_tr_b16 v[182:183], v14 offset:38912
    v_mfma_f32_16x16x32_bf16 v[88:91], v[152:155], a[40:43], v[88:91]
    buffer_load_dwordx4 v12, s[28:31], s45 offen offset:1024 lds
    v_cvt_pk_bf16_f32 v114, v36, v37
    v_mfma_f32_16x16x32_bf16 v[88:91], v[156:159], a[56:59], v[88:91]
    ds_read_b64_tr_b16 v[184:185], v14 offset:40960
    v_cvt_pk_bf16_f32 v115, v38, v39
    v_mfma_f32_16x16x32_bf16 v[92:95], v[152:155], a[44:47], v[92:95]
    ds_read_b64_tr_b16 v[186:187], v14 offset:43008
    v_mfma_f32_16x16x32_bf16 v[92:95], v[156:159], a[60:63], v[92:95]
    buffer_load_dwordx4 v13, s[28:31], s45 offen offset:2048 lds
    v_mul_f32 v40, v40, v72
    v_mfma_f32_16x16x32_bf16 v[80:83], v[160:163], a[64:67], v[80:83]
    ds_read_b64_tr_b16 v[188:189], v14 offset:45056
    v_mul_f32 v41, v41, v73
    v_mfma_f32_16x16x32_bf16 v[80:83], v[164:167], a[80:83], v[80:83]
    ds_read_b64_tr_b16 v[190:191], v14 offset:47104
    v_mfma_f32_16x16x32_bf16 v[84:87], v[160:163], a[68:71], v[84:87]
    v_mul_f32 v42, v42, v74
    v_mul_f32 v43, v43, v75
    v_mfma_f32_16x16x32_bf16 v[84:87], v[164:167], a[84:87], v[84:87]
    v_cvt_pk_bf16_f32 v116, v40, v41
    v_cvt_pk_bf16_f32 v117, v42, v43
    v_mfma_f32_16x16x32_bf16 v[88:91], v[160:163], a[72:75], v[88:91]
    v_mul_f32 v44, v44, v76
    v_mfma_f32_16x16x32_bf16 v[88:91], v[164:167], a[88:91], v[88:91]
    v_mul_f32 v45, v45, v77
    v_mul_f32 v46, v46, v78
    v_mfma_f32_16x16x32_bf16 v[92:95], v[160:163], a[76:79], v[92:95]
    v_mul_f32 v47, v47, v79
    v_cvt_pk_bf16_f32 v118, v44, v45
    v_mfma_f32_16x16x32_bf16 v[92:95], v[164:167], a[92:95], v[92:95]
    v_cvt_pk_bf16_f32 v119, v46, v47
    s_waitcnt lgkmcnt(0) vmcnt(19)
    s_barrier
    ds_write_b64 v25, v[96:97] offset:0
    ds_write_b64 v25, v[98:99] offset:1024
    ds_write_b64 v25, v[100:101] offset:2048
    ds_write_b64 v25, v[102:103] offset:3072
    ds_write_b64 v25, v[104:105] offset:8192
    ds_write_b64 v25, v[106:107] offset:9216
    ds_write_b64 v25, v[108:109] offset:10240
    ds_write_b64 v25, v[110:111] offset:11264
    ds_write_b64 v25, v[112:113] offset:16384
    ds_write_b64 v25, v[114:115] offset:17408
    ds_write_b64 v25, v[116:117] offset:18432
    ds_write_b64 v25, v[118:119] offset:19456
    v_mfma_f32_16x16x32_bf16 v[80:83], v[168:171], a[96:99], v[80:83]
    s_add_u32 m0, s46, 24576
    s_add_u32 s44, s48, 442624
    buffer_load_dwordx4 v11, s[28:31], s44 offen offset:0 lds
    v_mfma_f32_16x16x32_bf16 v[80:83], v[172:175], a[112:115], v[80:83]
    ds_read_b64_tr_b16 v[144:145], v15 offset:0
    v_mfma_f32_16x16x32_bf16 v[84:87], v[168:171], a[100:103], v[84:87]
    ds_read_b64_tr_b16 v[146:147], v15 offset:2048
    v_mfma_f32_16x16x32_bf16 v[84:87], v[172:175], a[116:119], v[84:87]
    buffer_load_dwordx4 v12, s[28:31], s44 offen offset:1024 lds
    v_mfma_f32_16x16x32_bf16 v[88:91], v[168:171], a[104:107], v[88:91]
    ds_read_b64_tr_b16 v[148:149], v15 offset:4096
    v_mfma_f32_16x16x32_bf16 v[88:91], v[172:175], a[120:123], v[88:91]
    ds_read_b64_tr_b16 v[150:151], v15 offset:6144
    v_mfma_f32_16x16x32_bf16 v[92:95], v[168:171], a[108:111], v[92:95]
    buffer_load_dwordx4 v13, s[28:31], s44 offen offset:2048 lds
    v_mfma_f32_16x16x32_bf16 v[92:95], v[172:175], a[124:127], v[92:95]
    ds_read_b64_tr_b16 v[152:153], v15 offset:8192
    v_mfma_f32_16x16x32_bf16 v[80:83], v[176:179], a[128:131], v[80:83]
    ds_read_b64_tr_b16 v[154:155], v15 offset:10240
    v_mfma_f32_16x16x32_bf16 v[80:83], v[180:183], a[144:147], v[80:83]
    s_add_u32 m0, s46, 27648
    s_add_u32 s45, s48, 470272
    buffer_load_dwordx4 v11, s[28:31], s45 offen offset:0 lds
    v_mfma_f32_16x16x32_bf16 v[84:87], v[176:179], a[132:135], v[84:87]
    ds_read_b64_tr_b16 v[156:157], v15 offset:12288
    v_mfma_f32_16x16x32_bf16 v[84:87], v[180:183], a[148:151], v[84:87]
    ds_read_b64_tr_b16 v[158:159], v15 offset:14336
    v_mfma_f32_16x16x32_bf16 v[88:91], v[176:179], a[136:139], v[88:91]
    buffer_load_dwordx4 v12, s[28:31], s45 offen offset:1024 lds
    v_mfma_f32_16x16x32_bf16 v[88:91], v[180:183], a[152:155], v[88:91]
    ds_read_b64_tr_b16 v[160:161], v15 offset:16384
    v_mfma_f32_16x16x32_bf16 v[92:95], v[176:179], a[140:143], v[92:95]
    ds_read_b64_tr_b16 v[162:163], v15 offset:18432
    v_mfma_f32_16x16x32_bf16 v[92:95], v[180:183], a[156:159], v[92:95]
    buffer_load_dwordx4 v13, s[28:31], s45 offen offset:2048 lds
    v_mfma_f32_16x16x32_bf16 v[80:83], v[184:187], a[160:163], v[80:83]
    ds_read_b64_tr_b16 v[164:165], v15 offset:20480
    v_mfma_f32_16x16x32_bf16 v[80:83], v[188:191], a[176:179], v[80:83]
    ds_read_b64_tr_b16 v[166:167], v15 offset:22528
    v_mfma_f32_16x16x32_bf16 v[84:87], v[184:187], a[164:167], v[84:87]
    v_mfma_f32_16x16x32_bf16 v[84:87], v[188:191], a[180:183], v[84:87]
    v_mfma_f32_16x16x32_bf16 v[88:91], v[184:187], a[168:171], v[88:91]
    v_mfma_f32_16x16x32_bf16 v[88:91], v[188:191], a[184:187], v[88:91]
    v_mfma_f32_16x16x32_bf16 v[92:95], v[184:187], a[172:175], v[92:95]
    v_mfma_f32_16x16x32_bf16 v[92:95], v[188:191], a[188:191], v[92:95]
    s_waitcnt lgkmcnt(0) vmcnt(19)
    s_barrier
    v_mfma_f32_16x16x32_bf16 v[120:123], v[144:147], a[0:3], 0
    s_add_u32 m0, s46, 49152
    s_add_u32 s44, s48, 384
    buffer_load_dwordx4 v11, s[28:31], s44 offen offset:0 lds
    ds_read_b64_tr_b16 v[168:169], v15 offset:24576
    v_mfma_f32_16x16x32_bf16 v[120:123], v[148:151], a[16:19], v[120:123]
    ds_read_b64_tr_b16 v[170:171], v15 offset:26624
    buffer_load_dwordx4 v12, s[28:31], s44 offen offset:1024 lds
    v_mfma_f32_16x16x32_bf16 v[124:127], v[144:147], a[4:7], 0
    ds_read_b64_tr_b16 v[172:173], v15 offset:28672
    v_mfma_f32_16x16x32_bf16 v[124:127], v[148:151], a[20:23], v[124:127]
    ds_read_b64_tr_b16 v[174:175], v15 offset:30720
    buffer_load_dwordx4 v13, s[28:31], s44 offen offset:2048 lds
    v_mfma_f32_16x16x32_bf16 v[128:131], v[144:147], a[8:11], 0
    ds_read_b64_tr_b16 v[176:177], v15 offset:32768
    ds_read_b64_tr_b16 v[178:179], v15 offset:34816
    v_mfma_f32_16x16x32_bf16 v[128:131], v[148:151], a[24:27], v[128:131]
    s_add_u32 m0, s46, 52224
    s_add_u32 s45, s48, 28032
    buffer_load_dwordx4 v11, s[28:31], s45 offen offset:0 lds
    v_mfma_f32_16x16x32_bf16 v[132:135], v[144:147], a[12:15], 0
    ds_read_b64_tr_b16 v[180:181], v15 offset:36864
    ds_read_b64_tr_b16 v[182:183], v15 offset:38912
    v_mfma_f32_16x16x32_bf16 v[132:135], v[148:151], a[28:31], v[132:135]
    buffer_load_dwordx4 v12, s[28:31], s45 offen offset:1024 lds
    ds_read_b64_tr_b16 v[184:185], v15 offset:40960
    v_mfma_f32_16x16x32_bf16 v[120:123], v[152:155], a[32:35], v[120:123]
    ds_read_b64_tr_b16 v[186:187], v15 offset:43008
    v_mfma_f32_16x16x32_bf16 v[120:123], v[156:159], a[48:51], v[120:123]
    buffer_load_dwordx4 v13, s[28:31], s45 offen offset:2048 lds
    ds_read_b64_tr_b16 v[188:189], v15 offset:45056
    v_mfma_f32_16x16x32_bf16 v[124:127], v[152:155], a[36:39], v[124:127]
    ds_read_b64_tr_b16 v[190:191], v15 offset:47104
    ds_read_b128 a[192:195], v23 offset:12288
    v_mfma_f32_16x16x32_bf16 v[124:127], v[156:159], a[52:55], v[124:127]
    ds_read_b128 a[196:199], v23 offset:13312
    v_mfma_f32_16x16x32_bf16 v[128:131], v[152:155], a[40:43], v[128:131]
    ds_read_b128 a[200:203], v23 offset:14336
    ds_read_b128 a[204:207], v23 offset:15360
    v_mfma_f32_16x16x32_bf16 v[128:131], v[156:159], a[56:59], v[128:131]
    ds_read_b128 a[208:211], v23 offset:16384
    ds_read_b128 a[212:215], v23 offset:17408
    v_mfma_f32_16x16x32_bf16 v[132:135], v[152:155], a[44:47], v[132:135]
    ds_read_b128 a[216:219], v23 offset:18432
    v_mfma_f32_16x16x32_bf16 v[132:135], v[156:159], a[60:63], v[132:135]
    ds_read_b128 a[220:223], v23 offset:19456
    ds_read_b128 a[224:227], v23 offset:20480
    v_mfma_f32_16x16x32_bf16 v[120:123], v[160:163], a[64:67], v[120:123]
    ds_read_b128 a[228:231], v23 offset:21504
    ds_read_b128 a[232:235], v23 offset:22528
    v_mfma_f32_16x16x32_bf16 v[120:123], v[164:167], a[80:83], v[120:123]
    ds_read_b128 a[236:239], v23 offset:23552
    v_mfma_f32_16x16x32_bf16 v[124:127], v[160:163], a[68:71], v[124:127]
    v_mfma_f32_16x16x32_bf16 v[124:127], v[164:167], a[84:87], v[124:127]
    v_mfma_f32_16x16x32_bf16 v[128:131], v[160:163], a[72:75], v[128:131]
    v_mfma_f32_16x16x32_bf16 v[128:131], v[164:167], a[88:91], v[128:131]
    v_mfma_f32_16x16x32_bf16 v[132:135], v[160:163], a[76:79], v[132:135]
    v_mfma_f32_16x16x32_bf16 v[132:135], v[164:167], a[92:95], v[132:135]
    s_waitcnt lgkmcnt(0) vmcnt(18)
    s_barrier
    v_mfma_f32_16x16x32_bf16 v[120:123], v[168:171], a[96:99], v[120:123]
    s_add_u32 m0, s46, 73728
    s_add_u32 s44, s48, 221568
    buffer_load_dwordx4 v11, s[28:31], s44 offen offset:0 lds
    ds_read_b64_tr_b16 v[144:145], v14 offset:0
    v_mfma_f32_16x16x32_bf16 v[120:123], v[172:175], a[112:115], v[120:123]
    ds_read_b64_tr_b16 v[146:147], v14 offset:2048
    buffer_load_dwordx4 v12, s[28:31], s44 offen offset:1024 lds
    v_mfma_f32_16x16x32_bf16 v[124:127], v[168:171], a[100:103], v[124:127]
    ds_read_b64_tr_b16 v[148:149], v14 offset:4096
    v_mfma_f32_16x16x32_bf16 v[124:127], v[172:175], a[116:119], v[124:127]
    ds_read_b64_tr_b16 v[150:151], v14 offset:6144
    buffer_load_dwordx4 v13, s[28:31], s44 offen offset:2048 lds
    v_mfma_f32_16x16x32_bf16 v[128:131], v[168:171], a[104:107], v[128:131]
    ds_read_b64_tr_b16 v[152:153], v14 offset:8192
    ds_read_b64_tr_b16 v[154:155], v14 offset:10240
    v_mfma_f32_16x16x32_bf16 v[128:131], v[172:175], a[120:123], v[128:131]
    s_add_u32 m0, s46, 76800
    s_add_u32 s45, s48, 249216
    buffer_load_dwordx4 v11, s[28:31], s45 offen offset:0 lds
    v_mfma_f32_16x16x32_bf16 v[132:135], v[168:171], a[108:111], v[132:135]
    ds_read_b64_tr_b16 v[156:157], v14 offset:12288
    ds_read_b64_tr_b16 v[158:159], v14 offset:14336
    v_mfma_f32_16x16x32_bf16 v[132:135], v[172:175], a[124:127], v[132:135]
    buffer_load_dwordx4 v12, s[28:31], s45 offen offset:1024 lds
    ds_read_b64_tr_b16 v[160:161], v14 offset:16384
    v_mfma_f32_16x16x32_bf16 v[120:123], v[176:179], a[128:131], v[120:123]
    ds_read_b64_tr_b16 v[162:163], v14 offset:18432
    v_mfma_f32_16x16x32_bf16 v[120:123], v[180:183], a[144:147], v[120:123]
    buffer_load_dwordx4 v13, s[28:31], s45 offen offset:2048 lds
    ds_read_b64_tr_b16 v[164:165], v14 offset:20480
    v_mfma_f32_16x16x32_bf16 v[124:127], v[176:179], a[132:135], v[124:127]
    ds_read_b64_tr_b16 v[166:167], v14 offset:22528
    ds_read_b128 a[240:243], v23 offset:24576
    v_mfma_f32_16x16x32_bf16 v[124:127], v[180:183], a[148:151], v[124:127]
    ds_read_b128 a[244:247], v23 offset:25600
    v_mfma_f32_16x16x32_bf16 v[128:131], v[176:179], a[136:139], v[128:131]
    ds_read_b128 a[248:251], v23 offset:26624
    ds_read_b128 a[252:255], v23 offset:27648
    v_mfma_f32_16x16x32_bf16 v[128:131], v[180:183], a[152:155], v[128:131]
    ds_read_b128 v[224:227], v23 offset:28672
    ds_read_b128 v[228:231], v23 offset:29696
    v_mfma_f32_16x16x32_bf16 v[132:135], v[176:179], a[140:143], v[132:135]
    ds_read_b128 v[232:235], v23 offset:30720
    v_mfma_f32_16x16x32_bf16 v[132:135], v[180:183], a[156:159], v[132:135]
    ds_read_b128 v[236:239], v23 offset:31744
    ds_read_b128 v[240:243], v23 offset:32768
    v_mfma_f32_16x16x32_bf16 v[120:123], v[184:187], a[160:163], v[120:123]
    ds_read_b128 v[244:247], v23 offset:33792
    ds_read_b128 v[248:251], v23 offset:34816
    v_mfma_f32_16x16x32_bf16 v[120:123], v[188:191], a[176:179], v[120:123]
    ds_read_b128 v[252:255], v23 offset:35840
    v_mfma_f32_16x16x32_bf16 v[124:127], v[184:187], a[164:167], v[124:127]
    v_mfma_f32_16x16x32_bf16 v[124:127], v[188:191], a[180:183], v[124:127]
    v_mfma_f32_16x16x32_bf16 v[128:131], v[184:187], a[168:171], v[128:131]
    v_mfma_f32_16x16x32_bf16 v[128:131], v[188:191], a[184:187], v[128:131]
    v_mfma_f32_16x16x32_bf16 v[132:135], v[184:187], a[172:175], v[132:135]
    v_mfma_f32_16x16x32_bf16 v[132:135], v[188:191], a[188:191], v[132:135]
    s_waitcnt lgkmcnt(0) vmcnt(18)
    s_barrier
    v_mfma_f32_16x16x32_bf16 v[48:51], v[144:147], a[192:195], v[48:51]
    s_add_u32 m0, s46, 0
    s_add_u32 s44, s48, 442752
    buffer_load_dwordx4 v11, s[28:31], s44 offen offset:0 lds
    v_mfma_f32_16x16x32_bf16 v[48:51], v[148:151], a[208:211], v[48:51]
    ds_read_b64_tr_b16 v[168:169], v16 offset:0
    v_mfma_f32_16x16x32_bf16 v[52:55], v[144:147], a[196:199], v[52:55]
    ds_read_b64_tr_b16 v[170:171], v16 offset:2048
    v_mfma_f32_16x16x32_bf16 v[52:55], v[148:151], a[212:215], v[52:55]
    buffer_load_dwordx4 v12, s[28:31], s44 offen offset:1024 lds
    v_mfma_f32_16x16x32_bf16 v[56:59], v[144:147], a[200:203], v[56:59]
    ds_read_b64_tr_b16 v[172:173], v16 offset:4096
    v_mfma_f32_16x16x32_bf16 v[56:59], v[148:151], a[216:219], v[56:59]
    ds_read_b64_tr_b16 v[174:175], v16 offset:6144
    v_mfma_f32_16x16x32_bf16 v[60:63], v[144:147], a[204:207], v[60:63]
    buffer_load_dwordx4 v13, s[28:31], s44 offen offset:2048 lds
    v_mfma_f32_16x16x32_bf16 v[60:63], v[148:151], a[220:223], v[60:63]
    ds_read_b64_tr_b16 v[176:177], v16 offset:8192
    v_mfma_f32_16x16x32_bf16 v[48:51], v[152:155], a[224:227], v[48:51]
    ds_read_b64_tr_b16 v[178:179], v16 offset:10240
    v_mfma_f32_16x16x32_bf16 v[48:51], v[156:159], a[240:243], v[48:51]
    s_add_u32 m0, s46, 3072
    s_add_u32 s45, s48, 470400
    buffer_load_dwordx4 v11, s[28:31], s45 offen offset:0 lds
    v_mfma_f32_16x16x32_bf16 v[52:55], v[152:155], a[228:231], v[52:55]
    ds_read_b64_tr_b16 v[180:181], v16 offset:12288
    v_mfma_f32_16x16x32_bf16 v[52:55], v[156:159], a[244:247], v[52:55]
    ds_read_b64_tr_b16 v[182:183], v16 offset:14336
    v_mfma_f32_16x16x32_bf16 v[56:59], v[152:155], a[232:235], v[56:59]
    buffer_load_dwordx4 v12, s[28:31], s45 offen offset:1024 lds
    v_mfma_f32_16x16x32_bf16 v[56:59], v[156:159], a[248:251], v[56:59]
    ds_read_b64_tr_b16 v[184:185], v16 offset:16384
    v_mfma_f32_16x16x32_bf16 v[60:63], v[152:155], a[236:239], v[60:63]
    ds_read_b64_tr_b16 v[186:187], v16 offset:18432
    v_mfma_f32_16x16x32_bf16 v[60:63], v[156:159], a[252:255], v[60:63]
    buffer_load_dwordx4 v13, s[28:31], s45 offen offset:2048 lds
    v_mfma_f32_16x16x32_bf16 v[48:51], v[160:163], v[224:227], v[48:51]
    ds_read_b64_tr_b16 v[188:189], v16 offset:20480
    v_mfma_f32_16x16x32_bf16 v[48:51], v[164:167], v[240:243], v[48:51]
    ds_read_b64_tr_b16 v[190:191], v16 offset:22528
    v_mfma_f32_16x16x32_bf16 v[52:55], v[160:163], v[228:231], v[52:55]
    v_mfma_f32_16x16x32_bf16 v[52:55], v[164:167], v[244:247], v[52:55]
    v_mfma_f32_16x16x32_bf16 v[56:59], v[160:163], v[232:235], v[56:59]
    v_mfma_f32_16x16x32_bf16 v[56:59], v[164:167], v[248:251], v[56:59]
    v_mfma_f32_16x16x32_bf16 v[60:63], v[160:163], v[236:239], v[60:63]
    v_mfma_f32_16x16x32_bf16 v[60:63], v[164:167], v[252:255], v[60:63]
    s_waitcnt lgkmcnt(0) vmcnt(18)
    s_barrier
    v_mfma_f32_16x16x32_bf16 v[80:83], v[168:171], a[192:195], v[80:83]
    s_add_u32 m0, s46, 98304
    s_add_u32 s44, s48, 512
    buffer_load_dwordx4 v11, s[28:31], s44 offen offset:0 lds
    v_cvt_pk_bf16_f32 v204, v48, v49
    v_mfma_f32_16x16x32_bf16 v[80:83], v[172:175], a[208:211], v[80:83]
    ds_read_b64_tr_b16 v[144:145], v14 offset:24576
    v_mfma_f32_16x16x32_bf16 v[84:87], v[168:171], a[196:199], v[84:87]
    ds_read_b64_tr_b16 v[146:147], v14 offset:26624
    v_mfma_f32_16x16x32_bf16 v[84:87], v[172:175], a[212:215], v[84:87]
    buffer_load_dwordx4 v12, s[28:31], s44 offen offset:1024 lds
    v_mfma_f32_16x16x32_bf16 v[88:91], v[168:171], a[200:203], v[88:91]
    ds_read_b64_tr_b16 v[148:149], v14 offset:28672
    v_mfma_f32_16x16x32_bf16 v[88:91], v[172:175], a[216:219], v[88:91]
    ds_read_b64_tr_b16 v[150:151], v14 offset:30720
    v_mfma_f32_16x16x32_bf16 v[92:95], v[168:171], a[204:207], v[92:95]
    buffer_load_dwordx4 v13, s[28:31], s44 offen offset:2048 lds
    v_cvt_pk_bf16_f32 v205, v50, v51
    v_mfma_f32_16x16x32_bf16 v[92:95], v[172:175], a[220:223], v[92:95]
    ds_read_b64_tr_b16 v[152:153], v14 offset:32768
    v_mfma_f32_16x16x32_bf16 v[80:83], v[176:179], a[224:227], v[80:83]
    ds_read_b64_tr_b16 v[154:155], v14 offset:34816
    v_mfma_f32_16x16x32_bf16 v[80:83], v[180:183], a[240:243], v[80:83]
    s_add_u32 m0, s46, 101376
    s_add_u32 s45, s48, 28160
    buffer_load_dwordx4 v11, s[28:31], s45 offen offset:0 lds
    v_mfma_f32_16x16x32_bf16 v[84:87], v[176:179], a[228:231], v[84:87]
    ds_read_b64_tr_b16 v[156:157], v14 offset:36864
    v_mfma_f32_16x16x32_bf16 v[84:87], v[180:183], a[244:247], v[84:87]
    ds_read_b64_tr_b16 v[158:159], v14 offset:38912
    v_mfma_f32_16x16x32_bf16 v[88:91], v[176:179], a[232:235], v[88:91]
    buffer_load_dwordx4 v12, s[28:31], s45 offen offset:1024 lds
    v_cvt_pk_bf16_f32 v206, v52, v53
    v_mfma_f32_16x16x32_bf16 v[88:91], v[180:183], a[248:251], v[88:91]
    ds_read_b64_tr_b16 v[160:161], v14 offset:40960
    v_mfma_f32_16x16x32_bf16 v[92:95], v[176:179], a[236:239], v[92:95]
    ds_read_b64_tr_b16 v[162:163], v14 offset:43008
    v_mfma_f32_16x16x32_bf16 v[92:95], v[180:183], a[252:255], v[92:95]
    buffer_load_dwordx4 v13, s[28:31], s45 offen offset:2048 lds
    v_mfma_f32_16x16x32_bf16 v[80:83], v[184:187], v[224:227], v[80:83]
    ds_read_b64_tr_b16 v[164:165], v14 offset:45056
    v_mfma_f32_16x16x32_bf16 v[80:83], v[188:191], v[240:243], v[80:83]
    ds_read_b64_tr_b16 v[166:167], v14 offset:47104
    v_mfma_f32_16x16x32_bf16 v[84:87], v[184:187], v[228:231], v[84:87]
    v_cvt_pk_bf16_f32 v207, v54, v55
    s_add_u32 s53, s52, 0
    buffer_store_dwordx4 v[204:207], v27, s[24:27], s53 offen offset:0 sc1
    v_mfma_f32_16x16x32_bf16 v[84:87], v[188:191], v[244:247], v[84:87]
    v_cvt_pk_bf16_f32 v208, v56, v57
    v_mfma_f32_16x16x32_bf16 v[88:91], v[184:187], v[232:235], v[88:91]
    v_cvt_pk_bf16_f32 v209, v58, v59
    v_mfma_f32_16x16x32_bf16 v[88:91], v[188:191], v[248:251], v[88:91]
    v_cvt_pk_bf16_f32 v210, v60, v61
    v_mfma_f32_16x16x32_bf16 v[92:95], v[184:187], v[236:239], v[92:95]
    v_cvt_pk_bf16_f32 v211, v62, v63
    v_mfma_f32_16x16x32_bf16 v[92:95], v[188:191], v[252:255], v[92:95]
    buffer_store_dwordx4 v[208:211], v27, s[24:27], s53 offen offset:1024 sc1
    s_waitcnt lgkmcnt(0) vmcnt(20)
    s_barrier
    v_mfma_f32_16x16x32_bf16 v[120:123], v[144:147], a[192:195], v[120:123]
    s_add_u32 m0, s46, 24576
    s_add_u32 s44, s48, 221696
    buffer_load_dwordx4 v11, s[28:31], s44 offen offset:0 lds
    v_cvt_pk_bf16_f32 v212, v80, v81
    v_mfma_f32_16x16x32_bf16 v[120:123], v[148:151], a[208:211], v[120:123]
    ds_read_b64_tr_b16 v[168:169], v15 offset:0
    v_mfma_f32_16x16x32_bf16 v[124:127], v[144:147], a[196:199], v[124:127]
    ds_read_b64_tr_b16 v[170:171], v15 offset:2048
    v_mfma_f32_16x16x32_bf16 v[124:127], v[148:151], a[212:215], v[124:127]
    buffer_load_dwordx4 v12, s[28:31], s44 offen offset:1024 lds
    v_mfma_f32_16x16x32_bf16 v[128:131], v[144:147], a[200:203], v[128:131]
    ds_read_b64_tr_b16 v[172:173], v15 offset:4096
    v_mfma_f32_16x16x32_bf16 v[128:131], v[148:151], a[216:219], v[128:131]
    ds_read_b64_tr_b16 v[174:175], v15 offset:6144
    v_mfma_f32_16x16x32_bf16 v[132:135], v[144:147], a[204:207], v[132:135]
    buffer_load_dwordx4 v13, s[28:31], s44 offen offset:2048 lds
    v_cvt_pk_bf16_f32 v213, v82, v83
    v_mfma_f32_16x16x32_bf16 v[132:135], v[148:151], a[220:223], v[132:135]
    ds_read_b64_tr_b16 v[176:177], v15 offset:8192
    v_mfma_f32_16x16x32_bf16 v[120:123], v[152:155], a[224:227], v[120:123]
    ds_read_b64_tr_b16 v[178:179], v15 offset:10240
    v_mfma_f32_16x16x32_bf16 v[120:123], v[156:159], a[240:243], v[120:123]
    s_add_u32 m0, s46, 27648
    s_add_u32 s45, s48, 249344
    buffer_load_dwordx4 v11, s[28:31], s45 offen offset:0 lds
    v_mfma_f32_16x16x32_bf16 v[124:127], v[152:155], a[228:231], v[124:127]
    ds_read_b64_tr_b16 v[180:181], v15 offset:12288
    v_mfma_f32_16x16x32_bf16 v[124:127], v[156:159], a[244:247], v[124:127]
    ds_read_b64_tr_b16 v[182:183], v15 offset:14336
    v_mfma_f32_16x16x32_bf16 v[128:131], v[152:155], a[232:235], v[128:131]
    buffer_load_dwordx4 v12, s[28:31], s45 offen offset:1024 lds
    v_cvt_pk_bf16_f32 v214, v84, v85
    v_mfma_f32_16x16x32_bf16 v[128:131], v[156:159], a[248:251], v[128:131]
    ds_read_b64_tr_b16 v[184:185], v15 offset:16384
    v_mfma_f32_16x16x32_bf16 v[132:135], v[152:155], a[236:239], v[132:135]
    ds_read_b64_tr_b16 v[186:187], v15 offset:18432
    v_mfma_f32_16x16x32_bf16 v[132:135], v[156:159], a[252:255], v[132:135]
    buffer_load_dwordx4 v13, s[28:31], s45 offen offset:2048 lds
    v_mfma_f32_16x16x32_bf16 v[120:123], v[160:163], v[224:227], v[120:123]
    ds_read_b64_tr_b16 v[188:189], v15 offset:20480
    v_mfma_f32_16x16x32_bf16 v[120:123], v[164:167], v[240:243], v[120:123]
    ds_read_b64_tr_b16 v[190:191], v15 offset:22528
    v_mfma_f32_16x16x32_bf16 v[124:127], v[160:163], v[228:231], v[124:127]
    v_cvt_pk_bf16_f32 v215, v86, v87
    s_add_u32 s53, s52, 8192
    buffer_store_dwordx4 v[212:215], v27, s[24:27], s53 offen offset:0 sc1
    v_mfma_f32_16x16x32_bf16 v[124:127], v[164:167], v[244:247], v[124:127]
    v_cvt_pk_bf16_f32 v216, v88, v89
    v_mfma_f32_16x16x32_bf16 v[128:131], v[160:163], v[232:235], v[128:131]
    v_cvt_pk_bf16_f32 v217, v90, v91
    v_mfma_f32_16x16x32_bf16 v[128:131], v[164:167], v[248:251], v[128:131]
    v_cvt_pk_bf16_f32 v218, v92, v93
    v_mfma_f32_16x16x32_bf16 v[132:135], v[160:163], v[236:239], v[132:135]
    v_cvt_pk_bf16_f32 v219, v94, v95
    v_mfma_f32_16x16x32_bf16 v[132:135], v[164:167], v[252:255], v[132:135]
    buffer_store_dwordx4 v[216:219], v27, s[24:27], s53 offen offset:1024 sc1
    s_waitcnt lgkmcnt(0) vmcnt(22)
    s_barrier
    v_mfma_f32_16x16x32_bf16 v[32:35], v[168:171], a[0:3], 0
    s_add_u32 m0, s46, 49152
    s_add_u32 s44, s48, 442880
    buffer_load_dwordx4 v11, s[28:31], s44 offen offset:0 lds
    v_cvt_pk_bf16_f32 v204, v120, v121
    v_mfma_f32_16x16x32_bf16 v[32:35], v[172:175], a[16:19], v[32:35]
    ds_read_b64_tr_b16 v[144:145], v15 offset:24576
    v_mfma_f32_16x16x32_bf16 v[36:39], v[168:171], a[4:7], 0
    ds_read_b64_tr_b16 v[146:147], v15 offset:26624
    v_mfma_f32_16x16x32_bf16 v[36:39], v[172:175], a[20:23], v[36:39]
    buffer_load_dwordx4 v12, s[28:31], s44 offen offset:1024 lds
    v_mfma_f32_16x16x32_bf16 v[40:43], v[168:171], a[8:11], 0
    ds_read_b64_tr_b16 v[148:149], v15 offset:28672
    v_mfma_f32_16x16x32_bf16 v[40:43], v[172:175], a[24:27], v[40:43]
    ds_read_b64_tr_b16 v[150:151], v15 offset:30720
    v_mfma_f32_16x16x32_bf16 v[44:47], v[168:171], a[12:15], 0
    buffer_load_dwordx4 v13, s[28:31], s44 offen offset:2048 lds
    v_cvt_pk_bf16_f32 v205, v122, v123
    v_mfma_f32_16x16x32_bf16 v[44:47], v[172:175], a[28:31], v[44:47]
    ds_read_b64_tr_b16 v[152:153], v15 offset:32768
    v_mfma_f32_16x16x32_bf16 v[32:35], v[176:179], a[32:35], v[32:35]
    ds_read_b64_tr_b16 v[154:155], v15 offset:34816
    v_mfma_f32_16x16x32_bf16 v[32:35], v[180:183], a[48:51], v[32:35]
    s_add_u32 m0, s46, 52224
    s_add_u32 s45, s48, 470528
    buffer_load_dwordx4 v11, s[28:31], s45 offen offset:0 lds
    v_mfma_f32_16x16x32_bf16 v[36:39], v[176:179], a[36:39], v[36:39]
    ds_read_b64_tr_b16 v[156:157], v15 offset:36864
    v_mfma_f32_16x16x32_bf16 v[36:39], v[180:183], a[52:55], v[36:39]
    ds_read_b64_tr_b16 v[158:159], v15 offset:38912
    v_mfma_f32_16x16x32_bf16 v[40:43], v[176:179], a[40:43], v[40:43]
    buffer_load_dwordx4 v12, s[28:31], s45 offen offset:1024 lds
    v_cvt_pk_bf16_f32 v206, v124, v125
    v_mfma_f32_16x16x32_bf16 v[40:43], v[180:183], a[56:59], v[40:43]
    ds_read_b64_tr_b16 v[160:161], v15 offset:40960
    v_mfma_f32_16x16x32_bf16 v[44:47], v[176:179], a[44:47], v[44:47]
    ds_read_b64_tr_b16 v[162:163], v15 offset:43008
    v_mfma_f32_16x16x32_bf16 v[44:47], v[180:183], a[60:63], v[44:47]
    buffer_load_dwordx4 v13, s[28:31], s45 offen offset:2048 lds
    v_mfma_f32_16x16x32_bf16 v[32:35], v[184:187], a[64:67], v[32:35]
    ds_read_b64_tr_b16 v[164:165], v15 offset:45056
    v_mfma_f32_16x16x32_bf16 v[32:35], v[188:191], a[80:83], v[32:35]
    ds_read_b64_tr_b16 v[166:167], v15 offset:47104
    v_mfma_f32_16x16x32_bf16 v[36:39], v[184:187], a[68:71], v[36:39]
    v_cvt_pk_bf16_f32 v207, v126, v127
    s_add_u32 s53, s52, 16384
    buffer_store_dwordx4 v[204:207], v27, s[24:27], s53 offen offset:0 sc1
    v_mfma_f32_16x16x32_bf16 v[36:39], v[188:191], a[84:87], v[36:39]
    v_cvt_pk_bf16_f32 v208, v128, v129
    v_mfma_f32_16x16x32_bf16 v[40:43], v[184:187], a[72:75], v[40:43]
    v_cvt_pk_bf16_f32 v209, v130, v131
    v_mfma_f32_16x16x32_bf16 v[40:43], v[188:191], a[88:91], v[40:43]
    v_cvt_pk_bf16_f32 v210, v132, v133
    v_mfma_f32_16x16x32_bf16 v[44:47], v[184:187], a[76:79], v[44:47]
    v_cvt_pk_bf16_f32 v211, v134, v135
    v_mfma_f32_16x16x32_bf16 v[44:47], v[188:191], a[92:95], v[44:47]
    buffer_store_dwordx4 v[208:211], v27, s[24:27], s53 offen offset:1024 sc1
    s_waitcnt lgkmcnt(0) vmcnt(24)
    s_barrier
    v_mfma_f32_16x16x32_bf16 v[32:35], v[144:147], a[96:99], v[32:35]
    s_add_u32 m0, s46, 73728
    s_add_u32 s44, s48, 640
    buffer_load_dwordx4 v11, s[28:31], s44 offen offset:0 lds
    v_mfma_f32_16x16x32_bf16 v[32:35], v[148:151], a[112:115], v[32:35]
    ds_read_b64_tr_b16 v[168:169], v14 offset:0
    v_mfma_f32_16x16x32_bf16 v[36:39], v[144:147], a[100:103], v[36:39]
    ds_read_b64_tr_b16 v[170:171], v14 offset:2048
    v_mfma_f32_16x16x32_bf16 v[36:39], v[148:151], a[116:119], v[36:39]
    buffer_load_dwordx4 v12, s[28:31], s44 offen offset:1024 lds
    v_mfma_f32_16x16x32_bf16 v[40:43], v[144:147], a[104:107], v[40:43]
    ds_read_b64_tr_b16 v[172:173], v14 offset:4096
    v_mfma_f32_16x16x32_bf16 v[40:43], v[148:151], a[120:123], v[40:43]
    ds_read_b64_tr_b16 v[174:175], v14 offset:6144
    v_mfma_f32_16x16x32_bf16 v[44:47], v[144:147], a[108:111], v[44:47]
    buffer_load_dwordx4 v13, s[28:31], s44 offen offset:2048 lds
    v_mfma_f32_16x16x32_bf16 v[44:47], v[148:151], a[124:127], v[44:47]
    ds_read_b64_tr_b16 v[176:177], v14 offset:8192
    v_mfma_f32_16x16x32_bf16 v[32:35], v[152:155], a[128:131], v[32:35]
    ds_read_b64_tr_b16 v[178:179], v14 offset:10240
    v_mfma_f32_16x16x32_bf16 v[32:35], v[156:159], a[144:147], v[32:35]
    s_add_u32 m0, s46, 76800
    s_add_u32 s45, s48, 28288
    buffer_load_dwordx4 v11, s[28:31], s45 offen offset:0 lds
    v_mfma_f32_16x16x32_bf16 v[36:39], v[152:155], a[132:135], v[36:39]
    ds_read_b64_tr_b16 v[180:181], v14 offset:12288
    v_mfma_f32_16x16x32_bf16 v[36:39], v[156:159], a[148:151], v[36:39]
    ds_read_b64_tr_b16 v[182:183], v14 offset:14336
    v_mfma_f32_16x16x32_bf16 v[40:43], v[152:155], a[136:139], v[40:43]
    buffer_load_dwordx4 v12, s[28:31], s45 offen offset:1024 lds
    v_mfma_f32_16x16x32_bf16 v[40:43], v[156:159], a[152:155], v[40:43]
    ds_read_b64_tr_b16 v[184:185], v14 offset:16384
    v_mfma_f32_16x16x32_bf16 v[44:47], v[152:155], a[140:143], v[44:47]
    ds_read_b64_tr_b16 v[186:187], v14 offset:18432
    v_mfma_f32_16x16x32_bf16 v[44:47], v[156:159], a[156:159], v[44:47]
    buffer_load_dwordx4 v13, s[28:31], s45 offen offset:2048 lds
    v_mfma_f32_16x16x32_bf16 v[32:35], v[160:163], a[160:163], v[32:35]
    ds_read_b64_tr_b16 v[188:189], v14 offset:20480
    v_mfma_f32_16x16x32_bf16 v[32:35], v[164:167], a[176:179], v[32:35]
    ds_read_b64_tr_b16 v[190:191], v14 offset:22528
    v_mfma_f32_16x16x32_bf16 v[36:39], v[160:163], a[164:167], v[36:39]
    v_mfma_f32_16x16x32_bf16 v[36:39], v[164:167], a[180:183], v[36:39]
    v_mfma_f32_16x16x32_bf16 v[40:43], v[160:163], a[168:171], v[40:43]
    v_mfma_f32_16x16x32_bf16 v[40:43], v[164:167], a[184:187], v[40:43]
    v_mfma_f32_16x16x32_bf16 v[44:47], v[160:163], a[172:175], v[44:47]
    v_mfma_f32_16x16x32_bf16 v[44:47], v[164:167], a[188:191], v[44:47]
    s_waitcnt lgkmcnt(0) vmcnt(24)
    s_barrier
    v_mfma_f32_16x16x32_bf16 v[32:35], v[168:171], a[192:195], v[32:35]
    s_add_u32 m0, s46, 0
    s_add_u32 s44, s48, 221824
    buffer_load_dwordx4 v11, s[28:31], s44 offen offset:0 lds
    v_mfma_f32_16x16x32_bf16 v[32:35], v[172:175], a[208:211], v[32:35]
    ds_read_b64_tr_b16 v[144:145], v16 offset:0
    v_mfma_f32_16x16x32_bf16 v[36:39], v[168:171], a[196:199], v[36:39]
    ds_read_b64_tr_b16 v[146:147], v16 offset:2048
    v_mfma_f32_16x16x32_bf16 v[36:39], v[172:175], a[212:215], v[36:39]
    buffer_load_dwordx4 v12, s[28:31], s44 offen offset:1024 lds
    v_mfma_f32_16x16x32_bf16 v[40:43], v[168:171], a[200:203], v[40:43]
    ds_read_b64_tr_b16 v[148:149], v16 offset:4096
    v_mfma_f32_16x16x32_bf16 v[40:43], v[172:175], a[216:219], v[40:43]
    ds_read_b64_tr_b16 v[150:151], v16 offset:6144
    v_mfma_f32_16x16x32_bf16 v[44:47], v[168:171], a[204:207], v[44:47]
    buffer_load_dwordx4 v13, s[28:31], s44 offen offset:2048 lds
    v_mfma_f32_16x16x32_bf16 v[44:47], v[172:175], a[220:223], v[44:47]
    ds_read_b64_tr_b16 v[152:153], v16 offset:8192
    v_mfma_f32_16x16x32_bf16 v[32:35], v[176:179], a[224:227], v[32:35]
    ds_read_b64_tr_b16 v[154:155], v16 offset:10240
    v_mfma_f32_16x16x32_bf16 v[32:35], v[180:183], a[240:243], v[32:35]
    s_add_u32 m0, s46, 3072
    s_add_u32 s45, s48, 249472
    buffer_load_dwordx4 v11, s[28:31], s45 offen offset:0 lds
    v_mfma_f32_16x16x32_bf16 v[36:39], v[176:179], a[228:231], v[36:39]
    ds_read_b64_tr_b16 v[156:157], v16 offset:12288
    v_mfma_f32_16x16x32_bf16 v[36:39], v[180:183], a[244:247], v[36:39]
    ds_read_b64_tr_b16 v[158:159], v16 offset:14336
    v_mfma_f32_16x16x32_bf16 v[40:43], v[176:179], a[232:235], v[40:43]
    buffer_load_dwordx4 v12, s[28:31], s45 offen offset:1024 lds
    v_mfma_f32_16x16x32_bf16 v[40:43], v[180:183], a[248:251], v[40:43]
    ds_read_b64_tr_b16 v[160:161], v16 offset:16384
    v_mfma_f32_16x16x32_bf16 v[44:47], v[176:179], a[236:239], v[44:47]
    ds_read_b64_tr_b16 v[162:163], v16 offset:18432
    v_mfma_f32_16x16x32_bf16 v[44:47], v[180:183], a[252:255], v[44:47]
    buffer_load_dwordx4 v13, s[28:31], s45 offen offset:2048 lds
    v_mfma_f32_16x16x32_bf16 v[32:35], v[184:187], v[224:227], v[32:35]
    ds_read_b64_tr_b16 v[164:165], v16 offset:20480
    v_mfma_f32_16x16x32_bf16 v[32:35], v[188:191], v[240:243], v[32:35]
    ds_read_b64_tr_b16 v[166:167], v16 offset:22528
    v_mfma_f32_16x16x32_bf16 v[36:39], v[184:187], v[228:231], v[36:39]
    v_mfma_f32_16x16x32_bf16 v[36:39], v[188:191], v[244:247], v[36:39]
    v_mfma_f32_16x16x32_bf16 v[40:43], v[184:187], v[232:235], v[40:43]
    v_mfma_f32_16x16x32_bf16 v[40:43], v[188:191], v[248:251], v[40:43]
    v_mfma_f32_16x16x32_bf16 v[44:47], v[184:187], v[236:239], v[44:47]
    v_mfma_f32_16x16x32_bf16 v[44:47], v[188:191], v[252:255], v[44:47]
    s_waitcnt lgkmcnt(0) vmcnt(22)
    s_barrier
    v_mfma_f32_16x16x32_bf16 v[64:67], v[144:147], a[0:3], 0
    s_add_u32 m0, s46, 98304
    s_add_u32 s44, s48, 443008
    buffer_load_dwordx4 v11, s[28:31], s44 offen offset:0 lds
    v_cvt_pk_bf16_f32 v212, v32, v33
    v_mfma_f32_16x16x32_bf16 v[64:67], v[148:151], a[16:19], v[64:67]
    ds_read_b64_tr_b16 v[168:169], v14 offset:24576
    v_mfma_f32_16x16x32_bf16 v[68:71], v[144:147], a[4:7], 0
    ds_read_b64_tr_b16 v[170:171], v14 offset:26624
    v_mfma_f32_16x16x32_bf16 v[68:71], v[148:151], a[20:23], v[68:71]
    buffer_load_dwordx4 v12, s[28:31], s44 offen offset:1024 lds
    v_mfma_f32_16x16x32_bf16 v[72:75], v[144:147], a[8:11], 0
    ds_read_b64_tr_b16 v[172:173], v14 offset:28672
    v_mfma_f32_16x16x32_bf16 v[72:75], v[148:151], a[24:27], v[72:75]
    ds_read_b64_tr_b16 v[174:175], v14 offset:30720
    v_mfma_f32_16x16x32_bf16 v[76:79], v[144:147], a[12:15], 0
    buffer_load_dwordx4 v13, s[28:31], s44 offen offset:2048 lds
    v_cvt_pk_bf16_f32 v213, v34, v35
    v_mfma_f32_16x16x32_bf16 v[76:79], v[148:151], a[28:31], v[76:79]
    ds_read_b64_tr_b16 v[176:177], v14 offset:32768
    v_mfma_f32_16x16x32_bf16 v[64:67], v[152:155], a[32:35], v[64:67]
    ds_read_b64_tr_b16 v[178:179], v14 offset:34816
    v_mfma_f32_16x16x32_bf16 v[64:67], v[156:159], a[48:51], v[64:67]
    s_add_u32 m0, s46, 101376
    s_add_u32 s45, s48, 470656
    buffer_load_dwordx4 v11, s[28:31], s45 offen offset:0 lds
    v_mfma_f32_16x16x32_bf16 v[68:71], v[152:155], a[36:39], v[68:71]
    ds_read_b64_tr_b16 v[180:181], v14 offset:36864
    v_mfma_f32_16x16x32_bf16 v[68:71], v[156:159], a[52:55], v[68:71]
    ds_read_b64_tr_b16 v[182:183], v14 offset:38912
    v_mfma_f32_16x16x32_bf16 v[72:75], v[152:155], a[40:43], v[72:75]
    buffer_load_dwordx4 v12, s[28:31], s45 offen offset:1024 lds
    v_cvt_pk_bf16_f32 v214, v36, v37
    v_mfma_f32_16x16x32_bf16 v[72:75], v[156:159], a[56:59], v[72:75]
    ds_read_b64_tr_b16 v[184:185], v14 offset:40960
    v_mfma_f32_16x16x32_bf16 v[76:79], v[152:155], a[44:47], v[76:79]
    ds_read_b64_tr_b16 v[186:187], v14 offset:43008
    v_mfma_f32_16x16x32_bf16 v[76:79], v[156:159], a[60:63], v[76:79]
    buffer_load_dwordx4 v13, s[28:31], s45 offen offset:2048 lds
    v_mfma_f32_16x16x32_bf16 v[64:67], v[160:163], a[64:67], v[64:67]
    ds_read_b64_tr_b16 v[188:189], v14 offset:45056
    v_mfma_f32_16x16x32_bf16 v[64:67], v[164:167], a[80:83], v[64:67]
    ds_read_b64_tr_b16 v[190:191], v14 offset:47104
    v_mfma_f32_16x16x32_bf16 v[68:71], v[160:163], a[68:71], v[68:71]
    v_cvt_pk_bf16_f32 v215, v38, v39
    s_add_u32 s53, s52, 24576
    buffer_store_dwordx4 v[212:215], v27, s[24:27], s53 offen offset:0 sc1
    v_mfma_f32_16x16x32_bf16 v[68:71], v[164:167], a[84:87], v[68:71]
    v_cvt_pk_bf16_f32 v216, v40, v41
    v_mfma_f32_16x16x32_bf16 v[72:75], v[160:163], a[72:75], v[72:75]
    v_cvt_pk_bf16_f32 v217, v42, v43
    v_mfma_f32_16x16x32_bf16 v[72:75], v[164:167], a[88:91], v[72:75]
    v_cvt_pk_bf16_f32 v218, v44, v45
    v_mfma_f32_16x16x32_bf16 v[76:79], v[160:163], a[76:79], v[76:79]
    v_cvt_pk_bf16_f32 v219, v46, v47
    v_mfma_f32_16x16x32_bf16 v[76:79], v[164:167], a[92:95], v[76:79]
    buffer_store_dwordx4 v[216:219], v27, s[24:27], s53 offen offset:1024 sc1
    s_waitcnt lgkmcnt(0) vmcnt(22)
    s_barrier
    v_mfma_f32_16x16x32_bf16 v[64:67], v[168:171], a[96:99], v[64:67]
    s_add_u32 m0, s46, 24576
    s_add_u32 s44, s48, 768
    buffer_load_dwordx4 v11, s[28:31], s44 offen offset:0 lds
    v_mfma_f32_16x16x32_bf16 v[64:67], v[172:175], a[112:115], v[64:67]
    ds_read_b64_tr_b16 v[144:145], v15 offset:0
    v_mfma_f32_16x16x32_bf16 v[68:71], v[168:171], a[100:103], v[68:71]
    ds_read_b64_tr_b16 v[146:147], v15 offset:2048
    v_mfma_f32_16x16x32_bf16 v[68:71], v[172:175], a[116:119], v[68:71]
    buffer_load_dwordx4 v12, s[28:31], s44 offen offset:1024 lds
    v_mfma_f32_16x16x32_bf16 v[72:75], v[168:171], a[104:107], v[72:75]
    ds_read_b64_tr_b16 v[148:149], v15 offset:4096
    v_mfma_f32_16x16x32_bf16 v[72:75], v[172:175], a[120:123], v[72:75]
    ds_read_b64_tr_b16 v[150:151], v15 offset:6144
    v_mfma_f32_16x16x32_bf16 v[76:79], v[168:171], a[108:111], v[76:79]
    buffer_load_dwordx4 v13, s[28:31], s44 offen offset:2048 lds
    v_mfma_f32_16x16x32_bf16 v[76:79], v[172:175], a[124:127], v[76:79]
    ds_read_b64_tr_b16 v[152:153], v15 offset:8192
    v_mfma_f32_16x16x32_bf16 v[64:67], v[176:179], a[128:131], v[64:67]
    ds_read_b64_tr_b16 v[154:155], v15 offset:10240
    v_mfma_f32_16x16x32_bf16 v[64:67], v[180:183], a[144:147], v[64:67]
    s_add_u32 m0, s46, 27648
    s_add_u32 s45, s48, 28416
    buffer_load_dwordx4 v11, s[28:31], s45 offen offset:0 lds
    v_mfma_f32_16x16x32_bf16 v[68:71], v[176:179], a[132:135], v[68:71]
    ds_read_b64_tr_b16 v[156:157], v15 offset:12288
    v_mfma_f32_16x16x32_bf16 v[68:71], v[180:183], a[148:151], v[68:71]
    ds_read_b64_tr_b16 v[158:159], v15 offset:14336
    v_mfma_f32_16x16x32_bf16 v[72:75], v[176:179], a[136:139], v[72:75]
    buffer_load_dwordx4 v12, s[28:31], s45 offen offset:1024 lds
    v_mfma_f32_16x16x32_bf16 v[72:75], v[180:183], a[152:155], v[72:75]
    ds_read_b64_tr_b16 v[160:161], v15 offset:16384
    v_mfma_f32_16x16x32_bf16 v[76:79], v[176:179], a[140:143], v[76:79]
    ds_read_b64_tr_b16 v[162:163], v15 offset:18432
    v_mfma_f32_16x16x32_bf16 v[76:79], v[180:183], a[156:159], v[76:79]
    buffer_load_dwordx4 v13, s[28:31], s45 offen offset:2048 lds
    v_mfma_f32_16x16x32_bf16 v[64:67], v[184:187], a[160:163], v[64:67]
    ds_read_b64_tr_b16 v[164:165], v15 offset:20480
    v_mfma_f32_16x16x32_bf16 v[64:67], v[188:191], a[176:179], v[64:67]
    ds_read_b64_tr_b16 v[166:167], v15 offset:22528
    v_mfma_f32_16x16x32_bf16 v[68:71], v[184:187], a[164:167], v[68:71]
    v_mfma_f32_16x16x32_bf16 v[68:71], v[188:191], a[180:183], v[68:71]
    v_mfma_f32_16x16x32_bf16 v[72:75], v[184:187], a[168:171], v[72:75]
    v_mfma_f32_16x16x32_bf16 v[72:75], v[188:191], a[184:187], v[72:75]
    v_mfma_f32_16x16x32_bf16 v[76:79], v[184:187], a[172:175], v[76:79]
    v_mfma_f32_16x16x32_bf16 v[76:79], v[188:191], a[188:191], v[76:79]
    s_waitcnt lgkmcnt(0) vmcnt(20)
    s_barrier
    v_mfma_f32_16x16x32_bf16 v[64:67], v[144:147], a[192:195], v[64:67]
    s_add_u32 m0, s46, 49152
    s_add_u32 s44, s48, 221952
    buffer_load_dwordx4 v11, s[28:31], s44 offen offset:0 lds
    v_mfma_f32_16x16x32_bf16 v[64:67], v[148:151], a[208:211], v[64:67]
    ds_read_b64_tr_b16 v[168:169], v15 offset:24576
    v_mfma_f32_16x16x32_bf16 v[68:71], v[144:147], a[196:199], v[68:71]
    ds_read_b64_tr_b16 v[170:171], v15 offset:26624
    v_mfma_f32_16x16x32_bf16 v[68:71], v[148:151], a[212:215], v[68:71]
    buffer_load_dwordx4 v12, s[28:31], s44 offen offset:1024 lds
    v_mfma_f32_16x16x32_bf16 v[72:75], v[144:147], a[200:203], v[72:75]
    ds_read_b64_tr_b16 v[172:173], v15 offset:28672
    v_mfma_f32_16x16x32_bf16 v[72:75], v[148:151], a[216:219], v[72:75]
    ds_read_b64_tr_b16 v[174:175], v15 offset:30720
    v_mfma_f32_16x16x32_bf16 v[76:79], v[144:147], a[204:207], v[76:79]
    buffer_load_dwordx4 v13, s[28:31], s44 offen offset:2048 lds
    v_mfma_f32_16x16x32_bf16 v[76:79], v[148:151], a[220:223], v[76:79]
    ds_read_b64_tr_b16 v[176:177], v15 offset:32768
    v_mfma_f32_16x16x32_bf16 v[64:67], v[152:155], a[224:227], v[64:67]
    ds_read_b64_tr_b16 v[178:179], v15 offset:34816
    v_mfma_f32_16x16x32_bf16 v[64:67], v[156:159], a[240:243], v[64:67]
    s_add_u32 m0, s46, 52224
    s_add_u32 s45, s48, 249600
    buffer_load_dwordx4 v11, s[28:31], s45 offen offset:0 lds
    v_mfma_f32_16x16x32_bf16 v[68:71], v[152:155], a[228:231], v[68:71]
    ds_read_b64_tr_b16 v[180:181], v15 offset:36864
    v_mfma_f32_16x16x32_bf16 v[68:71], v[156:159], a[244:247], v[68:71]
    ds_read_b64_tr_b16 v[182:183], v15 offset:38912
    v_mfma_f32_16x16x32_bf16 v[72:75], v[152:155], a[232:235], v[72:75]
    buffer_load_dwordx4 v12, s[28:31], s45 offen offset:1024 lds
    v_mfma_f32_16x16x32_bf16 v[72:75], v[156:159], a[248:251], v[72:75]
    ds_read_b64_tr_b16 v[184:185], v15 offset:40960
    v_mfma_f32_16x16x32_bf16 v[76:79], v[152:155], a[236:239], v[76:79]
    ds_read_b64_tr_b16 v[186:187], v15 offset:43008
    v_mfma_f32_16x16x32_bf16 v[76:79], v[156:159], a[252:255], v[76:79]
    buffer_load_dwordx4 v13, s[28:31], s45 offen offset:2048 lds
    v_mfma_f32_16x16x32_bf16 v[64:67], v[160:163], v[224:227], v[64:67]
    ds_read_b64_tr_b16 v[188:189], v15 offset:45056
    v_mfma_f32_16x16x32_bf16 v[64:67], v[164:167], v[240:243], v[64:67]
    ds_read_b64_tr_b16 v[190:191], v15 offset:47104
    v_mfma_f32_16x16x32_bf16 v[68:71], v[160:163], v[228:231], v[68:71]
    v_mfma_f32_16x16x32_bf16 v[68:71], v[164:167], v[244:247], v[68:71]
    v_mfma_f32_16x16x32_bf16 v[72:75], v[160:163], v[232:235], v[72:75]
    v_mfma_f32_16x16x32_bf16 v[72:75], v[164:167], v[248:251], v[72:75]
    v_mfma_f32_16x16x32_bf16 v[76:79], v[160:163], v[236:239], v[76:79]
    v_mfma_f32_16x16x32_bf16 v[76:79], v[164:167], v[252:255], v[76:79]
    s_waitcnt lgkmcnt(0) vmcnt(20)
    s_barrier
    v_mfma_f32_16x16x32_bf16 v[48:51], v[168:171], a[0:3], 0
    s_add_u32 m0, s46, 73728
    s_add_u32 s44, s48, 443136
    buffer_load_dwordx4 v11, s[28:31], s44 offen offset:0 lds
    v_cvt_pk_bf16_f32 v204, v64, v65
    v_mfma_f32_16x16x32_bf16 v[48:51], v[172:175], a[16:19], v[48:51]
    ds_read_b64_tr_b16 v[144:145], v14 offset:0
    v_mfma_f32_16x16x32_bf16 v[52:55], v[168:171], a[4:7], 0
    ds_read_b64_tr_b16 v[146:147], v14 offset:2048
    v_mfma_f32_16x16x32_bf16 v[52:55], v[172:175], a[20:23], v[52:55]
    buffer_load_dwordx4 v12, s[28:31], s44 offen offset:1024 lds
    v_mfma_f32_16x16x32_bf16 v[56:59], v[168:171], a[8:11], 0
    ds_read_b64_tr_b16 v[148:149], v14 offset:4096
    v_mfma_f32_16x16x32_bf16 v[56:59], v[172:175], a[24:27], v[56:59]
    ds_read_b64_tr_b16 v[150:151], v14 offset:6144
    v_mfma_f32_16x16x32_bf16 v[60:63], v[168:171], a[12:15], 0
    buffer_load_dwordx4 v13, s[28:31], s44 offen offset:2048 lds
    v_cvt_pk_bf16_f32 v205, v66, v67
    v_mfma_f32_16x16x32_bf16 v[60:63], v[172:175], a[28:31], v[60:63]
    ds_read_b64_tr_b16 v[152:153], v14 offset:8192
    v_mfma_f32_16x16x32_bf16 v[48:51], v[176:179], a[32:35], v[48:51]
    ds_read_b64_tr_b16 v[154:155], v14 offset:10240
    v_mfma_f32_16x16x32_bf16 v[48:51], v[180:183], a[48:51], v[48:51]
    s_add_u32 m0, s46, 76800
    s_add_u32 s45, s48, 470784
    buffer_load_dwordx4 v11, s[28:31], s45 offen offset:0 lds
    v_mfma_f32_16x16x32_bf16 v[52:55], v[176:179], a[36:39], v[52:55]
    ds_read_b64_tr_b16 v[156:157], v14 offset:12288
    v_mfma_f32_16x16x32_bf16 v[52:55], v[180:183], a[52:55], v[52:55]
    ds_read_b64_tr_b16 v[158:159], v14 offset:14336
    v_mfma_f32_16x16x32_bf16 v[56:59], v[176:179], a[40:43], v[56:59]
    buffer_load_dwordx4 v12, s[28:31], s45 offen offset:1024 lds
    v_cvt_pk_bf16_f32 v206, v68, v69
    v_mfma_f32_16x16x32_bf16 v[56:59], v[180:183], a[56:59], v[56:59]
    ds_read_b64_tr_b16 v[160:161], v14 offset:16384
    v_mfma_f32_16x16x32_bf16 v[60:63], v[176:179], a[44:47], v[60:63]
    ds_read_b64_tr_b16 v[162:163], v14 offset:18432
    v_mfma_f32_16x16x32_bf16 v[60:63], v[180:183], a[60:63], v[60:63]
    buffer_load_dwordx4 v13, s[28:31], s45 offen offset:2048 lds
    v_mfma_f32_16x16x32_bf16 v[48:51], v[184:187], a[64:67], v[48:51]
    ds_read_b64_tr_b16 v[164:165], v14 offset:20480
    v_mfma_f32_16x16x32_bf16 v[48:51], v[188:191], a[80:83], v[48:51]
    ds_read_b64_tr_b16 v[166:167], v14 offset:22528
    v_mfma_f32_16x16x32_bf16 v[52:55], v[184:187], a[68:71], v[52:55]
    v_cvt_pk_bf16_f32 v207, v70, v71
    s_add_u32 s53, s52, 32768
    buffer_store_dwordx4 v[204:207], v27, s[24:27], s53 offen offset:0 sc1
    v_mfma_f32_16x16x32_bf16 v[52:55], v[188:191], a[84:87], v[52:55]
    v_cvt_pk_bf16_f32 v208, v72, v73
    v_mfma_f32_16x16x32_bf16 v[56:59], v[184:187], a[72:75], v[56:59]
    v_cvt_pk_bf16_f32 v209, v74, v75
    v_mfma_f32_16x16x32_bf16 v[56:59], v[188:191], a[88:91], v[56:59]
    v_cvt_pk_bf16_f32 v210, v76, v77
    v_mfma_f32_16x16x32_bf16 v[60:63], v[184:187], a[76:79], v[60:63]
    v_cvt_pk_bf16_f32 v211, v78, v79
    v_mfma_f32_16x16x32_bf16 v[60:63], v[188:191], a[92:95], v[60:63]
    buffer_store_dwordx4 v[208:211], v27, s[24:27], s53 offen offset:1024 sc1
    s_waitcnt lgkmcnt(0) vmcnt(22)
    s_barrier
    v_mfma_f32_16x16x32_bf16 v[48:51], v[144:147], a[96:99], v[48:51]
    s_add_u32 m0, s46, 0
    s_add_u32 s44, s48, 896
    buffer_load_dwordx4 v11, s[28:31], s44 offen offset:0 lds
    v_mfma_f32_16x16x32_bf16 v[48:51], v[148:151], a[112:115], v[48:51]
    ds_read_b64_tr_b16 v[168:169], v16 offset:0
    v_mfma_f32_16x16x32_bf16 v[52:55], v[144:147], a[100:103], v[52:55]
    ds_read_b64_tr_b16 v[170:171], v16 offset:2048
    v_mfma_f32_16x16x32_bf16 v[52:55], v[148:151], a[116:119], v[52:55]
    buffer_load_dwordx4 v12, s[28:31], s44 offen offset:1024 lds
    v_mfma_f32_16x16x32_bf16 v[56:59], v[144:147], a[104:107], v[56:59]
    ds_read_b64_tr_b16 v[172:173], v16 offset:4096
    v_mfma_f32_16x16x32_bf16 v[56:59], v[148:151], a[120:123], v[56:59]
    ds_read_b64_tr_b16 v[174:175], v16 offset:6144
    v_mfma_f32_16x16x32_bf16 v[60:63], v[144:147], a[108:111], v[60:63]
    buffer_load_dwordx4 v13, s[28:31], s44 offen offset:2048 lds
    v_mfma_f32_16x16x32_bf16 v[60:63], v[148:151], a[124:127], v[60:63]
    ds_read_b64_tr_b16 v[176:177], v16 offset:8192
    v_mfma_f32_16x16x32_bf16 v[48:51], v[152:155], a[128:131], v[48:51]
    ds_read_b64_tr_b16 v[178:179], v16 offset:10240
    v_mfma_f32_16x16x32_bf16 v[48:51], v[156:159], a[144:147], v[48:51]
    s_add_u32 m0, s46, 3072
    s_add_u32 s45, s48, 28544
    buffer_load_dwordx4 v11, s[28:31], s45 offen offset:0 lds
    v_mfma_f32_16x16x32_bf16 v[52:55], v[152:155], a[132:135], v[52:55]
    ds_read_b64_tr_b16 v[180:181], v16 offset:12288
    v_mfma_f32_16x16x32_bf16 v[52:55], v[156:159], a[148:151], v[52:55]
    ds_read_b64_tr_b16 v[182:183], v16 offset:14336
    v_mfma_f32_16x16x32_bf16 v[56:59], v[152:155], a[136:139], v[56:59]
    buffer_load_dwordx4 v12, s[28:31], s45 offen offset:1024 lds
    v_mfma_f32_16x16x32_bf16 v[56:59], v[156:159], a[152:155], v[56:59]
    ds_read_b64_tr_b16 v[184:185], v16 offset:16384
    v_mfma_f32_16x16x32_bf16 v[60:63], v[152:155], a[140:143], v[60:63]
    ds_read_b64_tr_b16 v[186:187], v16 offset:18432
    v_mfma_f32_16x16x32_bf16 v[60:63], v[156:159], a[156:159], v[60:63]
    buffer_load_dwordx4 v13, s[28:31], s45 offen offset:2048 lds
    v_mfma_f32_16x16x32_bf16 v[48:51], v[160:163], a[160:163], v[48:51]
    ds_read_b64_tr_b16 v[188:189], v16 offset:20480
    v_mfma_f32_16x16x32_bf16 v[48:51], v[164:167], a[176:179], v[48:51]
    ds_read_b64_tr_b16 v[190:191], v16 offset:22528
    v_mfma_f32_16x16x32_bf16 v[52:55], v[160:163], a[164:167], v[52:55]
    v_mfma_f32_16x16x32_bf16 v[52:55], v[164:167], a[180:183], v[52:55]
    v_mfma_f32_16x16x32_bf16 v[56:59], v[160:163], a[168:171], v[56:59]
    v_mfma_f32_16x16x32_bf16 v[56:59], v[164:167], a[184:187], v[56:59]
    v_mfma_f32_16x16x32_bf16 v[60:63], v[160:163], a[172:175], v[60:63]
    v_mfma_f32_16x16x32_bf16 v[60:63], v[164:167], a[188:191], v[60:63]
    s_waitcnt lgkmcnt(0) vmcnt(20)
    s_barrier
    v_mfma_f32_16x16x32_bf16 v[48:51], v[168:171], a[192:195], v[48:51]
    s_add_u32 m0, s46, 98304
    s_add_u32 s44, s48, 222080
    buffer_load_dwordx4 v11, s[28:31], s44 offen offset:0 lds
    v_mfma_f32_16x16x32_bf16 v[48:51], v[172:175], a[208:211], v[48:51]
    ds_read_b64_tr_b16 v[144:145], v14 offset:24576
    v_mfma_f32_16x16x32_bf16 v[52:55], v[168:171], a[196:199], v[52:55]
    ds_read_b64_tr_b16 v[146:147], v14 offset:26624
    v_mfma_f32_16x16x32_bf16 v[52:55], v[172:175], a[212:215], v[52:55]
    buffer_load_dwordx4 v12, s[28:31], s44 offen offset:1024 lds
    v_mfma_f32_16x16x32_bf16 v[56:59], v[168:171], a[200:203], v[56:59]
    ds_read_b64_tr_b16 v[148:149], v14 offset:28672
    v_mfma_f32_16x16x32_bf16 v[56:59], v[172:175], a[216:219], v[56:59]
    ds_read_b64_tr_b16 v[150:151], v14 offset:30720
    v_mfma_f32_16x16x32_bf16 v[60:63], v[168:171], a[204:207], v[60:63]
    buffer_load_dwordx4 v13, s[28:31], s44 offen offset:2048 lds
    v_mfma_f32_16x16x32_bf16 v[60:63], v[172:175], a[220:223], v[60:63]
    ds_read_b64_tr_b16 v[152:153], v14 offset:32768
    v_mfma_f32_16x16x32_bf16 v[48:51], v[176:179], a[224:227], v[48:51]
    ds_read_b64_tr_b16 v[154:155], v14 offset:34816
    v_mfma_f32_16x16x32_bf16 v[48:51], v[180:183], a[240:243], v[48:51]
    s_add_u32 m0, s46, 101376
    s_add_u32 s45, s48, 249728
    buffer_load_dwordx4 v11, s[28:31], s45 offen offset:0 lds
    v_mfma_f32_16x16x32_bf16 v[52:55], v[176:179], a[228:231], v[52:55]
    ds_read_b64_tr_b16 v[156:157], v14 offset:36864
    v_mfma_f32_16x16x32_bf16 v[52:55], v[180:183], a[244:247], v[52:55]
    ds_read_b64_tr_b16 v[158:159], v14 offset:38912
    v_mfma_f32_16x16x32_bf16 v[56:59], v[176:179], a[232:235], v[56:59]
    buffer_load_dwordx4 v12, s[28:31], s45 offen offset:1024 lds
    v_mfma_f32_16x16x32_bf16 v[56:59], v[180:183], a[248:251], v[56:59]
    ds_read_b64_tr_b16 v[160:161], v14 offset:40960
    v_mfma_f32_16x16x32_bf16 v[60:63], v[176:179], a[236:239], v[60:63]
    ds_read_b64_tr_b16 v[162:163], v14 offset:43008
    v_mfma_f32_16x16x32_bf16 v[60:63], v[180:183], a[252:255], v[60:63]
    buffer_load_dwordx4 v13, s[28:31], s45 offen offset:2048 lds
    v_mfma_f32_16x16x32_bf16 v[48:51], v[184:187], v[224:227], v[48:51]
    ds_read_b64_tr_b16 v[164:165], v14 offset:45056
    v_mfma_f32_16x16x32_bf16 v[48:51], v[188:191], v[240:243], v[48:51]
    ds_read_b64_tr_b16 v[166:167], v14 offset:47104
    v_mfma_f32_16x16x32_bf16 v[52:55], v[184:187], v[228:231], v[52:55]
    v_mfma_f32_16x16x32_bf16 v[52:55], v[188:191], v[244:247], v[52:55]
    v_mfma_f32_16x16x32_bf16 v[56:59], v[184:187], v[232:235], v[56:59]
    v_mfma_f32_16x16x32_bf16 v[56:59], v[188:191], v[248:251], v[56:59]
    v_mfma_f32_16x16x32_bf16 v[60:63], v[184:187], v[236:239], v[60:63]
    v_mfma_f32_16x16x32_bf16 v[60:63], v[188:191], v[252:255], v[60:63]
    s_waitcnt lgkmcnt(0) vmcnt(20)
    s_barrier
    v_mfma_f32_16x16x32_bf16 v[80:83], v[144:147], a[0:3], 0
    s_add_u32 m0, s46, 24576
    s_add_u32 s44, s48, 443264
    buffer_load_dwordx4 v11, s[28:31], s44 offen offset:0 lds
    v_cvt_pk_bf16_f32 v212, v48, v49
    v_mfma_f32_16x16x32_bf16 v[80:83], v[148:151], a[16:19], v[80:83]
    ds_read_b64_tr_b16 v[168:169], v15 offset:0
    v_mfma_f32_16x16x32_bf16 v[84:87], v[144:147], a[4:7], 0
    ds_read_b64_tr_b16 v[170:171], v15 offset:2048
    v_mfma_f32_16x16x32_bf16 v[84:87], v[148:151], a[20:23], v[84:87]
    buffer_load_dwordx4 v12, s[28:31], s44 offen offset:1024 lds
    v_mfma_f32_16x16x32_bf16 v[88:91], v[144:147], a[8:11], 0
    ds_read_b64_tr_b16 v[172:173], v15 offset:4096
    v_mfma_f32_16x16x32_bf16 v[88:91], v[148:151], a[24:27], v[88:91]
    ds_read_b64_tr_b16 v[174:175], v15 offset:6144
    v_mfma_f32_16x16x32_bf16 v[92:95], v[144:147], a[12:15], 0
    buffer_load_dwordx4 v13, s[28:31], s44 offen offset:2048 lds
    v_cvt_pk_bf16_f32 v213, v50, v51
    v_mfma_f32_16x16x32_bf16 v[92:95], v[148:151], a[28:31], v[92:95]
    ds_read_b64_tr_b16 v[176:177], v15 offset:8192
    v_mfma_f32_16x16x32_bf16 v[80:83], v[152:155], a[32:35], v[80:83]
    ds_read_b64_tr_b16 v[178:179], v15 offset:10240
    v_mfma_f32_16x16x32_bf16 v[80:83], v[156:159], a[48:51], v[80:83]
    s_add_u32 m0, s46, 27648
    s_add_u32 s45, s48, 470912
    buffer_load_dwordx4 v11, s[28:31], s45 offen offset:0 lds
    v_mfma_f32_16x16x32_bf16 v[84:87], v[152:155], a[36:39], v[84:87]
    ds_read_b64_tr_b16 v[180:181], v15 offset:12288
    v_mfma_f32_16x16x32_bf16 v[84:87], v[156:159], a[52:55], v[84:87]
    ds_read_b64_tr_b16 v[182:183], v15 offset:14336
    v_mfma_f32_16x16x32_bf16 v[88:91], v[152:155], a[40:43], v[88:91]
    buffer_load_dwordx4 v12, s[28:31], s45 offen offset:1024 lds
    v_cvt_pk_bf16_f32 v214, v52, v53
    v_mfma_f32_16x16x32_bf16 v[88:91], v[156:159], a[56:59], v[88:91]
    ds_read_b64_tr_b16 v[184:185], v15 offset:16384
    v_mfma_f32_16x16x32_bf16 v[92:95], v[152:155], a[44:47], v[92:95]
    ds_read_b64_tr_b16 v[186:187], v15 offset:18432
    v_mfma_f32_16x16x32_bf16 v[92:95], v[156:159], a[60:63], v[92:95]
    buffer_load_dwordx4 v13, s[28:31], s45 offen offset:2048 lds
    v_mfma_f32_16x16x32_bf16 v[80:83], v[160:163], a[64:67], v[80:83]
    ds_read_b64_tr_b16 v[188:189], v15 offset:20480
    v_mfma_f32_16x16x32_bf16 v[80:83], v[164:167], a[80:83], v[80:83]
    ds_read_b64_tr_b16 v[190:191], v15 offset:22528
    v_mfma_f32_16x16x32_bf16 v[84:87], v[160:163], a[68:71], v[84:87]
    v_cvt_pk_bf16_f32 v215, v54, v55
    s_add_u32 s53, s52, 40960
    buffer_store_dwordx4 v[212:215], v27, s[24:27], s53 offen offset:0 sc1
    v_mfma_f32_16x16x32_bf16 v[84:87], v[164:167], a[84:87], v[84:87]
    v_cvt_pk_bf16_f32 v216, v56, v57
    v_mfma_f32_16x16x32_bf16 v[88:91], v[160:163], a[72:75], v[88:91]
    v_cvt_pk_bf16_f32 v217, v58, v59
    v_mfma_f32_16x16x32_bf16 v[88:91], v[164:167], a[88:91], v[88:91]
    v_cvt_pk_bf16_f32 v218, v60, v61
    v_mfma_f32_16x16x32_bf16 v[92:95], v[160:163], a[76:79], v[92:95]
    v_cvt_pk_bf16_f32 v219, v62, v63
    v_mfma_f32_16x16x32_bf16 v[92:95], v[164:167], a[92:95], v[92:95]
    buffer_store_dwordx4 v[216:219], v27, s[24:27], s53 offen offset:1024 sc1
    s_waitcnt lgkmcnt(0) vmcnt(22)
    s_barrier
    v_mfma_f32_16x16x32_bf16 v[80:83], v[168:171], a[96:99], v[80:83]
    s_add_u32 m0, s46, 49152
    s_add_u32 s44, s48, 1024
    buffer_load_dwordx4 v11, s[28:31], s44 offen offset:0 lds
    v_mfma_f32_16x16x32_bf16 v[80:83], v[172:175], a[112:115], v[80:83]
    ds_read_b64_tr_b16 v[144:145], v15 offset:24576
    v_mfma_f32_16x16x32_bf16 v[84:87], v[168:171], a[100:103], v[84:87]
    ds_read_b64_tr_b16 v[146:147], v15 offset:26624
    v_mfma_f32_16x16x32_bf16 v[84:87], v[172:175], a[116:119], v[84:87]
    buffer_load_dwordx4 v12, s[28:31], s44 offen offset:1024 lds
    v_mfma_f32_16x16x32_bf16 v[88:91], v[168:171], a[104:107], v[88:91]
    ds_read_b64_tr_b16 v[148:149], v15 offset:28672
    v_mfma_f32_16x16x32_bf16 v[88:91], v[172:175], a[120:123], v[88:91]
    ds_read_b64_tr_b16 v[150:151], v15 offset:30720
    v_mfma_f32_16x16x32_bf16 v[92:95], v[168:171], a[108:111], v[92:95]
    buffer_load_dwordx4 v13, s[28:31], s44 offen offset:2048 lds
    v_mfma_f32_16x16x32_bf16 v[92:95], v[172:175], a[124:127], v[92:95]
    ds_read_b64_tr_b16 v[152:153], v15 offset:32768
    v_mfma_f32_16x16x32_bf16 v[80:83], v[176:179], a[128:131], v[80:83]
    ds_read_b64_tr_b16 v[154:155], v15 offset:34816
    v_mfma_f32_16x16x32_bf16 v[80:83], v[180:183], a[144:147], v[80:83]
    s_add_u32 m0, s46, 52224
    s_add_u32 s45, s48, 28672
    buffer_load_dwordx4 v11, s[28:31], s45 offen offset:0 lds
    v_mfma_f32_16x16x32_bf16 v[84:87], v[176:179], a[132:135], v[84:87]
    ds_read_b64_tr_b16 v[156:157], v15 offset:36864
    v_mfma_f32_16x16x32_bf16 v[84:87], v[180:183], a[148:151], v[84:87]
    ds_read_b64_tr_b16 v[158:159], v15 offset:38912
    v_mfma_f32_16x16x32_bf16 v[88:91], v[176:179], a[136:139], v[88:91]
    buffer_load_dwordx4 v12, s[28:31], s45 offen offset:1024 lds
    v_mfma_f32_16x16x32_bf16 v[88:91], v[180:183], a[152:155], v[88:91]
    ds_read_b64_tr_b16 v[160:161], v15 offset:40960
    v_mfma_f32_16x16x32_bf16 v[92:95], v[176:179], a[140:143], v[92:95]
    ds_read_b64_tr_b16 v[162:163], v15 offset:43008
    v_mfma_f32_16x16x32_bf16 v[92:95], v[180:183], a[156:159], v[92:95]
    buffer_load_dwordx4 v13, s[28:31], s45 offen offset:2048 lds
    v_mfma_f32_16x16x32_bf16 v[80:83], v[184:187], a[160:163], v[80:83]
    ds_read_b64_tr_b16 v[164:165], v15 offset:45056
    v_mfma_f32_16x16x32_bf16 v[80:83], v[188:191], a[176:179], v[80:83]
    ds_read_b64_tr_b16 v[166:167], v15 offset:47104
    v_mfma_f32_16x16x32_bf16 v[84:87], v[184:187], a[164:167], v[84:87]
    v_mfma_f32_16x16x32_bf16 v[84:87], v[188:191], a[180:183], v[84:87]
    v_mfma_f32_16x16x32_bf16 v[88:91], v[184:187], a[168:171], v[88:91]
    v_mfma_f32_16x16x32_bf16 v[88:91], v[188:191], a[184:187], v[88:91]
    v_mfma_f32_16x16x32_bf16 v[92:95], v[184:187], a[172:175], v[92:95]
    v_mfma_f32_16x16x32_bf16 v[92:95], v[188:191], a[188:191], v[92:95]
    s_waitcnt lgkmcnt(0) vmcnt(20)
    s_barrier
    v_mfma_f32_16x16x32_bf16 v[80:83], v[144:147], a[192:195], v[80:83]
    s_add_u32 m0, s46, 73728
    s_add_u32 s44, s48, 222208
    buffer_load_dwordx4 v11, s[28:31], s44 offen offset:0 lds
    v_mfma_f32_16x16x32_bf16 v[80:83], v[148:151], a[208:211], v[80:83]
    ds_read_b64_tr_b16 v[168:169], v14 offset:0
    v_mfma_f32_16x16x32_bf16 v[84:87], v[144:147], a[196:199], v[84:87]
    ds_read_b64_tr_b16 v[170:171], v14 offset:2048
    v_mfma_f32_16x16x32_bf16 v[84:87], v[148:151], a[212:215], v[84:87]
    buffer_load_dwordx4 v12, s[28:31], s44 offen offset:1024 lds
    v_mfma_f32_16x16x32_bf16 v[88:91], v[144:147], a[200:203], v[88:91]
    ds_read_b64_tr_b16 v[172:173], v14 offset:4096
    v_mfma_f32_16x16x32_bf16 v[88:91], v[148:151], a[216:219], v[88:91]
    ds_read_b64_tr_b16 v[174:175], v14 offset:6144
    v_mfma_f32_16x16x32_bf16 v[92:95], v[144:147], a[204:207], v[92:95]
    buffer_load_dwordx4 v13, s[28:31], s44 offen offset:2048 lds
    v_mfma_f32_16x16x32_bf16 v[92:95], v[148:151], a[220:223], v[92:95]
    ds_read_b64_tr_b16 v[176:177], v14 offset:8192
    v_mfma_f32_16x16x32_bf16 v[80:83], v[152:155], a[224:227], v[80:83]
    ds_read_b64_tr_b16 v[178:179], v14 offset:10240
    v_mfma_f32_16x16x32_bf16 v[80:83], v[156:159], a[240:243], v[80:83]
    s_add_u32 m0, s46, 76800
    s_add_u32 s45, s48, 249856
    buffer_load_dwordx4 v11, s[28:31], s45 offen offset:0 lds
    v_mfma_f32_16x16x32_bf16 v[84:87], v[152:155], a[228:231], v[84:87]
    ds_read_b64_tr_b16 v[180:181], v14 offset:12288
    v_mfma_f32_16x16x32_bf16 v[84:87], v[156:159], a[244:247], v[84:87]
    ds_read_b64_tr_b16 v[182:183], v14 offset:14336
    v_mfma_f32_16x16x32_bf16 v[88:91], v[152:155], a[232:235], v[88:91]
    buffer_load_dwordx4 v12, s[28:31], s45 offen offset:1024 lds
    v_mfma_f32_16x16x32_bf16 v[88:91], v[156:159], a[248:251], v[88:91]
    ds_read_b64_tr_b16 v[184:185], v14 offset:16384
    v_mfma_f32_16x16x32_bf16 v[92:95], v[152:155], a[236:239], v[92:95]
    ds_read_b64_tr_b16 v[186:187], v14 offset:18432
    v_mfma_f32_16x16x32_bf16 v[92:95], v[156:159], a[252:255], v[92:95]
    buffer_load_dwordx4 v13, s[28:31], s45 offen offset:2048 lds
    v_mfma_f32_16x16x32_bf16 v[80:83], v[160:163], v[224:227], v[80:83]
    ds_read_b64_tr_b16 v[188:189], v14 offset:20480
    v_mfma_f32_16x16x32_bf16 v[80:83], v[164:167], v[240:243], v[80:83]
    ds_read_b64_tr_b16 v[190:191], v14 offset:22528
    v_mfma_f32_16x16x32_bf16 v[84:87], v[160:163], v[228:231], v[84:87]
    v_mfma_f32_16x16x32_bf16 v[84:87], v[164:167], v[244:247], v[84:87]
    v_mfma_f32_16x16x32_bf16 v[88:91], v[160:163], v[232:235], v[88:91]
    v_mfma_f32_16x16x32_bf16 v[88:91], v[164:167], v[248:251], v[88:91]
    v_mfma_f32_16x16x32_bf16 v[92:95], v[160:163], v[236:239], v[92:95]
    v_mfma_f32_16x16x32_bf16 v[92:95], v[164:167], v[252:255], v[92:95]
    s_waitcnt lgkmcnt(0) vmcnt(20)
    s_barrier
    v_mfma_f32_16x16x32_bf16 v[120:123], v[168:171], a[0:3], 0
    s_add_u32 m0, s46, 0
    s_add_u32 s44, s48, 443392
    buffer_load_dwordx4 v11, s[28:31], s44 offen offset:0 lds
    v_cvt_pk_bf16_f32 v204, v80, v81
    v_mfma_f32_16x16x32_bf16 v[120:123], v[172:175], a[16:19], v[120:123]
    ds_read_b64_tr_b16 v[144:145], v16 offset:0
    v_mfma_f32_16x16x32_bf16 v[124:127], v[168:171], a[4:7], 0
    ds_read_b64_tr_b16 v[146:147], v16 offset:2048
    v_mfma_f32_16x16x32_bf16 v[124:127], v[172:175], a[20:23], v[124:127]
    buffer_load_dwordx4 v12, s[28:31], s44 offen offset:1024 lds
    v_mfma_f32_16x16x32_bf16 v[128:131], v[168:171], a[8:11], 0
    ds_read_b64_tr_b16 v[148:149], v16 offset:4096
    v_mfma_f32_16x16x32_bf16 v[128:131], v[172:175], a[24:27], v[128:131]
    ds_read_b64_tr_b16 v[150:151], v16 offset:6144
    v_mfma_f32_16x16x32_bf16 v[132:135], v[168:171], a[12:15], 0
    buffer_load_dwordx4 v13, s[28:31], s44 offen offset:2048 lds
    v_cvt_pk_bf16_f32 v205, v82, v83
    v_mfma_f32_16x16x32_bf16 v[132:135], v[172:175], a[28:31], v[132:135]
    ds_read_b64_tr_b16 v[152:153], v16 offset:8192
    v_mfma_f32_16x16x32_bf16 v[120:123], v[176:179], a[32:35], v[120:123]
    ds_read_b64_tr_b16 v[154:155], v16 offset:10240
    v_mfma_f32_16x16x32_bf16 v[120:123], v[180:183], a[48:51], v[120:123]
    s_add_u32 m0, s46, 3072
    s_add_u32 s45, s48, 471040
    buffer_load_dwordx4 v11, s[28:31], s45 offen offset:0 lds
    v_mfma_f32_16x16x32_bf16 v[124:127], v[176:179], a[36:39], v[124:127]
    ds_read_b64_tr_b16 v[156:157], v16 offset:12288
    v_mfma_f32_16x16x32_bf16 v[124:127], v[180:183], a[52:55], v[124:127]
    ds_read_b64_tr_b16 v[158:159], v16 offset:14336
    v_mfma_f32_16x16x32_bf16 v[128:131], v[176:179], a[40:43], v[128:131]
    buffer_load_dwordx4 v12, s[28:31], s45 offen offset:1024 lds
    v_cvt_pk_bf16_f32 v206, v84, v85
    v_mfma_f32_16x16x32_bf16 v[128:131], v[180:183], a[56:59], v[128:131]
    ds_read_b64_tr_b16 v[160:161], v16 offset:16384
    v_mfma_f32_16x16x32_bf16 v[132:135], v[176:179], a[44:47], v[132:135]
    ds_read_b64_tr_b16 v[162:163], v16 offset:18432
    v_mfma_f32_16x16x32_bf16 v[132:135], v[180:183], a[60:63], v[132:135]
    buffer_load_dwordx4 v13, s[28:31], s45 offen offset:2048 lds
    v_mfma_f32_16x16x32_bf16 v[120:123], v[184:187], a[64:67], v[120:123]
    ds_read_b64_tr_b16 v[164:165], v16 offset:20480
    v_mfma_f32_16x16x32_bf16 v[120:123], v[188:191], a[80:83], v[120:123]
    ds_read_b64_tr_b16 v[166:167], v16 offset:22528
    v_mfma_f32_16x16x32_bf16 v[124:127], v[184:187], a[68:71], v[124:127]
    v_cvt_pk_bf16_f32 v207, v86, v87
    s_add_u32 s53, s52, 49152
    buffer_store_dwordx4 v[204:207], v27, s[24:27], s53 offen offset:0 sc1
    v_mfma_f32_16x16x32_bf16 v[124:127], v[188:191], a[84:87], v[124:127]
    v_cvt_pk_bf16_f32 v208, v88, v89
    v_mfma_f32_16x16x32_bf16 v[128:131], v[184:187], a[72:75], v[128:131]
    v_cvt_pk_bf16_f32 v209, v90, v91
    v_mfma_f32_16x16x32_bf16 v[128:131], v[188:191], a[88:91], v[128:131]
    v_cvt_pk_bf16_f32 v210, v92, v93
    v_mfma_f32_16x16x32_bf16 v[132:135], v[184:187], a[76:79], v[132:135]
    v_cvt_pk_bf16_f32 v211, v94, v95
    v_mfma_f32_16x16x32_bf16 v[132:135], v[188:191], a[92:95], v[132:135]
    buffer_store_dwordx4 v[208:211], v27, s[24:27], s53 offen offset:1024 sc1
    s_waitcnt lgkmcnt(0) vmcnt(22)
    s_barrier
    v_mfma_f32_16x16x32_bf16 v[120:123], v[144:147], a[96:99], v[120:123]
    ds_read_b64_tr_b16 v[168:169], v14 offset:24576
    v_mfma_f32_16x16x32_bf16 v[120:123], v[148:151], a[112:115], v[120:123]
    ds_read_b64_tr_b16 v[170:171], v14 offset:26624
    v_mfma_f32_16x16x32_bf16 v[124:127], v[144:147], a[100:103], v[124:127]
    v_mfma_f32_16x16x32_bf16 v[124:127], v[148:151], a[116:119], v[124:127]
    ds_read_b64_tr_b16 v[172:173], v14 offset:28672
    v_mfma_f32_16x16x32_bf16 v[128:131], v[144:147], a[104:107], v[128:131]
    ds_read_b64_tr_b16 v[174:175], v14 offset:30720
    v_mfma_f32_16x16x32_bf16 v[128:131], v[148:151], a[120:123], v[128:131]
    v_mfma_f32_16x16x32_bf16 v[132:135], v[144:147], a[108:111], v[132:135]
    ds_read_b64_tr_b16 v[176:177], v14 offset:32768
    v_mfma_f32_16x16x32_bf16 v[132:135], v[148:151], a[124:127], v[132:135]
    ds_read_b64_tr_b16 v[178:179], v14 offset:34816
    v_mfma_f32_16x16x32_bf16 v[120:123], v[152:155], a[128:131], v[120:123]
    v_mfma_f32_16x16x32_bf16 v[120:123], v[156:159], a[144:147], v[120:123]
    ds_read_b64_tr_b16 v[180:181], v14 offset:36864
    v_mfma_f32_16x16x32_bf16 v[124:127], v[152:155], a[132:135], v[124:127]
    ds_read_b64_tr_b16 v[182:183], v14 offset:38912
    v_mfma_f32_16x16x32_bf16 v[124:127], v[156:159], a[148:151], v[124:127]
    v_mfma_f32_16x16x32_bf16 v[128:131], v[152:155], a[136:139], v[128:131]
    ds_read_b64_tr_b16 v[184:185], v14 offset:40960
    v_mfma_f32_16x16x32_bf16 v[128:131], v[156:159], a[152:155], v[128:131]
    ds_read_b64_tr_b16 v[186:187], v14 offset:43008
    v_mfma_f32_16x16x32_bf16 v[132:135], v[152:155], a[140:143], v[132:135]
    v_mfma_f32_16x16x32_bf16 v[132:135], v[156:159], a[156:159], v[132:135]
    ds_read_b64_tr_b16 v[188:189], v14 offset:45056
    v_mfma_f32_16x16x32_bf16 v[120:123], v[160:163], a[160:163], v[120:123]
    ds_read_b64_tr_b16 v[190:191], v14 offset:47104
    v_mfma_f32_16x16x32_bf16 v[120:123], v[164:167], a[176:179], v[120:123]
    v_mfma_f32_16x16x32_bf16 v[124:127], v[160:163], a[164:167], v[124:127]
    v_mfma_f32_16x16x32_bf16 v[124:127], v[164:167], a[180:183], v[124:127]
    v_mfma_f32_16x16x32_bf16 v[128:131], v[160:163], a[168:171], v[128:131]
    v_mfma_f32_16x16x32_bf16 v[128:131], v[164:167], a[184:187], v[128:131]
    v_mfma_f32_16x16x32_bf16 v[132:135], v[160:163], a[172:175], v[132:135]
    v_mfma_f32_16x16x32_bf16 v[132:135], v[164:167], a[188:191], v[132:135]
    s_waitcnt lgkmcnt(0) vmcnt(14)
    s_barrier
    v_mfma_f32_16x16x32_bf16 v[120:123], v[168:171], a[192:195], v[120:123]
    ds_read_b64_tr_b16 v[144:145], v15 offset:0
    v_mfma_f32_16x16x32_bf16 v[120:123], v[172:175], a[208:211], v[120:123]
    ds_read_b64_tr_b16 v[146:147], v15 offset:2048
    v_mfma_f32_16x16x32_bf16 v[124:127], v[168:171], a[196:199], v[124:127]
    v_mfma_f32_16x16x32_bf16 v[124:127], v[172:175], a[212:215], v[124:127]
    ds_read_b64_tr_b16 v[148:149], v15 offset:4096
    v_mfma_f32_16x16x32_bf16 v[128:131], v[168:171], a[200:203], v[128:131]
    ds_read_b64_tr_b16 v[150:151], v15 offset:6144
    v_mfma_f32_16x16x32_bf16 v[128:131], v[172:175], a[216:219], v[128:131]
    v_mfma_f32_16x16x32_bf16 v[132:135], v[168:171], a[204:207], v[132:135]
    ds_read_b64_tr_b16 v[152:153], v15 offset:8192
    v_mfma_f32_16x16x32_bf16 v[132:135], v[172:175], a[220:223], v[132:135]
    ds_read_b64_tr_b16 v[154:155], v15 offset:10240
    v_mfma_f32_16x16x32_bf16 v[120:123], v[176:179], a[224:227], v[120:123]
    v_mfma_f32_16x16x32_bf16 v[120:123], v[180:183], a[240:243], v[120:123]
    ds_read_b64_tr_b16 v[156:157], v15 offset:12288
    v_mfma_f32_16x16x32_bf16 v[124:127], v[176:179], a[228:231], v[124:127]
    ds_read_b64_tr_b16 v[158:159], v15 offset:14336
    v_mfma_f32_16x16x32_bf16 v[124:127], v[180:183], a[244:247], v[124:127]
    v_mfma_f32_16x16x32_bf16 v[128:131], v[176:179], a[232:235], v[128:131]
    ds_read_b64_tr_b16 v[160:161], v15 offset:16384
    v_mfma_f32_16x16x32_bf16 v[128:131], v[180:183], a[248:251], v[128:131]
    ds_read_b64_tr_b16 v[162:163], v15 offset:18432
    v_mfma_f32_16x16x32_bf16 v[132:135], v[176:179], a[236:239], v[132:135]
    v_mfma_f32_16x16x32_bf16 v[132:135], v[180:183], a[252:255], v[132:135]
    ds_read_b64_tr_b16 v[164:165], v15 offset:20480
    v_mfma_f32_16x16x32_bf16 v[120:123], v[184:187], v[224:227], v[120:123]
    ds_read_b64_tr_b16 v[166:167], v15 offset:22528
    v_mfma_f32_16x16x32_bf16 v[120:123], v[188:191], v[240:243], v[120:123]
    v_mfma_f32_16x16x32_bf16 v[124:127], v[184:187], v[228:231], v[124:127]
    v_mfma_f32_16x16x32_bf16 v[124:127], v[188:191], v[244:247], v[124:127]
    v_mfma_f32_16x16x32_bf16 v[128:131], v[184:187], v[232:235], v[128:131]
    v_mfma_f32_16x16x32_bf16 v[128:131], v[188:191], v[248:251], v[128:131]
    v_mfma_f32_16x16x32_bf16 v[132:135], v[184:187], v[236:239], v[132:135]
    v_mfma_f32_16x16x32_bf16 v[132:135], v[188:191], v[252:255], v[132:135]
    s_waitcnt lgkmcnt(0) vmcnt(8)
    s_barrier
    v_mfma_f32_16x16x32_bf16 v[32:35], v[144:147], a[0:3], 0
    ds_read_b64_tr_b16 v[168:169], v15 offset:24576
    v_mfma_f32_16x16x32_bf16 v[32:35], v[148:151], a[16:19], v[32:35]
    ds_read_b64_tr_b16 v[170:171], v15 offset:26624
    v_mfma_f32_16x16x32_bf16 v[36:39], v[144:147], a[4:7], 0
    v_cvt_pk_bf16_f32 v212, v120, v121
    v_mfma_f32_16x16x32_bf16 v[36:39], v[148:151], a[20:23], v[36:39]
    ds_read_b64_tr_b16 v[172:173], v15 offset:28672
    v_mfma_f32_16x16x32_bf16 v[40:43], v[144:147], a[8:11], 0
    ds_read_b64_tr_b16 v[174:175], v15 offset:30720
    v_mfma_f32_16x16x32_bf16 v[40:43], v[148:151], a[24:27], v[40:43]
    v_cvt_pk_bf16_f32 v213, v122, v123
    v_mfma_f32_16x16x32_bf16 v[44:47], v[144:147], a[12:15], 0
    ds_read_b64_tr_b16 v[176:177], v15 offset:32768
    v_mfma_f32_16x16x32_bf16 v[44:47], v[148:151], a[28:31], v[44:47]
    ds_read_b64_tr_b16 v[178:179], v15 offset:34816
    v_mfma_f32_16x16x32_bf16 v[32:35], v[152:155], a[32:35], v[32:35]
    v_cvt_pk_bf16_f32 v214, v124, v125
    v_mfma_f32_16x16x32_bf16 v[32:35], v[156:159], a[48:51], v[32:35]
    ds_read_b64_tr_b16 v[180:181], v15 offset:36864
    v_mfma_f32_16x16x32_bf16 v[36:39], v[152:155], a[36:39], v[36:39]
    ds_read_b64_tr_b16 v[182:183], v15 offset:38912
    v_mfma_f32_16x16x32_bf16 v[36:39], v[156:159], a[52:55], v[36:39]
    v_mfma_f32_16x16x32_bf16 v[40:43], v[152:155], a[40:43], v[40:43]
    ds_read_b64_tr_b16 v[184:185], v15 offset:40960
    v_mfma_f32_16x16x32_bf16 v[40:43], v[156:159], a[56:59], v[40:43]
    ds_read_b64_tr_b16 v[186:187], v15 offset:43008
    v_mfma_f32_16x16x32_bf16 v[44:47], v[152:155], a[44:47], v[44:47]
    v_cvt_pk_bf16_f32 v215, v126, v127
    v_mfma_f32_16x16x32_bf16 v[44:47], v[156:159], a[60:63], v[44:47]
    ds_read_b64_tr_b16 v[188:189], v15 offset:45056
    v_mfma_f32_16x16x32_bf16 v[32:35], v[160:163], a[64:67], v[32:35]
    ds_read_b64_tr_b16 v[190:191], v15 offset:47104
    v_mfma_f32_16x16x32_bf16 v[32:35], v[164:167], a[80:83], v[32:35]
    s_add_u32 s53, s52, 57344
    buffer_store_dwordx4 v[212:215], v27, s[24:27], s53 offen offset:0 sc1
    v_mfma_f32_16x16x32_bf16 v[36:39], v[160:163], a[68:71], v[36:39]
    v_cvt_pk_bf16_f32 v216, v128, v129
    v_mfma_f32_16x16x32_bf16 v[36:39], v[164:167], a[84:87], v[36:39]
    v_cvt_pk_bf16_f32 v217, v130, v131
    v_mfma_f32_16x16x32_bf16 v[40:43], v[160:163], a[72:75], v[40:43]
    v_cvt_pk_bf16_f32 v218, v132, v133
    v_mfma_f32_16x16x32_bf16 v[40:43], v[164:167], a[88:91], v[40:43]
    v_cvt_pk_bf16_f32 v219, v134, v135
    v_mfma_f32_16x16x32_bf16 v[44:47], v[160:163], a[76:79], v[44:47]
    buffer_store_dwordx4 v[216:219], v27, s[24:27], s53 offen offset:1024 sc1
    v_mfma_f32_16x16x32_bf16 v[44:47], v[164:167], a[92:95], v[44:47]
    s_waitcnt lgkmcnt(0) vmcnt(4)
    s_barrier
    v_mfma_f32_16x16x32_bf16 v[32:35], v[168:171], a[96:99], v[32:35]
    ds_read_b64_tr_b16 v[144:145], v14 offset:0
    v_mfma_f32_16x16x32_bf16 v[32:35], v[172:175], a[112:115], v[32:35]
    ds_read_b64_tr_b16 v[146:147], v14 offset:2048
    v_mfma_f32_16x16x32_bf16 v[36:39], v[168:171], a[100:103], v[36:39]
    v_mfma_f32_16x16x32_bf16 v[36:39], v[172:175], a[116:119], v[36:39]
    ds_read_b64_tr_b16 v[148:149], v14 offset:4096
    v_mfma_f32_16x16x32_bf16 v[40:43], v[168:171], a[104:107], v[40:43]
    ds_read_b64_tr_b16 v[150:151], v14 offset:6144
    v_mfma_f32_16x16x32_bf16 v[40:43], v[172:175], a[120:123], v[40:43]
    v_mfma_f32_16x16x32_bf16 v[44:47], v[168:171], a[108:111], v[44:47]
    ds_read_b64_tr_b16 v[152:153], v14 offset:8192
    v_mfma_f32_16x16x32_bf16 v[44:47], v[172:175], a[124:127], v[44:47]
    ds_read_b64_tr_b16 v[154:155], v14 offset:10240
    v_mfma_f32_16x16x32_bf16 v[32:35], v[176:179], a[128:131], v[32:35]
    v_mfma_f32_16x16x32_bf16 v[32:35], v[180:183], a[144:147], v[32:35]
    ds_read_b64_tr_b16 v[156:157], v14 offset:12288
    v_mfma_f32_16x16x32_bf16 v[36:39], v[176:179], a[132:135], v[36:39]
    ds_read_b64_tr_b16 v[158:159], v14 offset:14336
    v_mfma_f32_16x16x32_bf16 v[36:39], v[180:183], a[148:151], v[36:39]
    v_mfma_f32_16x16x32_bf16 v[40:43], v[176:179], a[136:139], v[40:43]
    ds_read_b64_tr_b16 v[160:161], v14 offset:16384
    v_mfma_f32_16x16x32_bf16 v[40:43], v[180:183], a[152:155], v[40:43]
    ds_read_b64_tr_b16 v[162:163], v14 offset:18432
    v_mfma_f32_16x16x32_bf16 v[44:47], v[176:179], a[140:143], v[44:47]
    v_mfma_f32_16x16x32_bf16 v[44:47], v[180:183], a[156:159], v[44:47]
    ds_read_b64_tr_b16 v[164:165], v14 offset:20480
    v_mfma_f32_16x16x32_bf16 v[32:35], v[184:187], a[160:163], v[32:35]
    ds_read_b64_tr_b16 v[166:167], v14 offset:22528
    v_mfma_f32_16x16x32_bf16 v[32:35], v[188:191], a[176:179], v[32:35]
    v_mfma_f32_16x16x32_bf16 v[36:39], v[184:187], a[164:167], v[36:39]
    v_mfma_f32_16x16x32_bf16 v[36:39], v[188:191], a[180:183], v[36:39]
    v_mfma_f32_16x16x32_bf16 v[40:43], v[184:187], a[168:171], v[40:43]
    v_mfma_f32_16x16x32_bf16 v[40:43], v[188:191], a[184:187], v[40:43]
    v_mfma_f32_16x16x32_bf16 v[44:47], v[184:187], a[172:175], v[44:47]
    v_mfma_f32_16x16x32_bf16 v[44:47], v[188:191], a[188:191], v[44:47]
    s_waitcnt lgkmcnt(0) vmcnt(63)
    s_barrier
    v_mov_b32 v8, s100
    v_lshlrev_b32 v9, 2, v2
    v_lshlrev_b32 v4, 7, v2
    s_lshl_b32 s54, s40, 7
    s_add_u32 s54, s54, s64
    v_mfma_f32_16x16x32_bf16 v[32:35], v[144:147], a[192:195], v[32:35]
    v_mfma_f32_16x16x32_bf16 v[32:35], v[148:151], a[208:211], v[32:35]
    v_mfma_f32_16x16x32_bf16 v[36:39], v[144:147], a[196:199], v[36:39]
    v_mfma_f32_16x16x32_bf16 v[36:39], v[148:151], a[212:215], v[36:39]
    v_mfma_f32_16x16x32_bf16 v[40:43], v[144:147], a[200:203], v[40:43]
    v_mfma_f32_16x16x32_bf16 v[40:43], v[148:151], a[216:219], v[40:43]
    v_mfma_f32_16x16x32_bf16 v[44:47], v[144:147], a[204:207], v[44:47]
    v_mfma_f32_16x16x32_bf16 v[44:47], v[148:151], a[220:223], v[44:47]
    v_mfma_f32_16x16x32_bf16 v[32:35], v[152:155], a[224:227], v[32:35]
    v_mfma_f32_16x16x32_bf16 v[32:35], v[156:159], a[240:243], v[32:35]
    v_mfma_f32_16x16x32_bf16 v[36:39], v[152:155], a[228:231], v[36:39]
    v_mfma_f32_16x16x32_bf16 v[36:39], v[156:159], a[244:247], v[36:39]
    v_mfma_f32_16x16x32_bf16 v[40:43], v[152:155], a[232:235], v[40:43]
    v_mfma_f32_16x16x32_bf16 v[40:43], v[156:159], a[248:251], v[40:43]
    v_mfma_f32_16x16x32_bf16 v[44:47], v[152:155], a[236:239], v[44:47]
    v_mfma_f32_16x16x32_bf16 v[44:47], v[156:159], a[252:255], v[44:47]
    v_mfma_f32_16x16x32_bf16 v[32:35], v[160:163], v[224:227], v[32:35]
    v_mfma_f32_16x16x32_bf16 v[32:35], v[164:167], v[240:243], v[32:35]
    v_mfma_f32_16x16x32_bf16 v[36:39], v[160:163], v[228:231], v[36:39]
    v_mfma_f32_16x16x32_bf16 v[36:39], v[164:167], v[244:247], v[36:39]
    v_mfma_f32_16x16x32_bf16 v[40:43], v[160:163], v[232:235], v[40:43]
    v_mfma_f32_16x16x32_bf16 v[40:43], v[164:167], v[248:251], v[40:43]
    v_mfma_f32_16x16x32_bf16 v[44:47], v[160:163], v[236:239], v[44:47]
    v_mfma_f32_16x16x32_bf16 v[44:47], v[164:167], v[252:255], v[44:47]
    s_nop 7
    v_cvt_pk_bf16_f32 v204, v32, v33
    v_cvt_pk_bf16_f32 v205, v34, v35
    v_cvt_pk_bf16_f32 v206, v36, v37
    v_cvt_pk_bf16_f32 v207, v38, v39
    s_add_u32 s53, s52, 65536
    buffer_store_dwordx4 v[204:207], v27, s[24:27], s53 offen offset:0 sc1
    v_cvt_pk_bf16_f32 v208, v40, v41
    v_cvt_pk_bf16_f32 v209, v42, v43
    v_cvt_pk_bf16_f32 v210, v44, v45
    v_cvt_pk_bf16_f32 v211, v46, v47
    buffer_store_dwordx4 v[208:211], v27, s[24:27], s53 offen offset:1024 sc1
    s_waitcnt vmcnt(0)
    s_barrier
    s_cmp_lg_u32 s42, 0
    s_cbranch_scc1 L_sequential_preLN__linear_kernel_hedgehog__swiglu_ffn__prompt_kernelf_pubB
    s_mov_b64 exec, 0xffffffff
    buffer_store_dword v8, v9, s[60:63], s54 offen sc0 sc1
    s_mov_b64 exec, -1
L_sequential_preLN__linear_kernel_hedgehog__swiglu_ffn__prompt_kernelf_pubB:
    s_mov_b32 s16, s66
    s_mov_b32 s17, s67
    s_mov_b32 s18, 0x240000
    s_mov_b32 s19, 0x00020000
    v_and_b32 v10, 15, v2
    v_mul_u32_u24 v10, 1152, v10
    v_lshrrev_b32 v11, 4, v2
    v_lshl_add_u32 v10, v11, 3, v10
    v_add_u32 v11, 18432, v10
    v_add_u32 v12, 18432, v3
    s_add_u32 s44, s40, 0
    s_lshr_b32 s56, s44, 1
    s_lshl_b32 s56, s56, 2
    s_add_u32 s56, s56, s42
    s_lshl_b32 s56, s56, 1
    s_and_b32 s44, s44, 1
    s_add_u32 s56, s56, s44
    s_mul_i32 s44, s41, 73728
    s_lshl_b32 s45, s56, 10
    s_add_u32 s28, s44, s45
    s_and_b32 s45, s56, 1
    s_lshl_b32 s45, s45, 1
    s_lshl_b32 s46, s41, 2
    s_add_u32 s45, s45, s46
    s_mul_i32 s46, s45, 18432
    s_lshr_b32 s47, s56, 2
    s_lshl_b32 s47, s47, 10
    s_add_u32 s47, s47, s46
    s_bfe_u32 s48, s56, 0x10001
    s_lshl_b32 s48, s48, 3
    s_add_u32 s29, s47, s48
    s_lshr_b32 s47, s56, 1
    s_lshl_b32 s47, s47, 5
    s_add_u32 s30, s46, s47
    buffer_load_dwordx2 v[112:113], v3, s[20:23], s29 offen sc1
    buffer_load_dwordx2 v[114:115], v12, s[20:23], s29 offen sc1
    s_add_u32 s44, s40, 8
    s_lshr_b32 s56, s44, 1
    s_lshl_b32 s56, s56, 2
    s_add_u32 s56, s56, s42
    s_lshl_b32 s56, s56, 1
    s_and_b32 s44, s44, 1
    s_add_u32 s56, s56, s44
    s_mul_i32 s44, s41, 73728
    s_lshl_b32 s45, s56, 10
    s_add_u32 s31, s44, s45
    s_and_b32 s45, s56, 1
    s_lshl_b32 s45, s45, 1
    s_lshl_b32 s46, s41, 2
    s_add_u32 s45, s45, s46
    s_mul_i32 s46, s45, 18432
    s_lshr_b32 s47, s56, 2
    s_lshl_b32 s47, s47, 10
    s_add_u32 s47, s47, s46
    s_bfe_u32 s48, s56, 0x10001
    s_lshl_b32 s48, s48, 3
    s_add_u32 s32, s47, s48
    s_lshr_b32 s47, s56, 1
    s_lshl_b32 s47, s47, 5
    s_add_u32 s33, s46, s47
    buffer_load_dwordx2 v[148:149], v3, s[20:23], s32 offen sc1
    buffer_load_dwordx2 v[150:151], v12, s[20:23], s32 offen sc1
    s_add_u32 s44, s40, 16
    s_lshr_b32 s56, s44, 1
    s_lshl_b32 s56, s56, 2
    s_add_u32 s56, s56, s42
    s_lshl_b32 s56, s56, 1
    s_and_b32 s44, s44, 1
    s_add_u32 s56, s56, s44
    s_mul_i32 s44, s41, 73728
    s_lshl_b32 s45, s56, 10
    s_add_u32 s34, s44, s45
    s_and_b32 s45, s56, 1
    s_lshl_b32 s45, s45, 1
    s_lshl_b32 s46, s41, 2
    s_add_u32 s45, s45, s46
    s_mul_i32 s46, s45, 18432
    s_lshr_b32 s47, s56, 2
    s_lshl_b32 s47, s47, 10
    s_add_u32 s47, s47, s46
    s_bfe_u32 s48, s56, 0x10001
    s_lshl_b32 s48, s48, 3
    s_add_u32 s35, s47, s48
    s_lshr_b32 s47, s56, 1
    s_lshl_b32 s47, s47, 5
    s_add_u32 s36, s46, s47
    s_cmp_lt_u32 s40, 2
    s_cselect_b32 s34, s34, 0x40000000
    s_cselect_b32 s35, s35, 0x40000000
    s_cselect_b32 s36, s36, 0x40000000
    buffer_load_dwordx2 v[184:185], v3, s[20:23], s35 offen sc1
    buffer_load_dwordx2 v[186:187], v12, s[20:23], s35 offen sc1
    s_mov_b32 s55, 0x8000
    s_mov_b64 exec, 0xff
L_sequential_preLN__linear_kernel_hedgehog__swiglu_ffn__prompt_kernelf_pollB:
    buffer_load_dword v14, v4, s[60:63], s64 offen offset:0 sc0 sc1
    s_waitcnt vmcnt(0)
    v_cmp_ne_u32 vcc, v14, v8
    s_sub_u32 s55, s55, 1
    s_cbranch_scc1 L_sequential_preLN__linear_kernel_hedgehog__swiglu_ffn__prompt_kernelf_pollBd
    s_cbranch_vccz L_sequential_preLN__linear_kernel_hedgehog__swiglu_ffn__prompt_kernelf_pollBd
    s_sleep 1
    s_branch L_sequential_preLN__linear_kernel_hedgehog__swiglu_ffn__prompt_kernelf_pollB
L_sequential_preLN__linear_kernel_hedgehog__swiglu_ffn__prompt_kernelf_pollBd:
    s_mov_b64 exec, -1
    s_mov_b32 s44, s28
    buffer_load_dwordx4 v[80:83], v3, s[24:27], s44 offen sc1
    s_add_u32 s44, s44, 2359296
    buffer_load_dwordx4 v[84:87], v3, s[24:27], s44 offen sc1
    s_add_u32 s44, s44, 2359296
    buffer_load_dwordx4 v[88:91], v3, s[24:27], s44 offen sc1
    s_add_u32 s44, s44, 2359296
    buffer_load_dwordx4 v[92:95], v3, s[24:27], s44 offen sc1
    s_add_u32 s44, s44, 2359296
    buffer_load_dwordx4 v[96:99], v3, s[24:27], s44 offen sc1
    s_add_u32 s44, s44, 2359296
    buffer_load_dwordx4 v[100:103], v3, s[24:27], s44 offen sc1
    s_add_u32 s44, s44, 2359296
    buffer_load_dwordx4 v[104:107], v3, s[24:27], s44 offen sc1
    s_add_u32 s44, s44, 2359296
    buffer_load_dwordx4 v[108:111], v3, s[24:27], s44 offen sc1
    s_mov_b32 s44, s31
    buffer_load_dwordx4 v[116:119], v3, s[24:27], s44 offen sc1
    s_add_u32 s44, s44, 2359296
    buffer_load_dwordx4 v[120:123], v3, s[24:27], s44 offen sc1
    s_add_u32 s44, s44, 2359296
    buffer_load_dwordx4 v[124:127], v3, s[24:27], s44 offen sc1
    s_add_u32 s44, s44, 2359296
    buffer_load_dwordx4 v[128:131], v3, s[24:27], s44 offen sc1
    s_add_u32 s44, s44, 2359296
    buffer_load_dwordx4 v[132:135], v3, s[24:27], s44 offen sc1
    s_add_u32 s44, s44, 2359296
    buffer_load_dwordx4 v[136:139], v3, s[24:27], s44 offen sc1
    s_add_u32 s44, s44, 2359296
    buffer_load_dwordx4 v[140:143], v3, s[24:27], s44 offen sc1
    s_add_u32 s44, s44, 2359296
    buffer_load_dwordx4 v[144:147], v3, s[24:27], s44 offen sc1
    s_mov_b32 s44, s34
    buffer_load_dwordx4 v[152:155], v3, s[24:27], s44 offen sc1
    s_add_u32 s44, s44, 2359296
    buffer_load_dwordx4 v[156:159], v3, s[24:27], s44 offen sc1
    s_add_u32 s44, s44, 2359296
    buffer_load_dwordx4 v[160:163], v3, s[24:27], s44 offen sc1
    s_add_u32 s44, s44, 2359296
    buffer_load_dwordx4 v[164:167], v3, s[24:27], s44 offen sc1
    s_add_u32 s44, s44, 2359296
    buffer_load_dwordx4 v[168:171], v3, s[24:27], s44 offen sc1
    s_add_u32 s44, s44, 2359296
    buffer_load_dwordx4 v[172:175], v3, s[24:27], s44 offen sc1
    s_add_u32 s44, s44, 2359296
    buffer_load_dwordx4 v[176:179], v3, s[24:27], s44 offen sc1
    s_add_u32 s44, s44, 2359296
    buffer_load_dwordx4 v[180:183], v3, s[24:27], s44 offen sc1
    s_waitcnt vmcnt(16)
    v_lshlrev_b32 v32, 16, v112
    v_and_b32 v33, 0xffff0000, v112
    v_lshlrev_b32 v34, 16, v113
    v_and_b32 v35, 0xffff0000, v113
    v_lshlrev_b32 v36, 16, v114
    v_and_b32 v37, 0xffff0000, v114
    v_lshlrev_b32 v38, 16, v115
    v_and_b32 v39, 0xffff0000, v115
    v_lshlrev_b32 v40, 16, v80
    v_and_b32 v41, 0xffff0000, v80
    v_pk_add_f32 v[32:33], v[32:33], v[40:41]
    v_lshlrev_b32 v42, 16, v81
    v_and_b32 v43, 0xffff0000, v81
    v_pk_add_f32 v[34:35], v[34:35], v[42:43]
    v_lshlrev_b32 v40, 16, v82
    v_and_b32 v41, 0xffff0000, v82
    v_pk_add_f32 v[36:37], v[36:37], v[40:41]
    v_lshlrev_b32 v42, 16, v83
    v_and_b32 v43, 0xffff0000, v83
    v_pk_add_f32 v[38:39], v[38:39], v[42:43]
    v_lshlrev_b32 v40, 16, v84
    v_and_b32 v41, 0xffff0000, v84
    v_pk_add_f32 v[32:33], v[32:33], v[40:41]
    v_lshlrev_b32 v42, 16, v85
    v_and_b32 v43, 0xffff0000, v85
    v_pk_add_f32 v[34:35], v[34:35], v[42:43]
    v_lshlrev_b32 v40, 16, v86
    v_and_b32 v41, 0xffff0000, v86
    v_pk_add_f32 v[36:37], v[36:37], v[40:41]
    v_lshlrev_b32 v42, 16, v87
    v_and_b32 v43, 0xffff0000, v87
    v_pk_add_f32 v[38:39], v[38:39], v[42:43]
    v_lshlrev_b32 v40, 16, v88
    v_and_b32 v41, 0xffff0000, v88
    v_pk_add_f32 v[32:33], v[32:33], v[40:41]
    v_lshlrev_b32 v42, 16, v89
    v_and_b32 v43, 0xffff0000, v89
    v_pk_add_f32 v[34:35], v[34:35], v[42:43]
    v_lshlrev_b32 v40, 16, v90
    v_and_b32 v41, 0xffff0000, v90
    v_pk_add_f32 v[36:37], v[36:37], v[40:41]
    v_lshlrev_b32 v42, 16, v91
    v_and_b32 v43, 0xffff0000, v91
    v_pk_add_f32 v[38:39], v[38:39], v[42:43]
    v_lshlrev_b32 v40, 16, v92
    v_and_b32 v41, 0xffff0000, v92
    v_pk_add_f32 v[32:33], v[32:33], v[40:41]
    v_lshlrev_b32 v42, 16, v93
    v_and_b32 v43, 0xffff0000, v93
    v_pk_add_f32 v[34:35], v[34:35], v[42:43]
    v_lshlrev_b32 v40, 16, v94
    v_and_b32 v41, 0xffff0000, v94
    v_pk_add_f32 v[36:37], v[36:37], v[40:41]
    v_lshlrev_b32 v42, 16, v95
    v_and_b32 v43, 0xffff0000, v95
    v_pk_add_f32 v[38:39], v[38:39], v[42:43]
    v_lshlrev_b32 v40, 16, v96
    v_and_b32 v41, 0xffff0000, v96
    v_pk_add_f32 v[32:33], v[32:33], v[40:41]
    v_lshlrev_b32 v42, 16, v97
    v_and_b32 v43, 0xffff0000, v97
    v_pk_add_f32 v[34:35], v[34:35], v[42:43]
    v_lshlrev_b32 v40, 16, v98
    v_and_b32 v41, 0xffff0000, v98
    v_pk_add_f32 v[36:37], v[36:37], v[40:41]
    v_lshlrev_b32 v42, 16, v99
    v_and_b32 v43, 0xffff0000, v99
    v_pk_add_f32 v[38:39], v[38:39], v[42:43]
    v_lshlrev_b32 v40, 16, v100
    v_and_b32 v41, 0xffff0000, v100
    v_pk_add_f32 v[32:33], v[32:33], v[40:41]
    v_lshlrev_b32 v42, 16, v101
    v_and_b32 v43, 0xffff0000, v101
    v_pk_add_f32 v[34:35], v[34:35], v[42:43]
    v_lshlrev_b32 v40, 16, v102
    v_and_b32 v41, 0xffff0000, v102
    v_pk_add_f32 v[36:37], v[36:37], v[40:41]
    v_lshlrev_b32 v42, 16, v103
    v_and_b32 v43, 0xffff0000, v103
    v_pk_add_f32 v[38:39], v[38:39], v[42:43]
    v_lshlrev_b32 v40, 16, v104
    v_and_b32 v41, 0xffff0000, v104
    v_pk_add_f32 v[32:33], v[32:33], v[40:41]
    v_lshlrev_b32 v42, 16, v105
    v_and_b32 v43, 0xffff0000, v105
    v_pk_add_f32 v[34:35], v[34:35], v[42:43]
    v_lshlrev_b32 v40, 16, v106
    v_and_b32 v41, 0xffff0000, v106
    v_pk_add_f32 v[36:37], v[36:37], v[40:41]
    v_lshlrev_b32 v42, 16, v107
    v_and_b32 v43, 0xffff0000, v107
    v_pk_add_f32 v[38:39], v[38:39], v[42:43]
    v_lshlrev_b32 v40, 16, v108
    v_and_b32 v41, 0xffff0000, v108
    v_pk_add_f32 v[32:33], v[32:33], v[40:41]
    v_lshlrev_b32 v42, 16, v109
    v_and_b32 v43, 0xffff0000, v109
    v_pk_add_f32 v[34:35], v[34:35], v[42:43]
    v_lshlrev_b32 v40, 16, v110
    v_and_b32 v41, 0xffff0000, v110
    v_pk_add_f32 v[36:37], v[36:37], v[40:41]
    v_lshlrev_b32 v42, 16, v111
    v_and_b32 v43, 0xffff0000, v111
    v_pk_add_f32 v[38:39], v[38:39], v[42:43]
    v_cvt_pk_bf16_f32 v112, v32, v33
    v_cvt_pk_bf16_f32 v113, v34, v35
    v_cvt_pk_bf16_f32 v114, v36, v37
    v_cvt_pk_bf16_f32 v115, v38, v39
    buffer_store_dwordx2 v[112:113], v10, s[16:19], s30 offen
    buffer_store_dwordx2 v[114:115], v11, s[16:19], s30 offen
    s_waitcnt vmcnt(10)
    v_lshlrev_b32 v32, 16, v148
    v_and_b32 v33, 0xffff0000, v148
    v_lshlrev_b32 v34, 16, v149
    v_and_b32 v35, 0xffff0000, v149
    v_lshlrev_b32 v36, 16, v150
    v_and_b32 v37, 0xffff0000, v150
    v_lshlrev_b32 v38, 16, v151
    v_and_b32 v39, 0xffff0000, v151
    v_lshlrev_b32 v40, 16, v116
    v_and_b32 v41, 0xffff0000, v116
    v_pk_add_f32 v[32:33], v[32:33], v[40:41]
    v_lshlrev_b32 v42, 16, v117
    v_and_b32 v43, 0xffff0000, v117
    v_pk_add_f32 v[34:35], v[34:35], v[42:43]
    v_lshlrev_b32 v40, 16, v118
    v_and_b32 v41, 0xffff0000, v118
    v_pk_add_f32 v[36:37], v[36:37], v[40:41]
    v_lshlrev_b32 v42, 16, v119
    v_and_b32 v43, 0xffff0000, v119
    v_pk_add_f32 v[38:39], v[38:39], v[42:43]
    v_lshlrev_b32 v40, 16, v120
    v_and_b32 v41, 0xffff0000, v120
    v_pk_add_f32 v[32:33], v[32:33], v[40:41]
    v_lshlrev_b32 v42, 16, v121
    v_and_b32 v43, 0xffff0000, v121
    v_pk_add_f32 v[34:35], v[34:35], v[42:43]
    v_lshlrev_b32 v40, 16, v122
    v_and_b32 v41, 0xffff0000, v122
    v_pk_add_f32 v[36:37], v[36:37], v[40:41]
    v_lshlrev_b32 v42, 16, v123
    v_and_b32 v43, 0xffff0000, v123
    v_pk_add_f32 v[38:39], v[38:39], v[42:43]
    v_lshlrev_b32 v40, 16, v124
    v_and_b32 v41, 0xffff0000, v124
    v_pk_add_f32 v[32:33], v[32:33], v[40:41]
    v_lshlrev_b32 v42, 16, v125
    v_and_b32 v43, 0xffff0000, v125
    v_pk_add_f32 v[34:35], v[34:35], v[42:43]
    v_lshlrev_b32 v40, 16, v126
    v_and_b32 v41, 0xffff0000, v126
    v_pk_add_f32 v[36:37], v[36:37], v[40:41]
    v_lshlrev_b32 v42, 16, v127
    v_and_b32 v43, 0xffff0000, v127
    v_pk_add_f32 v[38:39], v[38:39], v[42:43]
    v_lshlrev_b32 v40, 16, v128
    v_and_b32 v41, 0xffff0000, v128
    v_pk_add_f32 v[32:33], v[32:33], v[40:41]
    v_lshlrev_b32 v42, 16, v129
    v_and_b32 v43, 0xffff0000, v129
    v_pk_add_f32 v[34:35], v[34:35], v[42:43]
    v_lshlrev_b32 v40, 16, v130
    v_and_b32 v41, 0xffff0000, v130
    v_pk_add_f32 v[36:37], v[36:37], v[40:41]
    v_lshlrev_b32 v42, 16, v131
    v_and_b32 v43, 0xffff0000, v131
    v_pk_add_f32 v[38:39], v[38:39], v[42:43]
    v_lshlrev_b32 v40, 16, v132
    v_and_b32 v41, 0xffff0000, v132
    v_pk_add_f32 v[32:33], v[32:33], v[40:41]
    v_lshlrev_b32 v42, 16, v133
    v_and_b32 v43, 0xffff0000, v133
    v_pk_add_f32 v[34:35], v[34:35], v[42:43]
    v_lshlrev_b32 v40, 16, v134
    v_and_b32 v41, 0xffff0000, v134
    v_pk_add_f32 v[36:37], v[36:37], v[40:41]
    v_lshlrev_b32 v42, 16, v135
    v_and_b32 v43, 0xffff0000, v135
    v_pk_add_f32 v[38:39], v[38:39], v[42:43]
    v_lshlrev_b32 v40, 16, v136
    v_and_b32 v41, 0xffff0000, v136
    v_pk_add_f32 v[32:33], v[32:33], v[40:41]
    v_lshlrev_b32 v42, 16, v137
    v_and_b32 v43, 0xffff0000, v137
    v_pk_add_f32 v[34:35], v[34:35], v[42:43]
    v_lshlrev_b32 v40, 16, v138
    v_and_b32 v41, 0xffff0000, v138
    v_pk_add_f32 v[36:37], v[36:37], v[40:41]
    v_lshlrev_b32 v42, 16, v139
    v_and_b32 v43, 0xffff0000, v139
    v_pk_add_f32 v[38:39], v[38:39], v[42:43]
    v_lshlrev_b32 v40, 16, v140
    v_and_b32 v41, 0xffff0000, v140
    v_pk_add_f32 v[32:33], v[32:33], v[40:41]
    v_lshlrev_b32 v42, 16, v141
    v_and_b32 v43, 0xffff0000, v141
    v_pk_add_f32 v[34:35], v[34:35], v[42:43]
    v_lshlrev_b32 v40, 16, v142
    v_and_b32 v41, 0xffff0000, v142
    v_pk_add_f32 v[36:37], v[36:37], v[40:41]
    v_lshlrev_b32 v42, 16, v143
    v_and_b32 v43, 0xffff0000, v143
    v_pk_add_f32 v[38:39], v[38:39], v[42:43]
    v_lshlrev_b32 v40, 16, v144
    v_and_b32 v41, 0xffff0000, v144
    v_pk_add_f32 v[32:33], v[32:33], v[40:41]
    v_lshlrev_b32 v42, 16, v145
    v_and_b32 v43, 0xffff0000, v145
    v_pk_add_f32 v[34:35], v[34:35], v[42:43]
    v_lshlrev_b32 v40, 16, v146
    v_and_b32 v41, 0xffff0000, v146
    v_pk_add_f32 v[36:37], v[36:37], v[40:41]
    v_lshlrev_b32 v42, 16, v147
    v_and_b32 v43, 0xffff0000, v147
    v_pk_add_f32 v[38:39], v[38:39], v[42:43]
    v_cvt_pk_bf16_f32 v148, v32, v33
    v_cvt_pk_bf16_f32 v149, v34, v35
    v_cvt_pk_bf16_f32 v150, v36, v37
    v_cvt_pk_bf16_f32 v151, v38, v39
    buffer_store_dwordx2 v[148:149], v10, s[16:19], s33 offen
    buffer_store_dwordx2 v[150:151], v11, s[16:19], s33 offen
    s_waitcnt vmcnt(4)
    v_lshlrev_b32 v32, 16, v184
    v_and_b32 v33, 0xffff0000, v184
    v_lshlrev_b32 v34, 16, v185
    v_and_b32 v35, 0xffff0000, v185
    v_lshlrev_b32 v36, 16, v186
    v_and_b32 v37, 0xffff0000, v186
    v_lshlrev_b32 v38, 16, v187
    v_and_b32 v39, 0xffff0000, v187
    v_lshlrev_b32 v40, 16, v152
    v_and_b32 v41, 0xffff0000, v152
    v_pk_add_f32 v[32:33], v[32:33], v[40:41]
    v_lshlrev_b32 v42, 16, v153
    v_and_b32 v43, 0xffff0000, v153
    v_pk_add_f32 v[34:35], v[34:35], v[42:43]
    v_lshlrev_b32 v40, 16, v154
    v_and_b32 v41, 0xffff0000, v154
    v_pk_add_f32 v[36:37], v[36:37], v[40:41]
    v_lshlrev_b32 v42, 16, v155
    v_and_b32 v43, 0xffff0000, v155
    v_pk_add_f32 v[38:39], v[38:39], v[42:43]
    v_lshlrev_b32 v40, 16, v156
    v_and_b32 v41, 0xffff0000, v156
    v_pk_add_f32 v[32:33], v[32:33], v[40:41]
    v_lshlrev_b32 v42, 16, v157
    v_and_b32 v43, 0xffff0000, v157
    v_pk_add_f32 v[34:35], v[34:35], v[42:43]
    v_lshlrev_b32 v40, 16, v158
    v_and_b32 v41, 0xffff0000, v158
    v_pk_add_f32 v[36:37], v[36:37], v[40:41]
    v_lshlrev_b32 v42, 16, v159
    v_and_b32 v43, 0xffff0000, v159
    v_pk_add_f32 v[38:39], v[38:39], v[42:43]
    v_lshlrev_b32 v40, 16, v160
    v_and_b32 v41, 0xffff0000, v160
    v_pk_add_f32 v[32:33], v[32:33], v[40:41]
    v_lshlrev_b32 v42, 16, v161
    v_and_b32 v43, 0xffff0000, v161
    v_pk_add_f32 v[34:35], v[34:35], v[42:43]
    v_lshlrev_b32 v40, 16, v162
    v_and_b32 v41, 0xffff0000, v162
    v_pk_add_f32 v[36:37], v[36:37], v[40:41]
    v_lshlrev_b32 v42, 16, v163
    v_and_b32 v43, 0xffff0000, v163
    v_pk_add_f32 v[38:39], v[38:39], v[42:43]
    v_lshlrev_b32 v40, 16, v164
    v_and_b32 v41, 0xffff0000, v164
    v_pk_add_f32 v[32:33], v[32:33], v[40:41]
    v_lshlrev_b32 v42, 16, v165
    v_and_b32 v43, 0xffff0000, v165
    v_pk_add_f32 v[34:35], v[34:35], v[42:43]
    v_lshlrev_b32 v40, 16, v166
    v_and_b32 v41, 0xffff0000, v166
    v_pk_add_f32 v[36:37], v[36:37], v[40:41]
    v_lshlrev_b32 v42, 16, v167
    v_and_b32 v43, 0xffff0000, v167
    v_pk_add_f32 v[38:39], v[38:39], v[42:43]
    v_lshlrev_b32 v40, 16, v168
    v_and_b32 v41, 0xffff0000, v168
    v_pk_add_f32 v[32:33], v[32:33], v[40:41]
    v_lshlrev_b32 v42, 16, v169
    v_and_b32 v43, 0xffff0000, v169
    v_pk_add_f32 v[34:35], v[34:35], v[42:43]
    v_lshlrev_b32 v40, 16, v170
    v_and_b32 v41, 0xffff0000, v170
    v_pk_add_f32 v[36:37], v[36:37], v[40:41]
    v_lshlrev_b32 v42, 16, v171
    v_and_b32 v43, 0xffff0000, v171
    v_pk_add_f32 v[38:39], v[38:39], v[42:43]
    v_lshlrev_b32 v40, 16, v172
    v_and_b32 v41, 0xffff0000, v172
    v_pk_add_f32 v[32:33], v[32:33], v[40:41]
    v_lshlrev_b32 v42, 16, v173
    v_and_b32 v43, 0xffff0000, v173
    v_pk_add_f32 v[34:35], v[34:35], v[42:43]
    v_lshlrev_b32 v40, 16, v174
    v_and_b32 v41, 0xffff0000, v174
    v_pk_add_f32 v[36:37], v[36:37], v[40:41]
    v_lshlrev_b32 v42, 16, v175
    v_and_b32 v43, 0xffff0000, v175
    v_pk_add_f32 v[38:39], v[38:39], v[42:43]
    v_lshlrev_b32 v40, 16, v176
    v_and_b32 v41, 0xffff0000, v176
    v_pk_add_f32 v[32:33], v[32:33], v[40:41]
    v_lshlrev_b32 v42, 16, v177
    v_and_b32 v43, 0xffff0000, v177
    v_pk_add_f32 v[34:35], v[34:35], v[42:43]
    v_lshlrev_b32 v40, 16, v178
    v_and_b32 v41, 0xffff0000, v178
    v_pk_add_f32 v[36:37], v[36:37], v[40:41]
    v_lshlrev_b32 v42, 16, v179
    v_and_b32 v43, 0xffff0000, v179
    v_pk_add_f32 v[38:39], v[38:39], v[42:43]
    v_lshlrev_b32 v40, 16, v180
    v_and_b32 v41, 0xffff0000, v180
    v_pk_add_f32 v[32:33], v[32:33], v[40:41]
    v_lshlrev_b32 v42, 16, v181
    v_and_b32 v43, 0xffff0000, v181
    v_pk_add_f32 v[34:35], v[34:35], v[42:43]
    v_lshlrev_b32 v40, 16, v182
    v_and_b32 v41, 0xffff0000, v182
    v_pk_add_f32 v[36:37], v[36:37], v[40:41]
    v_lshlrev_b32 v42, 16, v183
    v_and_b32 v43, 0xffff0000, v183
    v_pk_add_f32 v[38:39], v[38:39], v[42:43]
    v_cvt_pk_bf16_f32 v184, v32, v33
    v_cvt_pk_bf16_f32 v185, v34, v35
    v_cvt_pk_bf16_f32 v186, v36, v37
    v_cvt_pk_bf16_f32 v187, v38, v39
    buffer_store_dwordx2 v[184:185], v10, s[16:19], s36 offen
    buffer_store_dwordx2 v[186:187], v11, s[16:19], s36 offen
L_sequential_preLN__linear_kernel_hedgehog__swiglu_ffn__prompt_kernel_end:
    s_endpgm
.section .rodata,"a"
.p2align 6
.amdhsa_kernel sequential_preLN__linear_kernel_hedgehog__swiglu_ffn__prompt_kernel
  .amdhsa_next_free_vgpr 512
  .amdhsa_next_free_sgpr 102
  .amdhsa_accum_offset 256
  .amdhsa_group_segment_fixed_size 0
  .amdhsa_kernarg_size 88
  .amdhsa_user_sgpr_count 2
  .amdhsa_user_sgpr_kernarg_segment_ptr 1
  .amdhsa_system_sgpr_workgroup_id_x 1
.end_amdhsa_kernel
.text
L_all_end:
```
